```python
import torch

def _softmax(x, axis=-1):
    return torch.softmax(x, dim=axis)
def _gelu(x):
    return torch.nn.functional.gelu(x, approximate="tanh")
def _silu(x):
    return torch.nn.functional.silu(x)
def _sigmoid(x):
    return torch.sigmoid(x)
def _layernorm(x, axis=-1, eps=1e-5):
    m = x.mean(dim=axis, keepdim=True)
    v = x.var(dim=axis, keepdim=True, unbiased=False)
    return (x - m) / torch.sqrt(v + eps)
def _scatter_add(tgt, idx, src, axis=0):
    return tgt.clone().index_add_(axis, idx, src)
def _segment_sum(src, seg, n):
    out = torch.zeros((n,) + src.shape[1:], dtype=src.dtype)
    return out.index_add_(0, seg, src)
def _pad(x, pw):
    flat = tuple(v for pair in reversed(pw) for v in pair)
    return torch.nn.functional.pad(x, flat)

kernel_name = 'recurrent_scan__mha_block__mixer_channel_mlp__prompt'

def setup_inputs():

    _w = (lambda a: (lambda t: t.to(torch.bfloat16) if t.is_floating_point() else t)(torch.as_tensor(a)))
    def _A_setup():
        B, S, D, H = 1, 2048, 640, 32
        return {
            "x": _w((lambda *s: torch.randn(*s, dtype=torch.bfloat16) * 0.05)(B, S, D)),
            "wqkv": _w((lambda *s: torch.randn(*s, dtype=torch.bfloat16) * 0.05)(D, 3 * D)),
            "wo": _w((lambda *s: torch.randn(*s, dtype=torch.bfloat16) * 0.05)(D, D)),
        }
    _A_in = _A_setup()

    def _B_setup():
        B, S, D, F = 1, 2048, 640, 1728
        return {
            "x": _w((lambda *s: torch.randn(*s, dtype=torch.bfloat16) * 0.05)(B, S, D)),
            "w1": _w((lambda *s: torch.randn(*s, dtype=torch.bfloat16) * 3.2)(D, F) * (D ** -0.5)),
            "b1": _w((lambda *s: torch.randn(*s, dtype=torch.bfloat16) * 1.6)(F)),
            "w2": _w((lambda *s: torch.randn(*s, dtype=torch.bfloat16) * 0.05)(F, D) * (F ** -0.5)),
            "b2": _w((lambda *s: torch.randn(*s, dtype=torch.bfloat16) * 0.05)(D)),
        }
    _B_in = _B_setup()

    return {
        "A_x": _A_in["x"],
        "A_wqkv": _A_in["wqkv"],
        "A_wo": _A_in["wo"],
        "B_x": _B_in["x"],
        "B_w1": _B_in["w1"],
        "B_b1": _B_in["b1"],
        "B_w2": _B_in["w2"],
        "B_b2": _B_in["b2"],
    }

def reference(A_x, A_wqkv, A_wo, B_x, B_w1, B_b1, B_w2, B_b2):
    def _A_ref(x, wqkv, wo):
        B, S, D = x.shape
        H = 32
        Dh = D // H
        qkv = (lambda x, *d: x.permute(*d))((x @ wqkv).reshape(B, S, 3, H, Dh), 2, 0, 3, 1, 4)
        q, k, v = qkv[0], qkv[1], qkv[2]
        scores = torch.einsum("bhqd,bhkd->bhqk", q, k) * (Dh ** -0.5)
        p = _softmax(scores, axis=-1)
        o = torch.einsum("bhqk,bhkd->bhqd", p, v)
        return (lambda x, *d: x.permute(*d))(o, 0, 2, 1, 3).reshape(B, S, D) @ wo

    def _B_ref(x, w1, b1, w2, b2):
        y = _layernorm(x, axis=-1)
        h = _gelu(torch.einsum("bsd,df->bsf", y, w1) + b1)
        return torch.einsum("bsf,fd->bsd", h, w2) + b2

    x = A_x
    xn = _layernorm(x, axis=-1)
    s = _A_ref(xn, A_wqkv, A_wo)
    g = _silu(_B_ref(xn, B_w1, B_b1, B_w2, B_b2))
    return x + s * g
```

```asm
; @launch grid=(256,1,1) block=(512,1,1) lds=163840
.amdgcn_target "amdgcn-amd-amdhsa--gfx950"
.text
.globl recurrent_scan__mha_block__mixer_channel_mlp__prompt_kernel
.p2align 8
.type recurrent_scan__mha_block__mixer_channel_mlp__prompt_kernel,@function
recurrent_scan__mha_block__mixer_channel_mlp__prompt_kernel:

    s_cmp_ge_u32 s2, 256
    s_cbranch_scc1 M_END
    s_load_dwordx2 s[8:9], s[0:1], 0
    s_load_dwordx2 s[12:13], s[0:1], 8
    v_readfirstlane_b32 s3, v0
    s_lshr_b32 s39, s2, 3
M_CPF0:
    s_getpc_b64 s[48:49]
    v_lshl_add_u32 v1, v0, 5, s39
    v_lshlrev_b32 v1, 6, v1
    v_cmp_gt_u32 vcc, M_END - M_CPF0 - 8, v1
    s_and_saveexec_b64 s[46:47], vcc
    s_cbranch_execz M_CPF
    global_load_dword v251, v1, s[48:49]
M_CPF:
    s_mov_b64 exec, s[46:47]
    s_lshr_b32 s3, s3, 6
    v_and_b32 v0, 63, v0
    s_lshr_b32 s42, s2, 6
    s_xor_b32 s42, s42, 3
    s_and_b32 s45, s39, 7
    s_bfe_u32 s46, s2, 0x10002
    s_lshl2_add_u32 s41, s46, s42
    s_sub_u32 s44, s41, s46
    s_add_u32 s44, s44, 8
    s_bitcmp1_b32 s2, 0
    s_cselect_b32 s41, s44, s41
    s_and_b32 s44, s45, 3
    s_lshl2_add_u32 s46, s46, s44
    s_and_b32 s44, s2, 0xc1
    s_cmp_eq_u32 s44, 1
    s_cselect_b32 s45, s46, s45
    s_cselect_b32 s41, 14, s41
    s_and_b32 s40, s2, 2
    s_lshl2_add_u32 s40, s40, s45
    s_and_b32 s44, s2, 0xe1
    s_cmp_eq_u32 s44, 1
    s_cbranch_scc1 M_LIGHT
    s_and_b32 s19, s3, 3
    s_lshl2_add_u32 s48, s40, s19
    s_lshl_b32 s48, s48, 5
    v_lshrrev_b32 v20, 3, v0
    v_add_u32 v20, s48, v20
    v_mul_u32_u24 v1, 1280, v20
    v_lshrrev_b32 v21, 4, v0
    v_and_b32 v23, 7, v0
    v_xor_b32 v23, v23, v21
    v_lshl_add_u32 v1, v23, 4, v1
    v_and_b32 v23, 15, v0
    v_lshlrev_b32 v22, 1, v21
    v_xor_b32 v23, v23, v22
    v_lshlrev_b32 v24, 4, v23
    v_lshl_add_u32 v26, s19, 4, v21
    s_lshl_b32 s50, s19, 12
    s_and_b32 s48, s39, 7
    s_add_u32 s48, s48, s42
    s_lshl_b32 s48, s48, 1
    s_lshr_b32 s48, 0x124924, s48
    s_and_b32 s48, s48, 3
    s_mul_i32 s62, s48, 7
    s_lshr_b32 s62, s62, 1
    s_mov_b32 s10, 0x280000
    s_mov_b32 s11, 0x00020000
    s_cmp_lt_u32 s3, 4
    s_cbranch_scc1 P1_SETUP_A
    v_mul_u32_u24 v27, 3840, v26
    s_lshl_b32 s49, s41, 8
    v_add3_u32 v16, v27, v24, s49
    v_add_u32 v17, 14336, v16
    v_xor_b32 v25, 128, v24
    v_add3_u32 v19, v27, v25, s49
    v_add_u32 v18, 28672, v19
    v_add_u32 v19, 43008, v19
    v_xor_b32 v4, 64, v1
    v_add_u32 v2, 9216, v4
    v_add_u32 v3, 18432, v1
    v_add_u32 v4, 27648, v4
    s_mov_b32 s14, 0x258000
    s_mov_b32 s15, 0x00020000
    s_waitcnt lgkmcnt(0)
    s_add_u32 m0, s50, 16384
    s_lshl_b32 s51, s62, 7
    buffer_load_dwordx4 v1, s[8:11], s51 offen offset:0 lds
    buffer_load_dwordx4 v2, s[8:11], s51 offen offset:1024 lds
    buffer_load_dwordx4 v3, s[8:11], s51 offen offset:2048 lds
    buffer_load_dwordx4 v4, s[8:11], s51 offen offset:3072 lds
    s_add_u32 m0, s50, 98304
    s_mul_i32 s16, s62, 245760
    buffer_load_dwordx4 v16, s[12:15], s16 offen offset:0 lds
    buffer_load_dwordx4 v17, s[12:15], s16 offen offset:1024 lds
    buffer_load_dwordx4 v18, s[12:15], s16 offen offset:2048 lds
    buffer_load_dwordx4 v19, s[12:15], s16 offen offset:3072 lds
    s_add_u32 s62, s62, 1
    s_cmp_eq_u32 s62, 10
    s_cselect_b32 s62, 0, s62
    s_add_u32 m0, s50, 32768
    s_lshl_b32 s51, s62, 7
    buffer_load_dwordx4 v1, s[8:11], s51 offen offset:0 lds
    buffer_load_dwordx4 v2, s[8:11], s51 offen offset:1024 lds
    buffer_load_dwordx4 v3, s[8:11], s51 offen offset:2048 lds
    buffer_load_dwordx4 v4, s[8:11], s51 offen offset:3072 lds
    s_add_u32 m0, s50, 114688
    s_mul_i32 s16, s62, 245760
    buffer_load_dwordx4 v16, s[12:15], s16 offen offset:0 lds
    buffer_load_dwordx4 v17, s[12:15], s16 offen offset:1024 lds
    buffer_load_dwordx4 v18, s[12:15], s16 offen offset:2048 lds
    buffer_load_dwordx4 v19, s[12:15], s16 offen offset:3072 lds
    s_add_u32 s62, s62, 1
    s_cmp_eq_u32 s62, 10
    s_cselect_b32 s62, 0, s62
    s_add_u32 s60, s62, 3
    s_cmp_ge_u32 s60, 10
    s_cselect_b32 s48, 10, 0
    s_sub_u32 s60, s60, s48
    s_min_u32 s47, s41, 13
    s_branch P1_SETUP0
P1_SETUP_A:
    v_and_b32 v20, 7, v0
    v_lshlrev_b32 v20, 2, v20
    v_mov_b32 v21, 0
    ds_write_b32 v20, v21 offset:4064
    s_min_u32 s47, s41, 13
    v_xor_b32 v4, 64, v1
    v_add_u32 v2, 9216, v4
    v_add_u32 v3, 18432, v1
    v_add_u32 v4, 27648, v4
    v_mul_u32_u24 v27, 3456, v26
    s_lshl_b32 s49, s47, 8
    v_add3_u32 v16, v27, v24, s49
    v_add_u32 v17, 12800, v16
    v_xor_b32 v25, 128, v24
    v_add3_u32 v19, v27, v25, s49
    v_add_u32 v18, 25600, v19
    v_add_u32 v19, 38400, v19
    s_mov_b32 s17, s62
    s_add_u32 s62, s62, 8
    s_cmp_ge_u32 s62, 10
    s_cselect_b32 s48, 10, 0
    s_sub_u32 s62, s62, s48
    s_mov_b32 s14, 0x258000
    s_mov_b32 s15, 0x00020000
    s_cmp_eq_u32 s41, 14
    s_cselect_b32 s10, 0, s10
P1_SETUP0:
    s_load_dwordx4 s[28:31], s[0:1], 32
    s_load_dwordx4 s[32:35], s[0:1], 72
    s_lshr_b32 s43, s3, 2
    s_bfe_u32 s44, s3, 0x10001
    s_and_b32 s45, s3, 1
    s_waitcnt lgkmcnt(0)
P1_SETUP:
    s_mov_b32 s4, s28
    s_and_b32 s5, s29, 0xffff
    s_mov_b32 s6, 0x21c000
    s_mov_b32 s7, 0x00020000
    s_cmp_eq_u32 s41, 14
    s_cselect_b32 s6, 0, s6
    s_mov_b32 s20, s34
    s_and_b32 s21, s35, 0xffff
    s_mov_b32 s22, 0x2000000
    s_mov_b32 s23, 0x00020000
    s_mov_b32 s24, s30
    s_and_b32 s25, s31, 0xffff
    s_mov_b32 s26, 0xd80
    s_mov_b32 s27, 0x00020000
    s_mov_b32 s96, s32
    s_and_b32 s97, s33, 0xffff
    s_mov_b32 s98, 0x100
    s_mov_b32 s99, 0x00020000
    s_cmp_ge_u32 s41, 5
    s_cselect_b32 s55, 1, 0
    s_cmp_ge_u32 s41, 10
    s_cselect_b32 s55, 2, s55
    s_cmp_eq_u32 s43, 1
    s_cselect_b32 s55, 3, s55
    v_and_b32 v20, 15, v0
    v_lshlrev_b32 v20, 7, v20
    v_bfe_u32 v21, v0, 1, 3
    v_lshrrev_b32 v22, 4, v0
    v_xor_b32 v21, v21, v22
    v_lshl_add_u32 v20, v21, 4, v20
    s_lshl_b32 s49, s44, 13
    s_add_u32 s49, s49, 16384
    v_add_u32 v5, s49, v20
    v_xor_b32 v6, 64, v5
    v_add_u32 v14, 65536, v5
    v_add_u32 v15, 65536, v6
    v_bfe_u32 v20, v0, 2, 2
    v_lshl_add_u32 v21, v22, 3, v20
    v_lshlrev_b32 v21, 8, v21
    s_lshl_b32 s49, s45, 1
    s_or_b32 s49, s49, s44
    s_lshl_b32 s52, s49, 1
    v_bfe_u32 v20, v0, 2, 3
    v_xor_b32 v20, s52, v20
    v_lshl_add_u32 v21, v20, 5, v21
    v_and_b32 v20, 3, v0
    v_lshl_add_u32 v21, v20, 3, v21
    v_add_u32 v7, 98304, v21
    v_xor_b32 v8, 32, v7
    v_xor_b32 v9, 64, v7
    v_xor_b32 v10, 96, v7
    s_lshl_b32 s49, s49, 7
    s_lshl_b32 s52, s43, 9
    s_add_u32 s49, s49, s52
    s_add_u32 s59, s49, 1536
    v_and_b32 v20, 15, v0
    v_lshl_add_u32 v11, v20, 2, s59
    v_cmp_eq_u32 vcc, 0, v20
    v_mov_b32 v21, 0x3f803f80
    s_nop 0
    v_cndmask_b32 v28, 0, v21, vcc
    v_cndmask_b32 v29, 0, v21, vcc
    v_cndmask_b32 v30, 0, v21, vcc
    v_cndmask_b32 v31, 0, v21, vcc
    s_lshl_b32 s53, s40, 2
    s_lshl_b32 s49, s44, 1
    s_add_u32 s53, s53, s49
    s_add_u32 s54, s53, 1
    s_lshl_b32 s49, s40, 1
    s_add_u32 s49, s49, s44
    s_lshl_b32 s52, s41, 1
    s_add_u32 s52, s52, s45
    s_cmp_eq_u32 s43, 1
    s_cselect_b32 s46, s49, s52
    s_cselect_b32 s49, s52, s49
    s_lshl_b32 s46, s46, 7
    s_lshl_b32 s49, s49, 2
    s_add_u32 s46, s46, s49
    s_lshl_b32 s49, s43, 12
    s_add_u32 s46, s46, s49
    s_add_u32 s46, s46, 26214400
    s_cmp_eq_u32 s43, 1
    s_cbranch_scc1 P1_B
    s_cmp_eq_u32 s55, 2
    s_cbranch_scc1 P1_PRE_V
    v_and_b32 v102, 15, v0
    v_lshlrev_b32 v102, 4, v102
    v_bfe_u32 v103, v0, 4, 1
    v_lshrrev_b32 v20, 5, v0
    v_lshl_add_u32 v103, v103, 1, v20
    s_mul_i32 s49, s55, 5
    s_sub_u32 s49, s41, s49
    s_lshl_b32 s49, s49, 4
    s_lshl_b32 s52, s45, 3
    s_add_u32 s49, s49, s52
    s_mul_i32 s56, s55, 2097152
    s_mul_i32 s57, s55, 524288
    s_add_u32 s57, s57, 4194304
    s_xor_b32 s52, s44, 0
    s_lshl_b32 s52, s52, 2
    s_add_u32 s52, s52, s49
    v_add_u32 v20, s52, v103
    v_mul_u32_u24 v21, 52429, v20
    v_lshrrev_b32 v21, 18, v21
    v_mul_u32_u24 v22, 5, v21
    v_sub_u32 v22, v20, v22
    v_cmp_le_u32 vcc, 3, v22
    v_lshlrev_b32 v23, 17, v21
    v_lshl_add_u32 v23, v22, 9, v23
    v_add_u32 v24, 64000, v23
    v_cndmask_b32 v23, v23, v24, vcc
    v_add_u32 v23, s56, v23
    v_cmp_eq_u32 vcc, 2, v22
    v_lshlrev_b32 v24, 15, v21
    v_add_u32 v24, s57, v24
    v_mov_b32 v25, 10
    v_cndmask_b32 v23, v23, v24, vcc
    v_cndmask_b32 v25, v25, 9, vcc
    v_add_u32 v23, v23, v102
    v_lshlrev_b32 v24, v25, s53
    v_add_u32 v72, v23, v24
    v_lshlrev_b32 v24, v25, s54
    v_add_u32 v73, v23, v24
    s_xor_b32 s52, s44, 1
    s_lshl_b32 s52, s52, 2
    s_add_u32 s52, s52, s49
    v_add_u32 v20, s52, v103
    v_mul_u32_u24 v21, 52429, v20
    v_lshrrev_b32 v21, 18, v21
    v_mul_u32_u24 v22, 5, v21
    v_sub_u32 v22, v20, v22
    v_cmp_le_u32 vcc, 3, v22
    v_lshlrev_b32 v23, 17, v21
    v_lshl_add_u32 v23, v22, 9, v23
    v_add_u32 v24, 64000, v23
    v_cndmask_b32 v23, v23, v24, vcc
    v_add_u32 v23, s56, v23
    v_cmp_eq_u32 vcc, 2, v22
    v_lshlrev_b32 v24, 15, v21
    v_add_u32 v24, s57, v24
    v_mov_b32 v25, 10
    v_cndmask_b32 v23, v23, v24, vcc
    v_cndmask_b32 v25, v25, 9, vcc
    v_add_u32 v23, v23, v102
    v_lshlrev_b32 v24, v25, s53
    v_add_u32 v74, v23, v24
    v_lshlrev_b32 v24, v25, s54
    v_add_u32 v75, v23, v24
    s_branch P1_A_T
P1_PRE_V:
    s_sub_u32 s49, s41, 10
    s_lshl_b32 s49, s49, 7
    s_lshl_b32 s52, s45, 6
    s_add_u32 s49, s49, s52
    v_lshrrev_b32 v24, 5, v0
    v_mul_u32_u24 v24, 640, v24
    v_bfe_u32 v25, v0, 4, 1
    v_mul_u32_u24 v25, 320, v25
    v_add_u32 v24, v24, v25
    v_and_b32 v25, 15, v0
    s_lshl_b32 s52, s44, 1
    s_xor_b32 s52, s52, 0
    s_lshl_b32 s52, s52, 4
    s_add_u32 s52, s52, s49
    v_add_u32 v20, s52, v25
    v_mul_u32_u24 v21, 52429, v20
    v_lshrrev_b32 v21, 20, v21
    v_mul_u32_u24 v22, 81600, v21
    v_lshl_add_u32 v22, v20, 4, v22
    v_add_u32 v72, v22, v24
    s_lshl_b32 s52, s44, 1
    s_xor_b32 s52, s52, 1
    s_lshl_b32 s52, s52, 4
    s_add_u32 s52, s52, s49
    v_add_u32 v20, s52, v25
    v_mul_u32_u24 v21, 52429, v20
    v_lshrrev_b32 v21, 20, v21
    v_mul_u32_u24 v22, 81600, v21
    v_lshl_add_u32 v22, v20, 4, v22
    v_add_u32 v73, v22, v24
    s_lshl_b32 s52, s44, 1
    s_xor_b32 s52, s52, 2
    s_lshl_b32 s52, s52, 4
    s_add_u32 s52, s52, s49
    v_add_u32 v20, s52, v25
    v_mul_u32_u24 v21, 52429, v20
    v_lshrrev_b32 v21, 20, v21
    v_mul_u32_u24 v22, 81600, v21
    v_lshl_add_u32 v22, v20, 4, v22
    v_add_u32 v74, v22, v24
    s_lshl_b32 s52, s44, 1
    s_xor_b32 s52, s52, 3
    s_lshl_b32 s52, s52, 4
    s_add_u32 s52, s52, s49
    v_add_u32 v20, s52, v25
    v_mul_u32_u24 v21, 52429, v20
    v_lshrrev_b32 v21, 20, v21
    v_mul_u32_u24 v22, 81600, v21
    v_lshl_add_u32 v22, v20, 4, v22
    v_add_u32 v75, v22, v24
    s_mul_i32 s56, s53, 1280
    s_add_u32 s56, s56, 5242880
    s_mul_i32 s57, s54, 1280
    s_add_u32 s57, s57, 5242880
    s_branch P1_A_N
P1_A_N:
    s_barrier
    ds_read_b64_tr_b16 v[118:119], v7 offset:0
    ds_read_b64_tr_b16 v[120:121], v7 offset:1024
    ds_read_b128 v[86:89], v5 offset:0
    ds_read_b128 v[90:93], v5 offset:2048
    ds_read_b128 v[94:97], v5 offset:4096
    ds_read_b128 v[98:101], v5 offset:6144
    ds_read_b64_tr_b16 v[122:123], v8 offset:0
    ds_read_b64_tr_b16 v[124:125], v8 offset:1024
    ds_read_b64_tr_b16 v[126:127], v9 offset:0
    ds_read_b64_tr_b16 v[128:129], v9 offset:1024
    ds_read_b64_tr_b16 v[130:131], v10 offset:0
    ds_read_b64_tr_b16 v[132:133], v10 offset:1024
    s_waitcnt lgkmcnt(0)
    v_mfma_f32_16x16x32_bf16 v[150:153], v[86:89], v[118:121], 0
    ds_read_b64_tr_b16 v[134:135], v7 offset:8192
    v_mfma_f32_16x16x32_bf16 v[154:157], v[90:93], v[118:121], 0
    ds_read_b64_tr_b16 v[136:137], v7 offset:9216
    v_mfma_f32_16x16x32_bf16 v[158:161], v[94:97], v[118:121], 0
    ds_read_b128 v[102:105], v6 offset:0
    v_mfma_f32_16x16x32_bf16 v[162:165], v[98:101], v[118:121], 0
    ds_read_b128 v[106:109], v6 offset:2048
    v_mfma_f32_16x16x32_bf16 v[178:181], v[98:101], v[122:125], 0
    ds_read_b128 v[110:113], v6 offset:4096
    v_mfma_f32_16x16x32_bf16 v[174:177], v[94:97], v[122:125], 0
    ds_read_b128 v[114:117], v6 offset:6144
    v_mfma_f32_16x16x32_bf16 v[170:173], v[90:93], v[122:125], 0
    ds_read_b64_tr_b16 v[138:139], v8 offset:8192
    v_mfma_f32_16x16x32_bf16 v[166:169], v[86:89], v[122:125], 0
    ds_read_b64_tr_b16 v[140:141], v8 offset:9216
    v_mfma_f32_16x16x32_bf16 v[182:185], v[86:89], v[126:129], 0
    ds_read_b64_tr_b16 v[142:143], v9 offset:8192
    v_mfma_f32_16x16x32_bf16 v[186:189], v[90:93], v[126:129], 0
    ds_read_b64_tr_b16 v[144:145], v9 offset:9216
    v_mfma_f32_16x16x32_bf16 v[190:193], v[94:97], v[126:129], 0
    ds_read_b64_tr_b16 v[146:147], v10 offset:8192
    v_mfma_f32_16x16x32_bf16 v[194:197], v[98:101], v[126:129], 0
    ds_read_b64_tr_b16 v[148:149], v10 offset:9216
    v_mfma_f32_16x16x32_bf16 v[210:213], v[98:101], v[130:133], 0
    v_mfma_f32_16x16x32_bf16 v[206:209], v[94:97], v[130:133], 0
    v_mfma_f32_16x16x32_bf16 v[202:205], v[90:93], v[130:133], 0
    v_mfma_f32_16x16x32_bf16 v[198:201], v[86:89], v[130:133], 0
    v_mfma_f32_16x16x32_bf16 v[32:35], v[28:31], v[118:121], 0
    v_mfma_f32_16x16x32_bf16 v[36:39], v[28:31], v[122:125], 0
    s_waitcnt lgkmcnt(0)
    s_barrier
    v_mfma_f32_16x16x32_bf16 v[150:153], v[102:105], v[134:137], v[150:153]
    ds_read_b64_tr_b16 v[118:119], v7 offset:16384
    v_mfma_f32_16x16x32_bf16 v[154:157], v[106:109], v[134:137], v[154:157]
    ds_read_b64_tr_b16 v[120:121], v7 offset:17408
    v_mfma_f32_16x16x32_bf16 v[158:161], v[110:113], v[134:137], v[158:161]
    ds_read_b128 v[86:89], v5 offset:16384
    v_mfma_f32_16x16x32_bf16 v[162:165], v[114:117], v[134:137], v[162:165]
    ds_read_b128 v[90:93], v5 offset:18432
    v_mfma_f32_16x16x32_bf16 v[178:181], v[114:117], v[138:141], v[178:181]
    ds_read_b128 v[94:97], v5 offset:20480
    v_mfma_f32_16x16x32_bf16 v[174:177], v[110:113], v[138:141], v[174:177]
    ds_read_b128 v[98:101], v5 offset:22528
    v_mfma_f32_16x16x32_bf16 v[170:173], v[106:109], v[138:141], v[170:173]
    ds_read_b64_tr_b16 v[122:123], v8 offset:16384
    v_mfma_f32_16x16x32_bf16 v[166:169], v[102:105], v[138:141], v[166:169]
    ds_read_b64_tr_b16 v[124:125], v8 offset:17408
    v_mfma_f32_16x16x32_bf16 v[182:185], v[102:105], v[142:145], v[182:185]
    ds_read_b64_tr_b16 v[126:127], v9 offset:16384
    v_mfma_f32_16x16x32_bf16 v[186:189], v[106:109], v[142:145], v[186:189]
    ds_read_b64_tr_b16 v[128:129], v9 offset:17408
    v_mfma_f32_16x16x32_bf16 v[190:193], v[110:113], v[142:145], v[190:193]
    ds_read_b64_tr_b16 v[130:131], v10 offset:16384
    v_mfma_f32_16x16x32_bf16 v[194:197], v[114:117], v[142:145], v[194:197]
    ds_read_b64_tr_b16 v[132:133], v10 offset:17408
    v_mfma_f32_16x16x32_bf16 v[210:213], v[114:117], v[146:149], v[210:213]
    v_mfma_f32_16x16x32_bf16 v[206:209], v[110:113], v[146:149], v[206:209]
    v_mfma_f32_16x16x32_bf16 v[202:205], v[106:109], v[146:149], v[202:205]
    v_mfma_f32_16x16x32_bf16 v[198:201], v[102:105], v[146:149], v[198:201]
    v_mfma_f32_16x16x32_bf16 v[32:35], v[28:31], v[134:137], v[32:35]
    v_mfma_f32_16x16x32_bf16 v[36:39], v[28:31], v[138:141], v[36:39]
    s_waitcnt lgkmcnt(0)
    v_mfma_f32_16x16x32_bf16 v[150:153], v[86:89], v[118:121], v[150:153]
    ds_read_b64_tr_b16 v[134:135], v7 offset:24576
    v_mfma_f32_16x16x32_bf16 v[154:157], v[90:93], v[118:121], v[154:157]
    ds_read_b64_tr_b16 v[136:137], v7 offset:25600
    v_mfma_f32_16x16x32_bf16 v[158:161], v[94:97], v[118:121], v[158:161]
    ds_read_b128 v[102:105], v6 offset:16384
    v_mfma_f32_16x16x32_bf16 v[162:165], v[98:101], v[118:121], v[162:165]
    ds_read_b128 v[106:109], v6 offset:18432
    v_mfma_f32_16x16x32_bf16 v[178:181], v[98:101], v[122:125], v[178:181]
    ds_read_b128 v[110:113], v6 offset:20480
    v_mfma_f32_16x16x32_bf16 v[174:177], v[94:97], v[122:125], v[174:177]
    ds_read_b128 v[114:117], v6 offset:22528
    v_mfma_f32_16x16x32_bf16 v[170:173], v[90:93], v[122:125], v[170:173]
    ds_read_b64_tr_b16 v[138:139], v8 offset:24576
    v_mfma_f32_16x16x32_bf16 v[166:169], v[86:89], v[122:125], v[166:169]
    ds_read_b64_tr_b16 v[140:141], v8 offset:25600
    v_mfma_f32_16x16x32_bf16 v[182:185], v[86:89], v[126:129], v[182:185]
    ds_read_b64_tr_b16 v[142:143], v9 offset:24576
    v_mfma_f32_16x16x32_bf16 v[186:189], v[90:93], v[126:129], v[186:189]
    ds_read_b64_tr_b16 v[144:145], v9 offset:25600
    v_mfma_f32_16x16x32_bf16 v[190:193], v[94:97], v[126:129], v[190:193]
    ds_read_b64_tr_b16 v[146:147], v10 offset:24576
    v_mfma_f32_16x16x32_bf16 v[194:197], v[98:101], v[126:129], v[194:197]
    ds_read_b64_tr_b16 v[148:149], v10 offset:25600
    v_mfma_f32_16x16x32_bf16 v[210:213], v[98:101], v[130:133], v[210:213]
    v_mfma_f32_16x16x32_bf16 v[206:209], v[94:97], v[130:133], v[206:209]
    v_mfma_f32_16x16x32_bf16 v[202:205], v[90:93], v[130:133], v[202:205]
    v_mfma_f32_16x16x32_bf16 v[198:201], v[86:89], v[130:133], v[198:201]
    v_mfma_f32_16x16x32_bf16 v[32:35], v[28:31], v[118:121], v[32:35]
    v_mfma_f32_16x16x32_bf16 v[36:39], v[28:31], v[122:125], v[36:39]
    s_waitcnt lgkmcnt(0)
    s_barrier
    v_mfma_f32_16x16x32_bf16 v[150:153], v[102:105], v[134:137], v[150:153]
    ds_read_b64_tr_b16 v[118:119], v7 offset:32768
    v_mfma_f32_16x16x32_bf16 v[154:157], v[106:109], v[134:137], v[154:157]
    ds_read_b64_tr_b16 v[120:121], v7 offset:33792
    v_mfma_f32_16x16x32_bf16 v[158:161], v[110:113], v[134:137], v[158:161]
    ds_read_b128 v[86:89], v5 offset:32768
    v_mfma_f32_16x16x32_bf16 v[162:165], v[114:117], v[134:137], v[162:165]
    ds_read_b128 v[90:93], v5 offset:34816
    v_mfma_f32_16x16x32_bf16 v[178:181], v[114:117], v[138:141], v[178:181]
    ds_read_b128 v[94:97], v5 offset:36864
    v_mfma_f32_16x16x32_bf16 v[174:177], v[110:113], v[138:141], v[174:177]
    ds_read_b128 v[98:101], v5 offset:38912
    v_mfma_f32_16x16x32_bf16 v[170:173], v[106:109], v[138:141], v[170:173]
    ds_read_b64_tr_b16 v[122:123], v8 offset:32768
    v_mfma_f32_16x16x32_bf16 v[166:169], v[102:105], v[138:141], v[166:169]
    ds_read_b64_tr_b16 v[124:125], v8 offset:33792
    v_mfma_f32_16x16x32_bf16 v[182:185], v[102:105], v[142:145], v[182:185]
    ds_read_b64_tr_b16 v[126:127], v9 offset:32768
    v_mfma_f32_16x16x32_bf16 v[186:189], v[106:109], v[142:145], v[186:189]
    ds_read_b64_tr_b16 v[128:129], v9 offset:33792
    v_mfma_f32_16x16x32_bf16 v[190:193], v[110:113], v[142:145], v[190:193]
    ds_read_b64_tr_b16 v[130:131], v10 offset:32768
    v_mfma_f32_16x16x32_bf16 v[194:197], v[114:117], v[142:145], v[194:197]
    ds_read_b64_tr_b16 v[132:133], v10 offset:33792
    v_mfma_f32_16x16x32_bf16 v[210:213], v[114:117], v[146:149], v[210:213]
    v_mfma_f32_16x16x32_bf16 v[206:209], v[110:113], v[146:149], v[206:209]
    v_mfma_f32_16x16x32_bf16 v[202:205], v[106:109], v[146:149], v[202:205]
    v_mfma_f32_16x16x32_bf16 v[198:201], v[102:105], v[146:149], v[198:201]
    v_mfma_f32_16x16x32_bf16 v[32:35], v[28:31], v[134:137], v[32:35]
    v_mfma_f32_16x16x32_bf16 v[36:39], v[28:31], v[138:141], v[36:39]
    s_waitcnt lgkmcnt(0)
    v_mfma_f32_16x16x32_bf16 v[150:153], v[86:89], v[118:121], v[150:153]
    ds_read_b64_tr_b16 v[134:135], v7 offset:40960
    v_mfma_f32_16x16x32_bf16 v[154:157], v[90:93], v[118:121], v[154:157]
    ds_read_b64_tr_b16 v[136:137], v7 offset:41984
    v_mfma_f32_16x16x32_bf16 v[158:161], v[94:97], v[118:121], v[158:161]
    ds_read_b128 v[102:105], v6 offset:32768
    v_mfma_f32_16x16x32_bf16 v[162:165], v[98:101], v[118:121], v[162:165]
    ds_read_b128 v[106:109], v6 offset:34816
    v_mfma_f32_16x16x32_bf16 v[178:181], v[98:101], v[122:125], v[178:181]
    ds_read_b128 v[110:113], v6 offset:36864
    v_mfma_f32_16x16x32_bf16 v[174:177], v[94:97], v[122:125], v[174:177]
    ds_read_b128 v[114:117], v6 offset:38912
    v_mfma_f32_16x16x32_bf16 v[170:173], v[90:93], v[122:125], v[170:173]
    ds_read_b64_tr_b16 v[138:139], v8 offset:40960
    v_mfma_f32_16x16x32_bf16 v[166:169], v[86:89], v[122:125], v[166:169]
    ds_read_b64_tr_b16 v[140:141], v8 offset:41984
    v_mfma_f32_16x16x32_bf16 v[182:185], v[86:89], v[126:129], v[182:185]
    ds_read_b64_tr_b16 v[142:143], v9 offset:40960
    v_mfma_f32_16x16x32_bf16 v[186:189], v[90:93], v[126:129], v[186:189]
    ds_read_b64_tr_b16 v[144:145], v9 offset:41984
    v_mfma_f32_16x16x32_bf16 v[190:193], v[94:97], v[126:129], v[190:193]
    ds_read_b64_tr_b16 v[146:147], v10 offset:40960
    v_mfma_f32_16x16x32_bf16 v[194:197], v[98:101], v[126:129], v[194:197]
    ds_read_b64_tr_b16 v[148:149], v10 offset:41984
    v_mfma_f32_16x16x32_bf16 v[210:213], v[98:101], v[130:133], v[210:213]
    v_mfma_f32_16x16x32_bf16 v[206:209], v[94:97], v[130:133], v[206:209]
    v_mfma_f32_16x16x32_bf16 v[202:205], v[90:93], v[130:133], v[202:205]
    v_mfma_f32_16x16x32_bf16 v[198:201], v[86:89], v[130:133], v[198:201]
    v_mfma_f32_16x16x32_bf16 v[32:35], v[28:31], v[118:121], v[32:35]
    v_mfma_f32_16x16x32_bf16 v[36:39], v[28:31], v[122:125], v[36:39]
    s_waitcnt lgkmcnt(0)
    s_barrier
    v_mfma_f32_16x16x32_bf16 v[150:153], v[102:105], v[134:137], v[150:153]
    ds_read_b64_tr_b16 v[118:119], v7 offset:49152
    v_mfma_f32_16x16x32_bf16 v[154:157], v[106:109], v[134:137], v[154:157]
    ds_read_b64_tr_b16 v[120:121], v7 offset:50176
    v_mfma_f32_16x16x32_bf16 v[158:161], v[110:113], v[134:137], v[158:161]
    ds_read_b128 v[86:89], v5 offset:49152
    v_mfma_f32_16x16x32_bf16 v[162:165], v[114:117], v[134:137], v[162:165]
    ds_read_b128 v[90:93], v5 offset:51200
    v_mfma_f32_16x16x32_bf16 v[178:181], v[114:117], v[138:141], v[178:181]
    ds_read_b128 v[94:97], v5 offset:53248
    v_mfma_f32_16x16x32_bf16 v[174:177], v[110:113], v[138:141], v[174:177]
    ds_read_b128 v[98:101], v5 offset:55296
    v_mfma_f32_16x16x32_bf16 v[170:173], v[106:109], v[138:141], v[170:173]
    ds_read_b64_tr_b16 v[122:123], v8 offset:49152
    v_mfma_f32_16x16x32_bf16 v[166:169], v[102:105], v[138:141], v[166:169]
    ds_read_b64_tr_b16 v[124:125], v8 offset:50176
    v_mfma_f32_16x16x32_bf16 v[182:185], v[102:105], v[142:145], v[182:185]
    ds_read_b64_tr_b16 v[126:127], v9 offset:49152
    v_mfma_f32_16x16x32_bf16 v[186:189], v[106:109], v[142:145], v[186:189]
    ds_read_b64_tr_b16 v[128:129], v9 offset:50176
    v_mfma_f32_16x16x32_bf16 v[190:193], v[110:113], v[142:145], v[190:193]
    ds_read_b64_tr_b16 v[130:131], v10 offset:49152
    v_mfma_f32_16x16x32_bf16 v[194:197], v[114:117], v[142:145], v[194:197]
    ds_read_b64_tr_b16 v[132:133], v10 offset:50176
    v_mfma_f32_16x16x32_bf16 v[210:213], v[114:117], v[146:149], v[210:213]
    v_mfma_f32_16x16x32_bf16 v[206:209], v[110:113], v[146:149], v[206:209]
    v_mfma_f32_16x16x32_bf16 v[202:205], v[106:109], v[146:149], v[202:205]
    v_mfma_f32_16x16x32_bf16 v[198:201], v[102:105], v[146:149], v[198:201]
    v_mfma_f32_16x16x32_bf16 v[32:35], v[28:31], v[134:137], v[32:35]
    v_mfma_f32_16x16x32_bf16 v[36:39], v[28:31], v[138:141], v[36:39]
    s_waitcnt lgkmcnt(0)
    v_mfma_f32_16x16x32_bf16 v[150:153], v[86:89], v[118:121], v[150:153]
    ds_read_b64_tr_b16 v[134:135], v7 offset:57344
    v_mfma_f32_16x16x32_bf16 v[154:157], v[90:93], v[118:121], v[154:157]
    ds_read_b64_tr_b16 v[136:137], v7 offset:58368
    v_mfma_f32_16x16x32_bf16 v[158:161], v[94:97], v[118:121], v[158:161]
    ds_read_b128 v[102:105], v6 offset:49152
    v_mfma_f32_16x16x32_bf16 v[162:165], v[98:101], v[118:121], v[162:165]
    ds_read_b128 v[106:109], v6 offset:51200
    v_mfma_f32_16x16x32_bf16 v[178:181], v[98:101], v[122:125], v[178:181]
    ds_read_b128 v[110:113], v6 offset:53248
    v_mfma_f32_16x16x32_bf16 v[174:177], v[94:97], v[122:125], v[174:177]
    ds_read_b128 v[114:117], v6 offset:55296
    v_mfma_f32_16x16x32_bf16 v[170:173], v[90:93], v[122:125], v[170:173]
    ds_read_b64_tr_b16 v[138:139], v8 offset:57344
    v_mfma_f32_16x16x32_bf16 v[166:169], v[86:89], v[122:125], v[166:169]
    ds_read_b64_tr_b16 v[140:141], v8 offset:58368
    v_mfma_f32_16x16x32_bf16 v[182:185], v[86:89], v[126:129], v[182:185]
    ds_read_b64_tr_b16 v[142:143], v9 offset:57344
    v_mfma_f32_16x16x32_bf16 v[186:189], v[90:93], v[126:129], v[186:189]
    ds_read_b64_tr_b16 v[144:145], v9 offset:58368
    v_mfma_f32_16x16x32_bf16 v[190:193], v[94:97], v[126:129], v[190:193]
    ds_read_b64_tr_b16 v[146:147], v10 offset:57344
    v_mfma_f32_16x16x32_bf16 v[194:197], v[98:101], v[126:129], v[194:197]
    ds_read_b64_tr_b16 v[148:149], v10 offset:58368
    v_mfma_f32_16x16x32_bf16 v[210:213], v[98:101], v[130:133], v[210:213]
    v_mfma_f32_16x16x32_bf16 v[206:209], v[94:97], v[130:133], v[206:209]
    v_mfma_f32_16x16x32_bf16 v[202:205], v[90:93], v[130:133], v[202:205]
    v_mfma_f32_16x16x32_bf16 v[198:201], v[86:89], v[130:133], v[198:201]
    v_mfma_f32_16x16x32_bf16 v[32:35], v[28:31], v[118:121], v[32:35]
    v_mfma_f32_16x16x32_bf16 v[36:39], v[28:31], v[122:125], v[36:39]
    s_waitcnt lgkmcnt(0)
    s_barrier
    v_mfma_f32_16x16x32_bf16 v[150:153], v[102:105], v[134:137], v[150:153]
    ds_read_b64_tr_b16 v[118:119], v7 offset:0
    v_mfma_f32_16x16x32_bf16 v[154:157], v[106:109], v[134:137], v[154:157]
    ds_read_b64_tr_b16 v[120:121], v7 offset:1024
    v_mfma_f32_16x16x32_bf16 v[158:161], v[110:113], v[134:137], v[158:161]
    ds_read_b128 v[86:89], v14 offset:0
    v_mfma_f32_16x16x32_bf16 v[162:165], v[114:117], v[134:137], v[162:165]
    ds_read_b128 v[90:93], v14 offset:2048
    v_mfma_f32_16x16x32_bf16 v[178:181], v[114:117], v[138:141], v[178:181]
    ds_read_b128 v[94:97], v14 offset:4096
    v_mfma_f32_16x16x32_bf16 v[174:177], v[110:113], v[138:141], v[174:177]
    ds_read_b128 v[98:101], v14 offset:6144
    v_mfma_f32_16x16x32_bf16 v[170:173], v[106:109], v[138:141], v[170:173]
    ds_read_b64_tr_b16 v[122:123], v8 offset:0
    v_mfma_f32_16x16x32_bf16 v[166:169], v[102:105], v[138:141], v[166:169]
    ds_read_b64_tr_b16 v[124:125], v8 offset:1024
    v_mfma_f32_16x16x32_bf16 v[182:185], v[102:105], v[142:145], v[182:185]
    ds_read_b64_tr_b16 v[126:127], v9 offset:0
    v_mfma_f32_16x16x32_bf16 v[186:189], v[106:109], v[142:145], v[186:189]
    ds_read_b64_tr_b16 v[128:129], v9 offset:1024
    v_mfma_f32_16x16x32_bf16 v[190:193], v[110:113], v[142:145], v[190:193]
    ds_read_b64_tr_b16 v[130:131], v10 offset:0
    v_mfma_f32_16x16x32_bf16 v[194:197], v[114:117], v[142:145], v[194:197]
    ds_read_b64_tr_b16 v[132:133], v10 offset:1024
    v_mfma_f32_16x16x32_bf16 v[210:213], v[114:117], v[146:149], v[210:213]
    v_mfma_f32_16x16x32_bf16 v[206:209], v[110:113], v[146:149], v[206:209]
    v_mfma_f32_16x16x32_bf16 v[202:205], v[106:109], v[146:149], v[202:205]
    v_mfma_f32_16x16x32_bf16 v[198:201], v[102:105], v[146:149], v[198:201]
    v_mfma_f32_16x16x32_bf16 v[32:35], v[28:31], v[134:137], v[32:35]
    v_mfma_f32_16x16x32_bf16 v[36:39], v[28:31], v[138:141], v[36:39]
    s_waitcnt lgkmcnt(0)
    v_mfma_f32_16x16x32_bf16 v[150:153], v[86:89], v[118:121], v[150:153]
    ds_read_b64_tr_b16 v[134:135], v7 offset:8192
    v_mfma_f32_16x16x32_bf16 v[154:157], v[90:93], v[118:121], v[154:157]
    ds_read_b64_tr_b16 v[136:137], v7 offset:9216
    v_mfma_f32_16x16x32_bf16 v[158:161], v[94:97], v[118:121], v[158:161]
    ds_read_b128 v[102:105], v15 offset:0
    v_mfma_f32_16x16x32_bf16 v[162:165], v[98:101], v[118:121], v[162:165]
    ds_read_b128 v[106:109], v15 offset:2048
    v_mfma_f32_16x16x32_bf16 v[178:181], v[98:101], v[122:125], v[178:181]
    ds_read_b128 v[110:113], v15 offset:4096
    v_mfma_f32_16x16x32_bf16 v[174:177], v[94:97], v[122:125], v[174:177]
    ds_read_b128 v[114:117], v15 offset:6144
    v_mfma_f32_16x16x32_bf16 v[170:173], v[90:93], v[122:125], v[170:173]
    ds_read_b64_tr_b16 v[138:139], v8 offset:8192
    v_mfma_f32_16x16x32_bf16 v[166:169], v[86:89], v[122:125], v[166:169]
    ds_read_b64_tr_b16 v[140:141], v8 offset:9216
    v_mfma_f32_16x16x32_bf16 v[182:185], v[86:89], v[126:129], v[182:185]
    ds_read_b64_tr_b16 v[142:143], v9 offset:8192
    v_mfma_f32_16x16x32_bf16 v[186:189], v[90:93], v[126:129], v[186:189]
    ds_read_b64_tr_b16 v[144:145], v9 offset:9216
    v_mfma_f32_16x16x32_bf16 v[190:193], v[94:97], v[126:129], v[190:193]
    ds_read_b64_tr_b16 v[146:147], v10 offset:8192
    v_mfma_f32_16x16x32_bf16 v[194:197], v[98:101], v[126:129], v[194:197]
    ds_read_b64_tr_b16 v[148:149], v10 offset:9216
    v_mfma_f32_16x16x32_bf16 v[210:213], v[98:101], v[130:133], v[210:213]
    v_mfma_f32_16x16x32_bf16 v[206:209], v[94:97], v[130:133], v[206:209]
    v_mfma_f32_16x16x32_bf16 v[202:205], v[90:93], v[130:133], v[202:205]
    v_mfma_f32_16x16x32_bf16 v[198:201], v[86:89], v[130:133], v[198:201]
    v_mfma_f32_16x16x32_bf16 v[32:35], v[28:31], v[118:121], v[32:35]
    v_mfma_f32_16x16x32_bf16 v[36:39], v[28:31], v[122:125], v[36:39]
    s_waitcnt lgkmcnt(0)
    s_barrier
    v_mfma_f32_16x16x32_bf16 v[150:153], v[102:105], v[134:137], v[150:153]
    ds_read_b64_tr_b16 v[118:119], v7 offset:16384
    v_mfma_f32_16x16x32_bf16 v[154:157], v[106:109], v[134:137], v[154:157]
    ds_read_b64_tr_b16 v[120:121], v7 offset:17408
    v_mfma_f32_16x16x32_bf16 v[158:161], v[110:113], v[134:137], v[158:161]
    ds_read_b128 v[86:89], v5 offset:0
    v_mfma_f32_16x16x32_bf16 v[162:165], v[114:117], v[134:137], v[162:165]
    ds_read_b128 v[90:93], v5 offset:2048
    v_mfma_f32_16x16x32_bf16 v[178:181], v[114:117], v[138:141], v[178:181]
    ds_read_b128 v[94:97], v5 offset:4096
    v_mfma_f32_16x16x32_bf16 v[174:177], v[110:113], v[138:141], v[174:177]
    ds_read_b128 v[98:101], v5 offset:6144
    v_mfma_f32_16x16x32_bf16 v[170:173], v[106:109], v[138:141], v[170:173]
    ds_read_b64_tr_b16 v[122:123], v8 offset:16384
    v_mfma_f32_16x16x32_bf16 v[166:169], v[102:105], v[138:141], v[166:169]
    ds_read_b64_tr_b16 v[124:125], v8 offset:17408
    v_mfma_f32_16x16x32_bf16 v[182:185], v[102:105], v[142:145], v[182:185]
    ds_read_b64_tr_b16 v[126:127], v9 offset:16384
    v_mfma_f32_16x16x32_bf16 v[186:189], v[106:109], v[142:145], v[186:189]
    ds_read_b64_tr_b16 v[128:129], v9 offset:17408
    v_mfma_f32_16x16x32_bf16 v[190:193], v[110:113], v[142:145], v[190:193]
    ds_read_b64_tr_b16 v[130:131], v10 offset:16384
    v_mfma_f32_16x16x32_bf16 v[194:197], v[114:117], v[142:145], v[194:197]
    ds_read_b64_tr_b16 v[132:133], v10 offset:17408
    v_mfma_f32_16x16x32_bf16 v[210:213], v[114:117], v[146:149], v[210:213]
    v_mfma_f32_16x16x32_bf16 v[206:209], v[110:113], v[146:149], v[206:209]
    v_mfma_f32_16x16x32_bf16 v[202:205], v[106:109], v[146:149], v[202:205]
    v_mfma_f32_16x16x32_bf16 v[198:201], v[102:105], v[146:149], v[198:201]
    v_mfma_f32_16x16x32_bf16 v[32:35], v[28:31], v[134:137], v[32:35]
    v_mfma_f32_16x16x32_bf16 v[36:39], v[28:31], v[138:141], v[36:39]
    s_waitcnt lgkmcnt(0)
    v_mfma_f32_16x16x32_bf16 v[150:153], v[86:89], v[118:121], v[150:153]
    ds_read_b64_tr_b16 v[134:135], v7 offset:24576
    v_mfma_f32_16x16x32_bf16 v[154:157], v[90:93], v[118:121], v[154:157]
    ds_read_b64_tr_b16 v[136:137], v7 offset:25600
    v_mfma_f32_16x16x32_bf16 v[158:161], v[94:97], v[118:121], v[158:161]
    ds_read_b128 v[102:105], v6 offset:0
    v_mfma_f32_16x16x32_bf16 v[162:165], v[98:101], v[118:121], v[162:165]
    ds_read_b128 v[106:109], v6 offset:2048
    v_mfma_f32_16x16x32_bf16 v[178:181], v[98:101], v[122:125], v[178:181]
    ds_read_b128 v[110:113], v6 offset:4096
    v_mfma_f32_16x16x32_bf16 v[174:177], v[94:97], v[122:125], v[174:177]
    ds_read_b128 v[114:117], v6 offset:6144
    v_mfma_f32_16x16x32_bf16 v[170:173], v[90:93], v[122:125], v[170:173]
    ds_read_b64_tr_b16 v[138:139], v8 offset:24576
    v_mfma_f32_16x16x32_bf16 v[166:169], v[86:89], v[122:125], v[166:169]
    ds_read_b64_tr_b16 v[140:141], v8 offset:25600
    v_mfma_f32_16x16x32_bf16 v[182:185], v[86:89], v[126:129], v[182:185]
    ds_read_b64_tr_b16 v[142:143], v9 offset:24576
    v_mfma_f32_16x16x32_bf16 v[186:189], v[90:93], v[126:129], v[186:189]
    ds_read_b64_tr_b16 v[144:145], v9 offset:25600
    v_mfma_f32_16x16x32_bf16 v[190:193], v[94:97], v[126:129], v[190:193]
    ds_read_b64_tr_b16 v[146:147], v10 offset:24576
    v_mfma_f32_16x16x32_bf16 v[194:197], v[98:101], v[126:129], v[194:197]
    ds_read_b64_tr_b16 v[148:149], v10 offset:25600
    v_mfma_f32_16x16x32_bf16 v[210:213], v[98:101], v[130:133], v[210:213]
    v_mfma_f32_16x16x32_bf16 v[206:209], v[94:97], v[130:133], v[206:209]
    v_mfma_f32_16x16x32_bf16 v[202:205], v[90:93], v[130:133], v[202:205]
    v_mfma_f32_16x16x32_bf16 v[198:201], v[86:89], v[130:133], v[198:201]
    v_mfma_f32_16x16x32_bf16 v[32:35], v[28:31], v[118:121], v[32:35]
    v_mfma_f32_16x16x32_bf16 v[36:39], v[28:31], v[122:125], v[36:39]
    s_waitcnt lgkmcnt(0)
    s_barrier
    v_mfma_f32_16x16x32_bf16 v[150:153], v[102:105], v[134:137], v[150:153]
    ds_read_b64_tr_b16 v[118:119], v7 offset:32768
    v_mfma_f32_16x16x32_bf16 v[154:157], v[106:109], v[134:137], v[154:157]
    ds_read_b64_tr_b16 v[120:121], v7 offset:33792
    v_mfma_f32_16x16x32_bf16 v[158:161], v[110:113], v[134:137], v[158:161]
    ds_read_b128 v[86:89], v5 offset:16384
    v_mfma_f32_16x16x32_bf16 v[162:165], v[114:117], v[134:137], v[162:165]
    ds_read_b128 v[90:93], v5 offset:18432
    v_mfma_f32_16x16x32_bf16 v[178:181], v[114:117], v[138:141], v[178:181]
    ds_read_b128 v[94:97], v5 offset:20480
    v_mfma_f32_16x16x32_bf16 v[174:177], v[110:113], v[138:141], v[174:177]
    ds_read_b128 v[98:101], v5 offset:22528
    v_mfma_f32_16x16x32_bf16 v[170:173], v[106:109], v[138:141], v[170:173]
    ds_read_b64_tr_b16 v[122:123], v8 offset:32768
    v_mfma_f32_16x16x32_bf16 v[166:169], v[102:105], v[138:141], v[166:169]
    ds_read_b64_tr_b16 v[124:125], v8 offset:33792
    v_mfma_f32_16x16x32_bf16 v[182:185], v[102:105], v[142:145], v[182:185]
    ds_read_b64_tr_b16 v[126:127], v9 offset:32768
    v_mfma_f32_16x16x32_bf16 v[186:189], v[106:109], v[142:145], v[186:189]
    ds_read_b64_tr_b16 v[128:129], v9 offset:33792
    v_mfma_f32_16x16x32_bf16 v[190:193], v[110:113], v[142:145], v[190:193]
    ds_read_b64_tr_b16 v[130:131], v10 offset:32768
    v_mfma_f32_16x16x32_bf16 v[194:197], v[114:117], v[142:145], v[194:197]
    ds_read_b64_tr_b16 v[132:133], v10 offset:33792
    v_mfma_f32_16x16x32_bf16 v[210:213], v[114:117], v[146:149], v[210:213]
    v_mfma_f32_16x16x32_bf16 v[206:209], v[110:113], v[146:149], v[206:209]
    v_mfma_f32_16x16x32_bf16 v[202:205], v[106:109], v[146:149], v[202:205]
    v_mfma_f32_16x16x32_bf16 v[198:201], v[102:105], v[146:149], v[198:201]
    v_mfma_f32_16x16x32_bf16 v[32:35], v[28:31], v[134:137], v[32:35]
    v_mfma_f32_16x16x32_bf16 v[36:39], v[28:31], v[138:141], v[36:39]
    s_waitcnt lgkmcnt(0)
    v_mfma_f32_16x16x32_bf16 v[150:153], v[86:89], v[118:121], v[150:153]
    ds_read_b64_tr_b16 v[134:135], v7 offset:40960
    v_mfma_f32_16x16x32_bf16 v[154:157], v[90:93], v[118:121], v[154:157]
    ds_read_b64_tr_b16 v[136:137], v7 offset:41984
    v_mfma_f32_16x16x32_bf16 v[158:161], v[94:97], v[118:121], v[158:161]
    ds_read_b128 v[102:105], v6 offset:16384
    v_mfma_f32_16x16x32_bf16 v[162:165], v[98:101], v[118:121], v[162:165]
    ds_read_b128 v[106:109], v6 offset:18432
    v_mfma_f32_16x16x32_bf16 v[178:181], v[98:101], v[122:125], v[178:181]
    ds_read_b128 v[110:113], v6 offset:20480
    v_mfma_f32_16x16x32_bf16 v[174:177], v[94:97], v[122:125], v[174:177]
    ds_read_b128 v[114:117], v6 offset:22528
    v_mfma_f32_16x16x32_bf16 v[170:173], v[90:93], v[122:125], v[170:173]
    ds_read_b64_tr_b16 v[138:139], v8 offset:40960
    v_mfma_f32_16x16x32_bf16 v[166:169], v[86:89], v[122:125], v[166:169]
    ds_read_b64_tr_b16 v[140:141], v8 offset:41984
    v_mfma_f32_16x16x32_bf16 v[182:185], v[86:89], v[126:129], v[182:185]
    ds_read_b64_tr_b16 v[142:143], v9 offset:40960
    v_mfma_f32_16x16x32_bf16 v[186:189], v[90:93], v[126:129], v[186:189]
    ds_read_b64_tr_b16 v[144:145], v9 offset:41984
    v_mfma_f32_16x16x32_bf16 v[190:193], v[94:97], v[126:129], v[190:193]
    ds_read_b64_tr_b16 v[146:147], v10 offset:40960
    v_mfma_f32_16x16x32_bf16 v[194:197], v[98:101], v[126:129], v[194:197]
    ds_read_b64_tr_b16 v[148:149], v10 offset:41984
    v_mfma_f32_16x16x32_bf16 v[210:213], v[98:101], v[130:133], v[210:213]
    v_mfma_f32_16x16x32_bf16 v[206:209], v[94:97], v[130:133], v[206:209]
    v_mfma_f32_16x16x32_bf16 v[202:205], v[90:93], v[130:133], v[202:205]
    v_mfma_f32_16x16x32_bf16 v[198:201], v[86:89], v[130:133], v[198:201]
    v_mfma_f32_16x16x32_bf16 v[32:35], v[28:31], v[118:121], v[32:35]
    v_mfma_f32_16x16x32_bf16 v[36:39], v[28:31], v[122:125], v[36:39]
    s_waitcnt lgkmcnt(0)
    s_barrier
    v_mfma_f32_16x16x32_bf16 v[150:153], v[102:105], v[134:137], v[150:153]
    ds_read_b64_tr_b16 v[118:119], v7 offset:49152
    v_mfma_f32_16x16x32_bf16 v[154:157], v[106:109], v[134:137], v[154:157]
    ds_read_b64_tr_b16 v[120:121], v7 offset:50176
    v_mfma_f32_16x16x32_bf16 v[158:161], v[110:113], v[134:137], v[158:161]
    ds_read_b128 v[86:89], v5 offset:32768
    v_mfma_f32_16x16x32_bf16 v[162:165], v[114:117], v[134:137], v[162:165]
    ds_read_b128 v[90:93], v5 offset:34816
    v_mfma_f32_16x16x32_bf16 v[178:181], v[114:117], v[138:141], v[178:181]
    ds_read_b128 v[94:97], v5 offset:36864
    v_mfma_f32_16x16x32_bf16 v[174:177], v[110:113], v[138:141], v[174:177]
    ds_read_b128 v[98:101], v5 offset:38912
    v_mfma_f32_16x16x32_bf16 v[170:173], v[106:109], v[138:141], v[170:173]
    ds_read_b64_tr_b16 v[122:123], v8 offset:49152
    v_mfma_f32_16x16x32_bf16 v[166:169], v[102:105], v[138:141], v[166:169]
    ds_read_b64_tr_b16 v[124:125], v8 offset:50176
    v_mfma_f32_16x16x32_bf16 v[182:185], v[102:105], v[142:145], v[182:185]
    ds_read_b64_tr_b16 v[126:127], v9 offset:49152
    v_mfma_f32_16x16x32_bf16 v[186:189], v[106:109], v[142:145], v[186:189]
    ds_read_b64_tr_b16 v[128:129], v9 offset:50176
    v_mfma_f32_16x16x32_bf16 v[190:193], v[110:113], v[142:145], v[190:193]
    ds_read_b64_tr_b16 v[130:131], v10 offset:49152
    v_mfma_f32_16x16x32_bf16 v[194:197], v[114:117], v[142:145], v[194:197]
    ds_read_b64_tr_b16 v[132:133], v10 offset:50176
    v_mfma_f32_16x16x32_bf16 v[210:213], v[114:117], v[146:149], v[210:213]
    v_mfma_f32_16x16x32_bf16 v[206:209], v[110:113], v[146:149], v[206:209]
    v_mfma_f32_16x16x32_bf16 v[202:205], v[106:109], v[146:149], v[202:205]
    v_mfma_f32_16x16x32_bf16 v[198:201], v[102:105], v[146:149], v[198:201]
    v_mfma_f32_16x16x32_bf16 v[32:35], v[28:31], v[134:137], v[32:35]
    v_mfma_f32_16x16x32_bf16 v[36:39], v[28:31], v[138:141], v[36:39]
    s_waitcnt lgkmcnt(0)
    v_mfma_f32_16x16x32_bf16 v[150:153], v[86:89], v[118:121], v[150:153]
    ds_read_b64_tr_b16 v[134:135], v7 offset:57344
    v_mfma_f32_16x16x32_bf16 v[154:157], v[90:93], v[118:121], v[154:157]
    ds_read_b64_tr_b16 v[136:137], v7 offset:58368
    v_mfma_f32_16x16x32_bf16 v[158:161], v[94:97], v[118:121], v[158:161]
    ds_read_b128 v[102:105], v6 offset:32768
    v_mfma_f32_16x16x32_bf16 v[162:165], v[98:101], v[118:121], v[162:165]
    ds_read_b128 v[106:109], v6 offset:34816
    v_mfma_f32_16x16x32_bf16 v[178:181], v[98:101], v[122:125], v[178:181]
    ds_read_b128 v[110:113], v6 offset:36864
    v_mfma_f32_16x16x32_bf16 v[174:177], v[94:97], v[122:125], v[174:177]
    ds_read_b128 v[114:117], v6 offset:38912
    v_mfma_f32_16x16x32_bf16 v[170:173], v[90:93], v[122:125], v[170:173]
    ds_read_b64_tr_b16 v[138:139], v8 offset:57344
    v_mfma_f32_16x16x32_bf16 v[166:169], v[86:89], v[122:125], v[166:169]
    ds_read_b64_tr_b16 v[140:141], v8 offset:58368
    v_mfma_f32_16x16x32_bf16 v[182:185], v[86:89], v[126:129], v[182:185]
    ds_read_b64_tr_b16 v[142:143], v9 offset:57344
    v_mfma_f32_16x16x32_bf16 v[186:189], v[90:93], v[126:129], v[186:189]
    ds_read_b64_tr_b16 v[144:145], v9 offset:58368
    v_mfma_f32_16x16x32_bf16 v[190:193], v[94:97], v[126:129], v[190:193]
    ds_read_b64_tr_b16 v[146:147], v10 offset:57344
    v_mfma_f32_16x16x32_bf16 v[194:197], v[98:101], v[126:129], v[194:197]
    ds_read_b64_tr_b16 v[148:149], v10 offset:58368
    v_mfma_f32_16x16x32_bf16 v[210:213], v[98:101], v[130:133], v[210:213]
    v_mfma_f32_16x16x32_bf16 v[206:209], v[94:97], v[130:133], v[206:209]
    v_mfma_f32_16x16x32_bf16 v[202:205], v[90:93], v[130:133], v[202:205]
    v_mfma_f32_16x16x32_bf16 v[198:201], v[86:89], v[130:133], v[198:201]
    v_mfma_f32_16x16x32_bf16 v[32:35], v[28:31], v[118:121], v[32:35]
    v_mfma_f32_16x16x32_bf16 v[36:39], v[28:31], v[122:125], v[36:39]
    s_waitcnt lgkmcnt(0)
    s_barrier
    v_mfma_f32_16x16x32_bf16 v[150:153], v[102:105], v[134:137], v[150:153]
    ds_read_b64_tr_b16 v[118:119], v7 offset:0
    v_mfma_f32_16x16x32_bf16 v[154:157], v[106:109], v[134:137], v[154:157]
    ds_read_b64_tr_b16 v[120:121], v7 offset:1024
    v_mfma_f32_16x16x32_bf16 v[158:161], v[110:113], v[134:137], v[158:161]
    ds_read_b128 v[86:89], v5 offset:49152
    v_mfma_f32_16x16x32_bf16 v[162:165], v[114:117], v[134:137], v[162:165]
    ds_read_b128 v[90:93], v5 offset:51200
    v_mfma_f32_16x16x32_bf16 v[178:181], v[114:117], v[138:141], v[178:181]
    ds_read_b128 v[94:97], v5 offset:53248
    v_mfma_f32_16x16x32_bf16 v[174:177], v[110:113], v[138:141], v[174:177]
    ds_read_b128 v[98:101], v5 offset:55296
    v_mfma_f32_16x16x32_bf16 v[170:173], v[106:109], v[138:141], v[170:173]
    ds_read_b64_tr_b16 v[122:123], v8 offset:0
    v_mfma_f32_16x16x32_bf16 v[166:169], v[102:105], v[138:141], v[166:169]
    ds_read_b64_tr_b16 v[124:125], v8 offset:1024
    v_mfma_f32_16x16x32_bf16 v[182:185], v[102:105], v[142:145], v[182:185]
    ds_read_b64_tr_b16 v[126:127], v9 offset:0
    v_mfma_f32_16x16x32_bf16 v[186:189], v[106:109], v[142:145], v[186:189]
    ds_read_b64_tr_b16 v[128:129], v9 offset:1024
    v_mfma_f32_16x16x32_bf16 v[190:193], v[110:113], v[142:145], v[190:193]
    ds_read_b64_tr_b16 v[130:131], v10 offset:0
    v_mfma_f32_16x16x32_bf16 v[194:197], v[114:117], v[142:145], v[194:197]
    ds_read_b64_tr_b16 v[132:133], v10 offset:1024
    v_mfma_f32_16x16x32_bf16 v[210:213], v[114:117], v[146:149], v[210:213]
    v_mfma_f32_16x16x32_bf16 v[206:209], v[110:113], v[146:149], v[206:209]
    v_mfma_f32_16x16x32_bf16 v[202:205], v[106:109], v[146:149], v[202:205]
    v_mfma_f32_16x16x32_bf16 v[198:201], v[102:105], v[146:149], v[198:201]
    v_mfma_f32_16x16x32_bf16 v[32:35], v[28:31], v[134:137], v[32:35]
    v_mfma_f32_16x16x32_bf16 v[36:39], v[28:31], v[138:141], v[36:39]
    s_waitcnt lgkmcnt(0)
    v_mfma_f32_16x16x32_bf16 v[150:153], v[86:89], v[118:121], v[150:153]
    ds_read_b64_tr_b16 v[134:135], v7 offset:8192
    v_mfma_f32_16x16x32_bf16 v[154:157], v[90:93], v[118:121], v[154:157]
    ds_read_b64_tr_b16 v[136:137], v7 offset:9216
    v_mfma_f32_16x16x32_bf16 v[158:161], v[94:97], v[118:121], v[158:161]
    ds_read_b128 v[102:105], v6 offset:49152
    v_mfma_f32_16x16x32_bf16 v[162:165], v[98:101], v[118:121], v[162:165]
    ds_read_b128 v[106:109], v6 offset:51200
    v_mfma_f32_16x16x32_bf16 v[178:181], v[98:101], v[122:125], v[178:181]
    ds_read_b128 v[110:113], v6 offset:53248
    v_mfma_f32_16x16x32_bf16 v[174:177], v[94:97], v[122:125], v[174:177]
    ds_read_b128 v[114:117], v6 offset:55296
    v_mfma_f32_16x16x32_bf16 v[170:173], v[90:93], v[122:125], v[170:173]
    ds_read_b64_tr_b16 v[138:139], v8 offset:8192
    v_mfma_f32_16x16x32_bf16 v[166:169], v[86:89], v[122:125], v[166:169]
    ds_read_b64_tr_b16 v[140:141], v8 offset:9216
    v_mfma_f32_16x16x32_bf16 v[182:185], v[86:89], v[126:129], v[182:185]
    ds_read_b64_tr_b16 v[142:143], v9 offset:8192
    v_mfma_f32_16x16x32_bf16 v[186:189], v[90:93], v[126:129], v[186:189]
    ds_read_b64_tr_b16 v[144:145], v9 offset:9216
    v_mfma_f32_16x16x32_bf16 v[190:193], v[94:97], v[126:129], v[190:193]
    ds_read_b64_tr_b16 v[146:147], v10 offset:8192
    v_mfma_f32_16x16x32_bf16 v[194:197], v[98:101], v[126:129], v[194:197]
    ds_read_b64_tr_b16 v[148:149], v10 offset:9216
    v_mfma_f32_16x16x32_bf16 v[210:213], v[98:101], v[130:133], v[210:213]
    v_mfma_f32_16x16x32_bf16 v[206:209], v[94:97], v[130:133], v[206:209]
    v_mfma_f32_16x16x32_bf16 v[202:205], v[90:93], v[130:133], v[202:205]
    v_mfma_f32_16x16x32_bf16 v[198:201], v[86:89], v[130:133], v[198:201]
    v_mfma_f32_16x16x32_bf16 v[32:35], v[28:31], v[118:121], v[32:35]
    v_mfma_f32_16x16x32_bf16 v[36:39], v[28:31], v[122:125], v[36:39]
    s_waitcnt lgkmcnt(0)
    s_barrier
    v_mfma_f32_16x16x32_bf16 v[150:153], v[102:105], v[134:137], v[150:153]
    ds_read_b64_tr_b16 v[118:119], v7 offset:16384
    v_mfma_f32_16x16x32_bf16 v[154:157], v[106:109], v[134:137], v[154:157]
    ds_read_b64_tr_b16 v[120:121], v7 offset:17408
    v_mfma_f32_16x16x32_bf16 v[158:161], v[110:113], v[134:137], v[158:161]
    ds_read_b128 v[86:89], v14 offset:0
    v_mfma_f32_16x16x32_bf16 v[162:165], v[114:117], v[134:137], v[162:165]
    ds_read_b128 v[90:93], v14 offset:2048
    v_mfma_f32_16x16x32_bf16 v[178:181], v[114:117], v[138:141], v[178:181]
    ds_read_b128 v[94:97], v14 offset:4096
    v_mfma_f32_16x16x32_bf16 v[174:177], v[110:113], v[138:141], v[174:177]
    ds_read_b128 v[98:101], v14 offset:6144
    v_mfma_f32_16x16x32_bf16 v[170:173], v[106:109], v[138:141], v[170:173]
    ds_read_b64_tr_b16 v[122:123], v8 offset:16384
    v_mfma_f32_16x16x32_bf16 v[166:169], v[102:105], v[138:141], v[166:169]
    ds_read_b64_tr_b16 v[124:125], v8 offset:17408
    v_mfma_f32_16x16x32_bf16 v[182:185], v[102:105], v[142:145], v[182:185]
    ds_read_b64_tr_b16 v[126:127], v9 offset:16384
    v_mfma_f32_16x16x32_bf16 v[186:189], v[106:109], v[142:145], v[186:189]
    ds_read_b64_tr_b16 v[128:129], v9 offset:17408
    v_mfma_f32_16x16x32_bf16 v[190:193], v[110:113], v[142:145], v[190:193]
    ds_read_b64_tr_b16 v[130:131], v10 offset:16384
    v_mfma_f32_16x16x32_bf16 v[194:197], v[114:117], v[142:145], v[194:197]
    ds_read_b64_tr_b16 v[132:133], v10 offset:17408
    v_mfma_f32_16x16x32_bf16 v[210:213], v[114:117], v[146:149], v[210:213]
    v_mfma_f32_16x16x32_bf16 v[206:209], v[110:113], v[146:149], v[206:209]
    v_mfma_f32_16x16x32_bf16 v[202:205], v[106:109], v[146:149], v[202:205]
    v_mfma_f32_16x16x32_bf16 v[198:201], v[102:105], v[146:149], v[198:201]
    v_mfma_f32_16x16x32_bf16 v[32:35], v[28:31], v[134:137], v[32:35]
    v_mfma_f32_16x16x32_bf16 v[36:39], v[28:31], v[138:141], v[36:39]
    s_waitcnt lgkmcnt(0)
    v_mfma_f32_16x16x32_bf16 v[150:153], v[86:89], v[118:121], v[150:153]
    ds_read_b64_tr_b16 v[134:135], v7 offset:24576
    v_mfma_f32_16x16x32_bf16 v[154:157], v[90:93], v[118:121], v[154:157]
    ds_read_b64_tr_b16 v[136:137], v7 offset:25600
    v_mfma_f32_16x16x32_bf16 v[158:161], v[94:97], v[118:121], v[158:161]
    ds_read_b128 v[102:105], v15 offset:0
    v_mfma_f32_16x16x32_bf16 v[162:165], v[98:101], v[118:121], v[162:165]
    ds_read_b128 v[106:109], v15 offset:2048
    v_mfma_f32_16x16x32_bf16 v[178:181], v[98:101], v[122:125], v[178:181]
    ds_read_b128 v[110:113], v15 offset:4096
    v_mfma_f32_16x16x32_bf16 v[174:177], v[94:97], v[122:125], v[174:177]
    ds_read_b128 v[114:117], v15 offset:6144
    v_mfma_f32_16x16x32_bf16 v[170:173], v[90:93], v[122:125], v[170:173]
    ds_read_b64_tr_b16 v[138:139], v8 offset:24576
    v_mfma_f32_16x16x32_bf16 v[166:169], v[86:89], v[122:125], v[166:169]
    ds_read_b64_tr_b16 v[140:141], v8 offset:25600
    v_mfma_f32_16x16x32_bf16 v[182:185], v[86:89], v[126:129], v[182:185]
    ds_read_b64_tr_b16 v[142:143], v9 offset:24576
    v_mfma_f32_16x16x32_bf16 v[186:189], v[90:93], v[126:129], v[186:189]
    ds_read_b64_tr_b16 v[144:145], v9 offset:25600
    v_mfma_f32_16x16x32_bf16 v[190:193], v[94:97], v[126:129], v[190:193]
    ds_read_b64_tr_b16 v[146:147], v10 offset:24576
    v_mfma_f32_16x16x32_bf16 v[194:197], v[98:101], v[126:129], v[194:197]
    ds_read_b64_tr_b16 v[148:149], v10 offset:25600
    v_mfma_f32_16x16x32_bf16 v[210:213], v[98:101], v[130:133], v[210:213]
    v_mfma_f32_16x16x32_bf16 v[206:209], v[94:97], v[130:133], v[206:209]
    v_mfma_f32_16x16x32_bf16 v[202:205], v[90:93], v[130:133], v[202:205]
    v_mfma_f32_16x16x32_bf16 v[198:201], v[86:89], v[130:133], v[198:201]
    v_mfma_f32_16x16x32_bf16 v[32:35], v[28:31], v[118:121], v[32:35]
    v_mfma_f32_16x16x32_bf16 v[36:39], v[28:31], v[122:125], v[36:39]
    s_waitcnt lgkmcnt(0)
    s_barrier
    v_mfma_f32_16x16x32_bf16 v[32:35], v[28:31], v[134:137], v[32:35]
    v_mfma_f32_16x16x32_bf16 v[36:39], v[28:31], v[138:141], v[36:39]
    v_mfma_f32_16x16x32_bf16 v[150:153], v[102:105], v[134:137], v[150:153]
    v_mfma_f32_16x16x32_bf16 v[154:157], v[106:109], v[134:137], v[154:157]
    v_mfma_f32_16x16x32_bf16 v[158:161], v[110:113], v[134:137], v[158:161]
    v_mfma_f32_16x16x32_bf16 v[162:165], v[114:117], v[134:137], v[162:165]
    v_mfma_f32_16x16x32_bf16 v[178:181], v[114:117], v[138:141], v[178:181]
    v_mfma_f32_16x16x32_bf16 v[174:177], v[110:113], v[138:141], v[174:177]
    v_mfma_f32_16x16x32_bf16 v[170:173], v[106:109], v[138:141], v[170:173]
    v_mfma_f32_16x16x32_bf16 v[166:169], v[102:105], v[138:141], v[166:169]
    v_mfma_f32_16x16x32_bf16 v[182:185], v[102:105], v[142:145], v[182:185]
    v_mfma_f32_16x16x32_bf16 v[186:189], v[106:109], v[142:145], v[186:189]
    v_mfma_f32_16x16x32_bf16 v[190:193], v[110:113], v[142:145], v[190:193]
    v_mfma_f32_16x16x32_bf16 v[194:197], v[114:117], v[142:145], v[194:197]
    v_mfma_f32_16x16x32_bf16 v[210:213], v[114:117], v[146:149], v[210:213]
    v_mfma_f32_16x16x32_bf16 v[206:209], v[110:113], v[146:149], v[206:209]
    v_mfma_f32_16x16x32_bf16 v[202:205], v[106:109], v[146:149], v[202:205]
    v_mfma_f32_16x16x32_bf16 v[198:201], v[102:105], v[146:149], v[198:201]
    s_mov_b64 exec, 0xffff
    ds_write_b32 v11, v32 offset:0
    ds_write_b32 v11, v36 offset:64
    s_mov_b64 exec, -1
    s_add_u32 m0, s50, 114688
    s_mul_i32 s16, s62, 221184
    buffer_load_dwordx4 v16, s[4:7], s16 offen offset:0 lds
    buffer_load_dwordx4 v17, s[4:7], s16 offen offset:1024 lds
    buffer_load_dwordx4 v18, s[4:7], s16 offen offset:2048 lds
    buffer_load_dwordx4 v19, s[4:7], s16 offen offset:3072 lds
    s_add_u32 s62, s62, 1
    s_cmp_eq_u32 s62, 10
    s_cselect_b32 s62, 0, s62
    s_waitcnt lgkmcnt(0)
    s_barrier
    s_add_u32 m0, s50, 131072
    s_mul_i32 s16, s62, 221184
    buffer_load_dwordx4 v16, s[4:7], s16 offen offset:0 lds
    buffer_load_dwordx4 v17, s[4:7], s16 offen offset:1024 lds
    buffer_load_dwordx4 v18, s[4:7], s16 offen offset:2048 lds
    buffer_load_dwordx4 v19, s[4:7], s16 offen offset:3072 lds
    s_add_u32 s62, s62, 1
    s_cmp_eq_u32 s62, 10
    s_cselect_b32 s62, 0, s62
    s_add_u32 m0, s50, 16384
    s_lshl_b32 s51, s17, 7
    buffer_load_dwordx4 v1, s[8:11], s51 offen offset:0 lds
    buffer_load_dwordx4 v2, s[8:11], s51 offen offset:1024 lds
    buffer_load_dwordx4 v3, s[8:11], s51 offen offset:2048 lds
    buffer_load_dwordx4 v4, s[8:11], s51 offen offset:3072 lds
    s_add_u32 s17, s17, 1
    s_cmp_eq_u32 s17, 10
    s_cselect_b32 s17, 0, s17
    v_xor_b32 v26, 128, v11
    ds_read_b32 v76, v11 offset:0
    ds_read_b32 v77, v11 offset:64
    ds_read_b32 v78, v26 offset:0
    ds_read_b32 v79, v26 offset:64
    v_lshrrev_b32 v25, 4, v0
    s_lshl_b32 s49, s44, 8
    v_lshl_add_u32 v25, v25, 4, s49
    ds_read_b128 v[86:89], v25 offset:0
    ds_read_b128 v[102:105], v25 offset:512
    ds_read_b128 v[90:93], v25 offset:64
    ds_read_b128 v[106:109], v25 offset:576
    ds_read_b128 v[94:97], v25 offset:128
    ds_read_b128 v[110:113], v25 offset:640
    ds_read_b128 v[98:101], v25 offset:192
    ds_read_b128 v[114:117], v25 offset:704
    s_waitcnt lgkmcnt(0)
    v_mov_b32 v13, 4032
    ds_read_b32 v13, v13
    v_fmac_f32 v150, v86, v76
    v_fmac_f32 v151, v87, v76
    v_fmac_f32 v152, v88, v76
    v_fmac_f32 v153, v89, v76
    v_fmac_f32 v154, v90, v76
    v_fmac_f32 v155, v91, v76
    v_fmac_f32 v156, v92, v76
    v_fmac_f32 v157, v93, v76
    v_mul_f32 v150, v150, v102
    v_mul_f32 v151, v151, v103
    v_mul_f32 v152, v152, v104
    v_mul_f32 v153, v153, v105
    v_mul_f32 v154, v154, v106
    v_mul_f32 v155, v155, v107
    v_mul_f32 v156, v156, v108
    v_mul_f32 v157, v157, v109
    v_cvt_pk_bf16_f32 v214, v150, v151
    v_cvt_pk_bf16_f32 v215, v152, v153
    v_cvt_pk_bf16_f32 v216, v154, v155
    v_cvt_pk_bf16_f32 v217, v156, v157
    s_nop 1
    v_permlane32_swap_b32 v214, v216
    v_permlane32_swap_b32 v215, v217
    s_waitcnt vmcnt(4)
    s_barrier
    s_add_u32 m0, s50, 147456
    s_mul_i32 s16, s62, 221184
    buffer_load_dwordx4 v16, s[4:7], s16 offen offset:0 lds
    buffer_load_dwordx4 v17, s[4:7], s16 offen offset:1024 lds
    buffer_load_dwordx4 v18, s[4:7], s16 offen offset:2048 lds
    buffer_load_dwordx4 v19, s[4:7], s16 offen offset:3072 lds
    s_add_u32 s62, s62, 1
    s_cmp_eq_u32 s62, 10
    s_cselect_b32 s62, 0, s62
    s_add_u32 m0, s50, 32768
    s_lshl_b32 s51, s17, 7
    buffer_load_dwordx4 v1, s[8:11], s51 offen offset:0 lds
    buffer_load_dwordx4 v2, s[8:11], s51 offen offset:1024 lds
    buffer_load_dwordx4 v3, s[8:11], s51 offen offset:2048 lds
    buffer_load_dwordx4 v4, s[8:11], s51 offen offset:3072 lds
    s_add_u32 s17, s17, 1
    s_cmp_eq_u32 s17, 10
    s_cselect_b32 s17, 0, s17
    buffer_store_dwordx4 v[214:217], v72, s[20:23], s56 offen sc1
    v_fmac_f32 v158, v94, v76
    v_fmac_f32 v159, v95, v76
    v_fmac_f32 v160, v96, v76
    v_fmac_f32 v161, v97, v76
    v_fmac_f32 v162, v98, v76
    v_fmac_f32 v163, v99, v76
    v_fmac_f32 v164, v100, v76
    v_fmac_f32 v165, v101, v76
    v_mul_f32 v158, v158, v110
    v_mul_f32 v159, v159, v111
    v_mul_f32 v160, v160, v112
    v_mul_f32 v161, v161, v113
    v_mul_f32 v162, v162, v114
    v_mul_f32 v163, v163, v115
    v_mul_f32 v164, v164, v116
    v_mul_f32 v165, v165, v117
    v_cvt_pk_bf16_f32 v218, v158, v159
    v_cvt_pk_bf16_f32 v219, v160, v161
    v_cvt_pk_bf16_f32 v220, v162, v163
    v_cvt_pk_bf16_f32 v221, v164, v165
    s_nop 1
    v_permlane32_swap_b32 v218, v220
    v_permlane32_swap_b32 v219, v221
    buffer_store_dwordx4 v[218:221], v72, s[20:23], s57 offen sc1
    v_fmac_f32 v166, v86, v77
    v_fmac_f32 v167, v87, v77
    v_fmac_f32 v168, v88, v77
    v_fmac_f32 v169, v89, v77
    v_fmac_f32 v170, v90, v77
    v_fmac_f32 v171, v91, v77
    v_fmac_f32 v172, v92, v77
    v_fmac_f32 v173, v93, v77
    v_mul_f32 v166, v166, v102
    v_mul_f32 v167, v167, v103
    v_mul_f32 v168, v168, v104
    v_mul_f32 v169, v169, v105
    v_mul_f32 v170, v170, v106
    v_mul_f32 v171, v171, v107
    v_mul_f32 v172, v172, v108
    v_mul_f32 v173, v173, v109
    v_cvt_pk_bf16_f32 v222, v166, v167
    v_cvt_pk_bf16_f32 v223, v168, v169
    v_cvt_pk_bf16_f32 v224, v170, v171
    v_cvt_pk_bf16_f32 v225, v172, v173
    s_nop 1
    v_permlane32_swap_b32 v222, v224
    v_permlane32_swap_b32 v223, v225
    buffer_store_dwordx4 v[222:225], v73, s[20:23], s56 offen sc1
    v_fmac_f32 v174, v94, v77
    v_fmac_f32 v175, v95, v77
    v_fmac_f32 v176, v96, v77
    v_fmac_f32 v177, v97, v77
    v_fmac_f32 v178, v98, v77
    v_fmac_f32 v179, v99, v77
    v_fmac_f32 v180, v100, v77
    v_fmac_f32 v181, v101, v77
    v_mul_f32 v174, v174, v110
    v_mul_f32 v175, v175, v111
    v_mul_f32 v176, v176, v112
    v_mul_f32 v177, v177, v113
    v_mul_f32 v178, v178, v114
    v_mul_f32 v179, v179, v115
    v_mul_f32 v180, v180, v116
    v_mul_f32 v181, v181, v117
    v_cvt_pk_bf16_f32 v226, v174, v175
    v_cvt_pk_bf16_f32 v227, v176, v177
    v_cvt_pk_bf16_f32 v228, v178, v179
    v_cvt_pk_bf16_f32 v229, v180, v181
    s_nop 1
    v_permlane32_swap_b32 v226, v228
    v_permlane32_swap_b32 v227, v229
    buffer_store_dwordx4 v[226:229], v73, s[20:23], s57 offen sc1
    v_fmac_f32 v182, v86, v78
    v_fmac_f32 v183, v87, v78
    v_fmac_f32 v184, v88, v78
    v_fmac_f32 v185, v89, v78
    v_fmac_f32 v186, v90, v78
    v_fmac_f32 v187, v91, v78
    v_fmac_f32 v188, v92, v78
    v_fmac_f32 v189, v93, v78
    v_mul_f32 v182, v182, v102
    v_mul_f32 v183, v183, v103
    v_mul_f32 v184, v184, v104
    v_mul_f32 v185, v185, v105
    v_mul_f32 v186, v186, v106
    v_mul_f32 v187, v187, v107
    v_mul_f32 v188, v188, v108
    v_mul_f32 v189, v189, v109
    v_cvt_pk_bf16_f32 v230, v182, v183
    v_cvt_pk_bf16_f32 v231, v184, v185
    v_cvt_pk_bf16_f32 v232, v186, v187
    v_cvt_pk_bf16_f32 v233, v188, v189
    s_nop 1
    v_permlane32_swap_b32 v230, v232
    v_permlane32_swap_b32 v231, v233
    buffer_store_dwordx4 v[230:233], v74, s[20:23], s56 offen sc1
    v_fmac_f32 v190, v94, v78
    v_fmac_f32 v191, v95, v78
    v_fmac_f32 v192, v96, v78
    v_fmac_f32 v193, v97, v78
    v_fmac_f32 v194, v98, v78
    v_fmac_f32 v195, v99, v78
    v_fmac_f32 v196, v100, v78
    v_fmac_f32 v197, v101, v78
    v_mul_f32 v190, v190, v110
    v_mul_f32 v191, v191, v111
    v_mul_f32 v192, v192, v112
    v_mul_f32 v193, v193, v113
    v_mul_f32 v194, v194, v114
    v_mul_f32 v195, v195, v115
    v_mul_f32 v196, v196, v116
    v_mul_f32 v197, v197, v117
    v_cvt_pk_bf16_f32 v234, v190, v191
    v_cvt_pk_bf16_f32 v235, v192, v193
    v_cvt_pk_bf16_f32 v236, v194, v195
    v_cvt_pk_bf16_f32 v237, v196, v197
    s_nop 1
    v_permlane32_swap_b32 v234, v236
    v_permlane32_swap_b32 v235, v237
    buffer_store_dwordx4 v[234:237], v74, s[20:23], s57 offen sc1
    v_fmac_f32 v198, v86, v79
    v_fmac_f32 v199, v87, v79
    v_fmac_f32 v200, v88, v79
    v_fmac_f32 v201, v89, v79
    v_fmac_f32 v202, v90, v79
    v_fmac_f32 v203, v91, v79
    v_fmac_f32 v204, v92, v79
    v_fmac_f32 v205, v93, v79
    v_mul_f32 v198, v198, v102
    v_mul_f32 v199, v199, v103
    v_mul_f32 v200, v200, v104
    v_mul_f32 v201, v201, v105
    v_mul_f32 v202, v202, v106
    v_mul_f32 v203, v203, v107
    v_mul_f32 v204, v204, v108
    v_mul_f32 v205, v205, v109
    v_cvt_pk_bf16_f32 v238, v198, v199
    v_cvt_pk_bf16_f32 v239, v200, v201
    v_cvt_pk_bf16_f32 v240, v202, v203
    v_cvt_pk_bf16_f32 v241, v204, v205
    s_nop 1
    v_permlane32_swap_b32 v238, v240
    v_permlane32_swap_b32 v239, v241
    buffer_store_dwordx4 v[238:241], v75, s[20:23], s56 offen sc1
    v_fmac_f32 v206, v94, v79
    v_fmac_f32 v207, v95, v79
    v_fmac_f32 v208, v96, v79
    v_fmac_f32 v209, v97, v79
    v_fmac_f32 v210, v98, v79
    v_fmac_f32 v211, v99, v79
    v_fmac_f32 v212, v100, v79
    v_fmac_f32 v213, v101, v79
    v_mul_f32 v206, v206, v110
    v_mul_f32 v207, v207, v111
    v_mul_f32 v208, v208, v112
    v_mul_f32 v209, v209, v113
    v_mul_f32 v210, v210, v114
    v_mul_f32 v211, v211, v115
    v_mul_f32 v212, v212, v116
    v_mul_f32 v213, v213, v117
    v_cvt_pk_bf16_f32 v242, v206, v207
    v_cvt_pk_bf16_f32 v243, v208, v209
    v_cvt_pk_bf16_f32 v244, v210, v211
    v_cvt_pk_bf16_f32 v245, v212, v213
    s_nop 1
    v_permlane32_swap_b32 v242, v244
    v_permlane32_swap_b32 v243, v245
    buffer_store_dwordx4 v[242:245], v75, s[20:23], s57 offen sc1
    s_waitcnt vmcnt(12)
    s_barrier
    s_add_u32 m0, s50, 98304
    s_mul_i32 s16, s62, 221184
    buffer_load_dwordx4 v16, s[4:7], s16 offen offset:0 lds
    buffer_load_dwordx4 v17, s[4:7], s16 offen offset:1024 lds
    buffer_load_dwordx4 v18, s[4:7], s16 offen offset:2048 lds
    buffer_load_dwordx4 v19, s[4:7], s16 offen offset:3072 lds
    s_add_u32 s62, s62, 1
    s_cmp_eq_u32 s62, 10
    s_cselect_b32 s62, 0, s62
    s_add_u32 m0, s50, 114688
    s_mul_i32 s16, s62, 221184
    buffer_load_dwordx4 v16, s[4:7], s16 offen offset:0 lds
    buffer_load_dwordx4 v17, s[4:7], s16 offen offset:1024 lds
    buffer_load_dwordx4 v18, s[4:7], s16 offen offset:2048 lds
    buffer_load_dwordx4 v19, s[4:7], s16 offen offset:3072 lds
    s_add_u32 s62, s62, 1
    s_cmp_eq_u32 s62, 10
    s_cselect_b32 s62, 0, s62
    s_add_u32 m0, s50, 49152
    s_lshl_b32 s51, s17, 7
    buffer_load_dwordx4 v1, s[8:11], s51 offen offset:0 lds
    buffer_load_dwordx4 v2, s[8:11], s51 offen offset:1024 lds
    buffer_load_dwordx4 v3, s[8:11], s51 offen offset:2048 lds
    buffer_load_dwordx4 v4, s[8:11], s51 offen offset:3072 lds
    s_add_u32 s17, s17, 1
    s_cmp_eq_u32 s17, 10
    s_cselect_b32 s17, 0, s17
    s_waitcnt lgkmcnt(0)
    v_readfirstlane_b32 s61, v13
    s_waitcnt vmcnt(12)
    s_mov_b64 exec, 1
    buffer_store_dword v13, off, s[20:23], s46 sc1
    s_mov_b64 exec, -1
    s_waitcnt vmcnt(9)
    s_barrier
    s_add_u32 m0, s50, 131072
    s_mul_i32 s16, s62, 221184
    buffer_load_dwordx4 v16, s[4:7], s16 offen offset:0 lds
    buffer_load_dwordx4 v17, s[4:7], s16 offen offset:1024 lds
    buffer_load_dwordx4 v18, s[4:7], s16 offen offset:2048 lds
    buffer_load_dwordx4 v19, s[4:7], s16 offen offset:3072 lds
    s_add_u32 s62, s62, 1
    s_cmp_eq_u32 s62, 10
    s_cselect_b32 s62, 0, s62
    s_add_u32 m0, s50, 65536
    s_lshl_b32 s51, s17, 7
    buffer_load_dwordx4 v1, s[8:11], s51 offen offset:0 lds
    buffer_load_dwordx4 v2, s[8:11], s51 offen offset:1024 lds
    buffer_load_dwordx4 v3, s[8:11], s51 offen offset:2048 lds
    buffer_load_dwordx4 v4, s[8:11], s51 offen offset:3072 lds
    s_add_u32 s17, s17, 1
    s_cmp_eq_u32 s17, 10
    s_cselect_b32 s17, 0, s17
    v_mov_b32 v6, 0x3f803f80
    v_mov_b32 v172, v6
    v_mov_b32 v173, v6
    v_mov_b32 v174, v6
    v_mov_b32 v175, v6
    v_mov_b32 v176, v6
    v_mov_b32 v177, v6
    v_mov_b32 v178, v6
    v_mov_b32 v179, v6
    v_mov_b32 v180, v6
    v_mov_b32 v181, v6
    v_mov_b32 v182, v6
    v_mov_b32 v183, v6
    v_mov_b32 v120, 0
    v_mov_b32 v121, 0
    v_mov_b32 v122, 0
    v_mov_b32 v123, 0
    v_mov_b32 v184, 0
    v_mov_b32 v116, -1
    v_mov_b32 v185, 0
    v_mov_b32 v117, -1
    v_mov_b32 v186, 0
    v_mov_b32 v118, -1
    v_mov_b32 v187, 0
    v_mov_b32 v119, -1
    v_mfma_f32_32x32x16_bf16 v[124:139], v[120:123], v[120:123], 0
    v_mfma_f32_32x32x16_bf16 v[140:155], v[120:123], v[120:123], 0
    s_waitcnt vmcnt(9)
    s_barrier
    s_add_u32 m0, s50, 147456
    s_mul_i32 s16, s62, 221184
    buffer_load_dwordx4 v16, s[4:7], s16 offen offset:0 lds
    buffer_load_dwordx4 v17, s[4:7], s16 offen offset:1024 lds
    buffer_load_dwordx4 v18, s[4:7], s16 offen offset:2048 lds
    buffer_load_dwordx4 v19, s[4:7], s16 offen offset:3072 lds
    s_add_u32 s62, s62, 1
    s_cmp_eq_u32 s62, 10
    s_cselect_b32 s62, 0, s62
    s_add_u32 m0, s50, 81920
    s_lshl_b32 s51, s17, 7
    buffer_load_dwordx4 v1, s[8:11], s51 offen offset:0 lds
    buffer_load_dwordx4 v2, s[8:11], s51 offen offset:1024 lds
    buffer_load_dwordx4 v3, s[8:11], s51 offen offset:2048 lds
    buffer_load_dwordx4 v4, s[8:11], s51 offen offset:3072 lds
    s_add_u32 s17, s17, 1
    s_cmp_eq_u32 s17, 10
    s_cselect_b32 s17, 0, s17
    s_waitcnt vmcnt(8)
    s_barrier
    s_branch P2_SETUP
P1_A_T:
    s_barrier
    ds_read_b64_tr_b16 v[118:119], v7 offset:0
    ds_read_b64_tr_b16 v[120:121], v7 offset:1024
    ds_read_b128 v[86:89], v5 offset:0
    ds_read_b128 v[90:93], v5 offset:2048
    ds_read_b128 v[94:97], v5 offset:4096
    ds_read_b128 v[98:101], v5 offset:6144
    ds_read_b64_tr_b16 v[122:123], v8 offset:0
    ds_read_b64_tr_b16 v[124:125], v8 offset:1024
    ds_read_b64_tr_b16 v[126:127], v9 offset:0
    ds_read_b64_tr_b16 v[128:129], v9 offset:1024
    ds_read_b64_tr_b16 v[130:131], v10 offset:0
    ds_read_b64_tr_b16 v[132:133], v10 offset:1024
    s_waitcnt lgkmcnt(0)
    v_mfma_f32_16x16x32_bf16 v[150:153], v[118:121], v[86:89], 0
    ds_read_b64_tr_b16 v[134:135], v7 offset:8192
    v_mfma_f32_16x16x32_bf16 v[154:157], v[118:121], v[90:93], 0
    ds_read_b64_tr_b16 v[136:137], v7 offset:9216
    v_mfma_f32_16x16x32_bf16 v[158:161], v[118:121], v[94:97], 0
    ds_read_b128 v[102:105], v6 offset:0
    v_mfma_f32_16x16x32_bf16 v[162:165], v[118:121], v[98:101], 0
    ds_read_b128 v[106:109], v6 offset:2048
    v_mfma_f32_16x16x32_bf16 v[178:181], v[122:125], v[98:101], 0
    ds_read_b128 v[110:113], v6 offset:4096
    v_mfma_f32_16x16x32_bf16 v[174:177], v[122:125], v[94:97], 0
    ds_read_b128 v[114:117], v6 offset:6144
    v_mfma_f32_16x16x32_bf16 v[170:173], v[122:125], v[90:93], 0
    ds_read_b64_tr_b16 v[138:139], v8 offset:8192
    v_mfma_f32_16x16x32_bf16 v[166:169], v[122:125], v[86:89], 0
    ds_read_b64_tr_b16 v[140:141], v8 offset:9216
    v_mfma_f32_16x16x32_bf16 v[182:185], v[126:129], v[86:89], 0
    ds_read_b64_tr_b16 v[142:143], v9 offset:8192
    v_mfma_f32_16x16x32_bf16 v[186:189], v[126:129], v[90:93], 0
    ds_read_b64_tr_b16 v[144:145], v9 offset:9216
    v_mfma_f32_16x16x32_bf16 v[190:193], v[126:129], v[94:97], 0
    ds_read_b64_tr_b16 v[146:147], v10 offset:8192
    v_mfma_f32_16x16x32_bf16 v[194:197], v[126:129], v[98:101], 0
    ds_read_b64_tr_b16 v[148:149], v10 offset:9216
    v_mfma_f32_16x16x32_bf16 v[210:213], v[130:133], v[98:101], 0
    v_mfma_f32_16x16x32_bf16 v[206:209], v[130:133], v[94:97], 0
    v_mfma_f32_16x16x32_bf16 v[202:205], v[130:133], v[90:93], 0
    v_mfma_f32_16x16x32_bf16 v[198:201], v[130:133], v[86:89], 0
    v_mfma_f32_16x16x32_bf16 v[32:35], v[28:31], v[118:121], 0
    v_mfma_f32_16x16x32_bf16 v[36:39], v[28:31], v[122:125], 0
    s_waitcnt lgkmcnt(0)
    s_barrier
    v_mfma_f32_16x16x32_bf16 v[150:153], v[134:137], v[102:105], v[150:153]
    ds_read_b64_tr_b16 v[118:119], v7 offset:16384
    v_mfma_f32_16x16x32_bf16 v[154:157], v[134:137], v[106:109], v[154:157]
    ds_read_b64_tr_b16 v[120:121], v7 offset:17408
    v_mfma_f32_16x16x32_bf16 v[158:161], v[134:137], v[110:113], v[158:161]
    ds_read_b128 v[86:89], v5 offset:16384
    v_mfma_f32_16x16x32_bf16 v[162:165], v[134:137], v[114:117], v[162:165]
    ds_read_b128 v[90:93], v5 offset:18432
    v_mfma_f32_16x16x32_bf16 v[178:181], v[138:141], v[114:117], v[178:181]
    ds_read_b128 v[94:97], v5 offset:20480
    v_mfma_f32_16x16x32_bf16 v[174:177], v[138:141], v[110:113], v[174:177]
    ds_read_b128 v[98:101], v5 offset:22528
    v_mfma_f32_16x16x32_bf16 v[170:173], v[138:141], v[106:109], v[170:173]
    ds_read_b64_tr_b16 v[122:123], v8 offset:16384
    v_mfma_f32_16x16x32_bf16 v[166:169], v[138:141], v[102:105], v[166:169]
    ds_read_b64_tr_b16 v[124:125], v8 offset:17408
    v_mfma_f32_16x16x32_bf16 v[182:185], v[142:145], v[102:105], v[182:185]
    ds_read_b64_tr_b16 v[126:127], v9 offset:16384
    v_mfma_f32_16x16x32_bf16 v[186:189], v[142:145], v[106:109], v[186:189]
    ds_read_b64_tr_b16 v[128:129], v9 offset:17408
    v_mfma_f32_16x16x32_bf16 v[190:193], v[142:145], v[110:113], v[190:193]
    ds_read_b64_tr_b16 v[130:131], v10 offset:16384
    v_mfma_f32_16x16x32_bf16 v[194:197], v[142:145], v[114:117], v[194:197]
    ds_read_b64_tr_b16 v[132:133], v10 offset:17408
    v_mfma_f32_16x16x32_bf16 v[210:213], v[146:149], v[114:117], v[210:213]
    v_mfma_f32_16x16x32_bf16 v[206:209], v[146:149], v[110:113], v[206:209]
    v_mfma_f32_16x16x32_bf16 v[202:205], v[146:149], v[106:109], v[202:205]
    v_mfma_f32_16x16x32_bf16 v[198:201], v[146:149], v[102:105], v[198:201]
    v_mfma_f32_16x16x32_bf16 v[32:35], v[28:31], v[134:137], v[32:35]
    v_mfma_f32_16x16x32_bf16 v[36:39], v[28:31], v[138:141], v[36:39]
    s_waitcnt lgkmcnt(0)
    v_mfma_f32_16x16x32_bf16 v[150:153], v[118:121], v[86:89], v[150:153]
    ds_read_b64_tr_b16 v[134:135], v7 offset:24576
    v_mfma_f32_16x16x32_bf16 v[154:157], v[118:121], v[90:93], v[154:157]
    ds_read_b64_tr_b16 v[136:137], v7 offset:25600
    v_mfma_f32_16x16x32_bf16 v[158:161], v[118:121], v[94:97], v[158:161]
    ds_read_b128 v[102:105], v6 offset:16384
    v_mfma_f32_16x16x32_bf16 v[162:165], v[118:121], v[98:101], v[162:165]
    ds_read_b128 v[106:109], v6 offset:18432
    v_mfma_f32_16x16x32_bf16 v[178:181], v[122:125], v[98:101], v[178:181]
    ds_read_b128 v[110:113], v6 offset:20480
    v_mfma_f32_16x16x32_bf16 v[174:177], v[122:125], v[94:97], v[174:177]
    ds_read_b128 v[114:117], v6 offset:22528
    v_mfma_f32_16x16x32_bf16 v[170:173], v[122:125], v[90:93], v[170:173]
    ds_read_b64_tr_b16 v[138:139], v8 offset:24576
    v_mfma_f32_16x16x32_bf16 v[166:169], v[122:125], v[86:89], v[166:169]
    ds_read_b64_tr_b16 v[140:141], v8 offset:25600
    v_mfma_f32_16x16x32_bf16 v[182:185], v[126:129], v[86:89], v[182:185]
    ds_read_b64_tr_b16 v[142:143], v9 offset:24576
    v_mfma_f32_16x16x32_bf16 v[186:189], v[126:129], v[90:93], v[186:189]
    ds_read_b64_tr_b16 v[144:145], v9 offset:25600
    v_mfma_f32_16x16x32_bf16 v[190:193], v[126:129], v[94:97], v[190:193]
    ds_read_b64_tr_b16 v[146:147], v10 offset:24576
    v_mfma_f32_16x16x32_bf16 v[194:197], v[126:129], v[98:101], v[194:197]
    ds_read_b64_tr_b16 v[148:149], v10 offset:25600
    v_mfma_f32_16x16x32_bf16 v[210:213], v[130:133], v[98:101], v[210:213]
    v_mfma_f32_16x16x32_bf16 v[206:209], v[130:133], v[94:97], v[206:209]
    v_mfma_f32_16x16x32_bf16 v[202:205], v[130:133], v[90:93], v[202:205]
    v_mfma_f32_16x16x32_bf16 v[198:201], v[130:133], v[86:89], v[198:201]
    v_mfma_f32_16x16x32_bf16 v[32:35], v[28:31], v[118:121], v[32:35]
    v_mfma_f32_16x16x32_bf16 v[36:39], v[28:31], v[122:125], v[36:39]
    s_waitcnt lgkmcnt(0)
    s_barrier
    v_mfma_f32_16x16x32_bf16 v[150:153], v[134:137], v[102:105], v[150:153]
    ds_read_b64_tr_b16 v[118:119], v7 offset:32768
    v_mfma_f32_16x16x32_bf16 v[154:157], v[134:137], v[106:109], v[154:157]
    ds_read_b64_tr_b16 v[120:121], v7 offset:33792
    v_mfma_f32_16x16x32_bf16 v[158:161], v[134:137], v[110:113], v[158:161]
    ds_read_b128 v[86:89], v5 offset:32768
    v_mfma_f32_16x16x32_bf16 v[162:165], v[134:137], v[114:117], v[162:165]
    ds_read_b128 v[90:93], v5 offset:34816
    v_mfma_f32_16x16x32_bf16 v[178:181], v[138:141], v[114:117], v[178:181]
    ds_read_b128 v[94:97], v5 offset:36864
    v_mfma_f32_16x16x32_bf16 v[174:177], v[138:141], v[110:113], v[174:177]
    ds_read_b128 v[98:101], v5 offset:38912
    v_mfma_f32_16x16x32_bf16 v[170:173], v[138:141], v[106:109], v[170:173]
    ds_read_b64_tr_b16 v[122:123], v8 offset:32768
    v_mfma_f32_16x16x32_bf16 v[166:169], v[138:141], v[102:105], v[166:169]
    ds_read_b64_tr_b16 v[124:125], v8 offset:33792
    v_mfma_f32_16x16x32_bf16 v[182:185], v[142:145], v[102:105], v[182:185]
    ds_read_b64_tr_b16 v[126:127], v9 offset:32768
    v_mfma_f32_16x16x32_bf16 v[186:189], v[142:145], v[106:109], v[186:189]
    ds_read_b64_tr_b16 v[128:129], v9 offset:33792
    v_mfma_f32_16x16x32_bf16 v[190:193], v[142:145], v[110:113], v[190:193]
    ds_read_b64_tr_b16 v[130:131], v10 offset:32768
    v_mfma_f32_16x16x32_bf16 v[194:197], v[142:145], v[114:117], v[194:197]
    ds_read_b64_tr_b16 v[132:133], v10 offset:33792
    v_mfma_f32_16x16x32_bf16 v[210:213], v[146:149], v[114:117], v[210:213]
    v_mfma_f32_16x16x32_bf16 v[206:209], v[146:149], v[110:113], v[206:209]
    v_mfma_f32_16x16x32_bf16 v[202:205], v[146:149], v[106:109], v[202:205]
    v_mfma_f32_16x16x32_bf16 v[198:201], v[146:149], v[102:105], v[198:201]
    v_mfma_f32_16x16x32_bf16 v[32:35], v[28:31], v[134:137], v[32:35]
    v_mfma_f32_16x16x32_bf16 v[36:39], v[28:31], v[138:141], v[36:39]
    s_waitcnt lgkmcnt(0)
    v_mfma_f32_16x16x32_bf16 v[150:153], v[118:121], v[86:89], v[150:153]
    ds_read_b64_tr_b16 v[134:135], v7 offset:40960
    v_mfma_f32_16x16x32_bf16 v[154:157], v[118:121], v[90:93], v[154:157]
    ds_read_b64_tr_b16 v[136:137], v7 offset:41984
    v_mfma_f32_16x16x32_bf16 v[158:161], v[118:121], v[94:97], v[158:161]
    ds_read_b128 v[102:105], v6 offset:32768
    v_mfma_f32_16x16x32_bf16 v[162:165], v[118:121], v[98:101], v[162:165]
    ds_read_b128 v[106:109], v6 offset:34816
    v_mfma_f32_16x16x32_bf16 v[178:181], v[122:125], v[98:101], v[178:181]
    ds_read_b128 v[110:113], v6 offset:36864
    v_mfma_f32_16x16x32_bf16 v[174:177], v[122:125], v[94:97], v[174:177]
    ds_read_b128 v[114:117], v6 offset:38912
    v_mfma_f32_16x16x32_bf16 v[170:173], v[122:125], v[90:93], v[170:173]
    ds_read_b64_tr_b16 v[138:139], v8 offset:40960
    v_mfma_f32_16x16x32_bf16 v[166:169], v[122:125], v[86:89], v[166:169]
    ds_read_b64_tr_b16 v[140:141], v8 offset:41984
    v_mfma_f32_16x16x32_bf16 v[182:185], v[126:129], v[86:89], v[182:185]
    ds_read_b64_tr_b16 v[142:143], v9 offset:40960
    v_mfma_f32_16x16x32_bf16 v[186:189], v[126:129], v[90:93], v[186:189]
    ds_read_b64_tr_b16 v[144:145], v9 offset:41984
    v_mfma_f32_16x16x32_bf16 v[190:193], v[126:129], v[94:97], v[190:193]
    ds_read_b64_tr_b16 v[146:147], v10 offset:40960
    v_mfma_f32_16x16x32_bf16 v[194:197], v[126:129], v[98:101], v[194:197]
    ds_read_b64_tr_b16 v[148:149], v10 offset:41984
    v_mfma_f32_16x16x32_bf16 v[210:213], v[130:133], v[98:101], v[210:213]
    v_mfma_f32_16x16x32_bf16 v[206:209], v[130:133], v[94:97], v[206:209]
    v_mfma_f32_16x16x32_bf16 v[202:205], v[130:133], v[90:93], v[202:205]
    v_mfma_f32_16x16x32_bf16 v[198:201], v[130:133], v[86:89], v[198:201]
    v_mfma_f32_16x16x32_bf16 v[32:35], v[28:31], v[118:121], v[32:35]
    v_mfma_f32_16x16x32_bf16 v[36:39], v[28:31], v[122:125], v[36:39]
    s_waitcnt lgkmcnt(0)
    s_barrier
    v_mfma_f32_16x16x32_bf16 v[150:153], v[134:137], v[102:105], v[150:153]
    ds_read_b64_tr_b16 v[118:119], v7 offset:49152
    v_mfma_f32_16x16x32_bf16 v[154:157], v[134:137], v[106:109], v[154:157]
    ds_read_b64_tr_b16 v[120:121], v7 offset:50176
    v_mfma_f32_16x16x32_bf16 v[158:161], v[134:137], v[110:113], v[158:161]
    ds_read_b128 v[86:89], v5 offset:49152
    v_mfma_f32_16x16x32_bf16 v[162:165], v[134:137], v[114:117], v[162:165]
    ds_read_b128 v[90:93], v5 offset:51200
    v_mfma_f32_16x16x32_bf16 v[178:181], v[138:141], v[114:117], v[178:181]
    ds_read_b128 v[94:97], v5 offset:53248
    v_mfma_f32_16x16x32_bf16 v[174:177], v[138:141], v[110:113], v[174:177]
    ds_read_b128 v[98:101], v5 offset:55296
    v_mfma_f32_16x16x32_bf16 v[170:173], v[138:141], v[106:109], v[170:173]
    ds_read_b64_tr_b16 v[122:123], v8 offset:49152
    v_mfma_f32_16x16x32_bf16 v[166:169], v[138:141], v[102:105], v[166:169]
    ds_read_b64_tr_b16 v[124:125], v8 offset:50176
    v_mfma_f32_16x16x32_bf16 v[182:185], v[142:145], v[102:105], v[182:185]
    ds_read_b64_tr_b16 v[126:127], v9 offset:49152
    v_mfma_f32_16x16x32_bf16 v[186:189], v[142:145], v[106:109], v[186:189]
    ds_read_b64_tr_b16 v[128:129], v9 offset:50176
    v_mfma_f32_16x16x32_bf16 v[190:193], v[142:145], v[110:113], v[190:193]
    ds_read_b64_tr_b16 v[130:131], v10 offset:49152
    v_mfma_f32_16x16x32_bf16 v[194:197], v[142:145], v[114:117], v[194:197]
    ds_read_b64_tr_b16 v[132:133], v10 offset:50176
    v_mfma_f32_16x16x32_bf16 v[210:213], v[146:149], v[114:117], v[210:213]
    v_mfma_f32_16x16x32_bf16 v[206:209], v[146:149], v[110:113], v[206:209]
    v_mfma_f32_16x16x32_bf16 v[202:205], v[146:149], v[106:109], v[202:205]
    v_mfma_f32_16x16x32_bf16 v[198:201], v[146:149], v[102:105], v[198:201]
    v_mfma_f32_16x16x32_bf16 v[32:35], v[28:31], v[134:137], v[32:35]
    v_mfma_f32_16x16x32_bf16 v[36:39], v[28:31], v[138:141], v[36:39]
    s_waitcnt lgkmcnt(0)
    v_mfma_f32_16x16x32_bf16 v[150:153], v[118:121], v[86:89], v[150:153]
    ds_read_b64_tr_b16 v[134:135], v7 offset:57344
    v_mfma_f32_16x16x32_bf16 v[154:157], v[118:121], v[90:93], v[154:157]
    ds_read_b64_tr_b16 v[136:137], v7 offset:58368
    v_mfma_f32_16x16x32_bf16 v[158:161], v[118:121], v[94:97], v[158:161]
    ds_read_b128 v[102:105], v6 offset:49152
    v_mfma_f32_16x16x32_bf16 v[162:165], v[118:121], v[98:101], v[162:165]
    ds_read_b128 v[106:109], v6 offset:51200
    v_mfma_f32_16x16x32_bf16 v[178:181], v[122:125], v[98:101], v[178:181]
    ds_read_b128 v[110:113], v6 offset:53248
    v_mfma_f32_16x16x32_bf16 v[174:177], v[122:125], v[94:97], v[174:177]
    ds_read_b128 v[114:117], v6 offset:55296
    v_mfma_f32_16x16x32_bf16 v[170:173], v[122:125], v[90:93], v[170:173]
    ds_read_b64_tr_b16 v[138:139], v8 offset:57344
    v_mfma_f32_16x16x32_bf16 v[166:169], v[122:125], v[86:89], v[166:169]
    ds_read_b64_tr_b16 v[140:141], v8 offset:58368
    v_mfma_f32_16x16x32_bf16 v[182:185], v[126:129], v[86:89], v[182:185]
    ds_read_b64_tr_b16 v[142:143], v9 offset:57344
    v_mfma_f32_16x16x32_bf16 v[186:189], v[126:129], v[90:93], v[186:189]
    ds_read_b64_tr_b16 v[144:145], v9 offset:58368
    v_mfma_f32_16x16x32_bf16 v[190:193], v[126:129], v[94:97], v[190:193]
    ds_read_b64_tr_b16 v[146:147], v10 offset:57344
    v_mfma_f32_16x16x32_bf16 v[194:197], v[126:129], v[98:101], v[194:197]
    ds_read_b64_tr_b16 v[148:149], v10 offset:58368
    v_mfma_f32_16x16x32_bf16 v[210:213], v[130:133], v[98:101], v[210:213]
    v_mfma_f32_16x16x32_bf16 v[206:209], v[130:133], v[94:97], v[206:209]
    v_mfma_f32_16x16x32_bf16 v[202:205], v[130:133], v[90:93], v[202:205]
    v_mfma_f32_16x16x32_bf16 v[198:201], v[130:133], v[86:89], v[198:201]
    v_mfma_f32_16x16x32_bf16 v[32:35], v[28:31], v[118:121], v[32:35]
    v_mfma_f32_16x16x32_bf16 v[36:39], v[28:31], v[122:125], v[36:39]
    s_waitcnt lgkmcnt(0)
    s_barrier
    v_mfma_f32_16x16x32_bf16 v[150:153], v[134:137], v[102:105], v[150:153]
    ds_read_b64_tr_b16 v[118:119], v7 offset:0
    v_mfma_f32_16x16x32_bf16 v[154:157], v[134:137], v[106:109], v[154:157]
    ds_read_b64_tr_b16 v[120:121], v7 offset:1024
    v_mfma_f32_16x16x32_bf16 v[158:161], v[134:137], v[110:113], v[158:161]
    ds_read_b128 v[86:89], v14 offset:0
    v_mfma_f32_16x16x32_bf16 v[162:165], v[134:137], v[114:117], v[162:165]
    ds_read_b128 v[90:93], v14 offset:2048
    v_mfma_f32_16x16x32_bf16 v[178:181], v[138:141], v[114:117], v[178:181]
    ds_read_b128 v[94:97], v14 offset:4096
    v_mfma_f32_16x16x32_bf16 v[174:177], v[138:141], v[110:113], v[174:177]
    ds_read_b128 v[98:101], v14 offset:6144
    v_mfma_f32_16x16x32_bf16 v[170:173], v[138:141], v[106:109], v[170:173]
    ds_read_b64_tr_b16 v[122:123], v8 offset:0
    v_mfma_f32_16x16x32_bf16 v[166:169], v[138:141], v[102:105], v[166:169]
    ds_read_b64_tr_b16 v[124:125], v8 offset:1024
    v_mfma_f32_16x16x32_bf16 v[182:185], v[142:145], v[102:105], v[182:185]
    ds_read_b64_tr_b16 v[126:127], v9 offset:0
    v_mfma_f32_16x16x32_bf16 v[186:189], v[142:145], v[106:109], v[186:189]
    ds_read_b64_tr_b16 v[128:129], v9 offset:1024
    v_mfma_f32_16x16x32_bf16 v[190:193], v[142:145], v[110:113], v[190:193]
    ds_read_b64_tr_b16 v[130:131], v10 offset:0
    v_mfma_f32_16x16x32_bf16 v[194:197], v[142:145], v[114:117], v[194:197]
    ds_read_b64_tr_b16 v[132:133], v10 offset:1024
    v_mfma_f32_16x16x32_bf16 v[210:213], v[146:149], v[114:117], v[210:213]
    v_mfma_f32_16x16x32_bf16 v[206:209], v[146:149], v[110:113], v[206:209]
    v_mfma_f32_16x16x32_bf16 v[202:205], v[146:149], v[106:109], v[202:205]
    v_mfma_f32_16x16x32_bf16 v[198:201], v[146:149], v[102:105], v[198:201]
    v_mfma_f32_16x16x32_bf16 v[32:35], v[28:31], v[134:137], v[32:35]
    v_mfma_f32_16x16x32_bf16 v[36:39], v[28:31], v[138:141], v[36:39]
    s_waitcnt lgkmcnt(0)
    v_mfma_f32_16x16x32_bf16 v[150:153], v[118:121], v[86:89], v[150:153]
    ds_read_b64_tr_b16 v[134:135], v7 offset:8192
    v_mfma_f32_16x16x32_bf16 v[154:157], v[118:121], v[90:93], v[154:157]
    ds_read_b64_tr_b16 v[136:137], v7 offset:9216
    v_mfma_f32_16x16x32_bf16 v[158:161], v[118:121], v[94:97], v[158:161]
    ds_read_b128 v[102:105], v15 offset:0
    v_mfma_f32_16x16x32_bf16 v[162:165], v[118:121], v[98:101], v[162:165]
    ds_read_b128 v[106:109], v15 offset:2048
    v_mfma_f32_16x16x32_bf16 v[178:181], v[122:125], v[98:101], v[178:181]
    ds_read_b128 v[110:113], v15 offset:4096
    v_mfma_f32_16x16x32_bf16 v[174:177], v[122:125], v[94:97], v[174:177]
    ds_read_b128 v[114:117], v15 offset:6144
    v_mfma_f32_16x16x32_bf16 v[170:173], v[122:125], v[90:93], v[170:173]
    ds_read_b64_tr_b16 v[138:139], v8 offset:8192
    v_mfma_f32_16x16x32_bf16 v[166:169], v[122:125], v[86:89], v[166:169]
    ds_read_b64_tr_b16 v[140:141], v8 offset:9216
    v_mfma_f32_16x16x32_bf16 v[182:185], v[126:129], v[86:89], v[182:185]
    ds_read_b64_tr_b16 v[142:143], v9 offset:8192
    v_mfma_f32_16x16x32_bf16 v[186:189], v[126:129], v[90:93], v[186:189]
    ds_read_b64_tr_b16 v[144:145], v9 offset:9216
    v_mfma_f32_16x16x32_bf16 v[190:193], v[126:129], v[94:97], v[190:193]
    ds_read_b64_tr_b16 v[146:147], v10 offset:8192
    v_mfma_f32_16x16x32_bf16 v[194:197], v[126:129], v[98:101], v[194:197]
    ds_read_b64_tr_b16 v[148:149], v10 offset:9216
    v_mfma_f32_16x16x32_bf16 v[210:213], v[130:133], v[98:101], v[210:213]
    v_mfma_f32_16x16x32_bf16 v[206:209], v[130:133], v[94:97], v[206:209]
    v_mfma_f32_16x16x32_bf16 v[202:205], v[130:133], v[90:93], v[202:205]
    v_mfma_f32_16x16x32_bf16 v[198:201], v[130:133], v[86:89], v[198:201]
    v_mfma_f32_16x16x32_bf16 v[32:35], v[28:31], v[118:121], v[32:35]
    v_mfma_f32_16x16x32_bf16 v[36:39], v[28:31], v[122:125], v[36:39]
    s_waitcnt lgkmcnt(0)
    s_barrier
    v_mfma_f32_16x16x32_bf16 v[150:153], v[134:137], v[102:105], v[150:153]
    ds_read_b64_tr_b16 v[118:119], v7 offset:16384
    v_mfma_f32_16x16x32_bf16 v[154:157], v[134:137], v[106:109], v[154:157]
    ds_read_b64_tr_b16 v[120:121], v7 offset:17408
    v_mfma_f32_16x16x32_bf16 v[158:161], v[134:137], v[110:113], v[158:161]
    ds_read_b128 v[86:89], v5 offset:0
    v_mfma_f32_16x16x32_bf16 v[162:165], v[134:137], v[114:117], v[162:165]
    ds_read_b128 v[90:93], v5 offset:2048
    v_mfma_f32_16x16x32_bf16 v[178:181], v[138:141], v[114:117], v[178:181]
    ds_read_b128 v[94:97], v5 offset:4096
    v_mfma_f32_16x16x32_bf16 v[174:177], v[138:141], v[110:113], v[174:177]
    ds_read_b128 v[98:101], v5 offset:6144
    v_mfma_f32_16x16x32_bf16 v[170:173], v[138:141], v[106:109], v[170:173]
    ds_read_b64_tr_b16 v[122:123], v8 offset:16384
    v_mfma_f32_16x16x32_bf16 v[166:169], v[138:141], v[102:105], v[166:169]
    ds_read_b64_tr_b16 v[124:125], v8 offset:17408
    v_mfma_f32_16x16x32_bf16 v[182:185], v[142:145], v[102:105], v[182:185]
    ds_read_b64_tr_b16 v[126:127], v9 offset:16384
    v_mfma_f32_16x16x32_bf16 v[186:189], v[142:145], v[106:109], v[186:189]
    ds_read_b64_tr_b16 v[128:129], v9 offset:17408
    v_mfma_f32_16x16x32_bf16 v[190:193], v[142:145], v[110:113], v[190:193]
    ds_read_b64_tr_b16 v[130:131], v10 offset:16384
    v_mfma_f32_16x16x32_bf16 v[194:197], v[142:145], v[114:117], v[194:197]
    ds_read_b64_tr_b16 v[132:133], v10 offset:17408
    v_mfma_f32_16x16x32_bf16 v[210:213], v[146:149], v[114:117], v[210:213]
    v_mfma_f32_16x16x32_bf16 v[206:209], v[146:149], v[110:113], v[206:209]
    v_mfma_f32_16x16x32_bf16 v[202:205], v[146:149], v[106:109], v[202:205]
    v_mfma_f32_16x16x32_bf16 v[198:201], v[146:149], v[102:105], v[198:201]
    v_mfma_f32_16x16x32_bf16 v[32:35], v[28:31], v[134:137], v[32:35]
    v_mfma_f32_16x16x32_bf16 v[36:39], v[28:31], v[138:141], v[36:39]
    s_waitcnt lgkmcnt(0)
    v_mfma_f32_16x16x32_bf16 v[150:153], v[118:121], v[86:89], v[150:153]
    ds_read_b64_tr_b16 v[134:135], v7 offset:24576
    v_mfma_f32_16x16x32_bf16 v[154:157], v[118:121], v[90:93], v[154:157]
    ds_read_b64_tr_b16 v[136:137], v7 offset:25600
    v_mfma_f32_16x16x32_bf16 v[158:161], v[118:121], v[94:97], v[158:161]
    ds_read_b128 v[102:105], v6 offset:0
    v_mfma_f32_16x16x32_bf16 v[162:165], v[118:121], v[98:101], v[162:165]
    ds_read_b128 v[106:109], v6 offset:2048
    v_mfma_f32_16x16x32_bf16 v[178:181], v[122:125], v[98:101], v[178:181]
    ds_read_b128 v[110:113], v6 offset:4096
    v_mfma_f32_16x16x32_bf16 v[174:177], v[122:125], v[94:97], v[174:177]
    ds_read_b128 v[114:117], v6 offset:6144
    v_mfma_f32_16x16x32_bf16 v[170:173], v[122:125], v[90:93], v[170:173]
    ds_read_b64_tr_b16 v[138:139], v8 offset:24576
    v_mfma_f32_16x16x32_bf16 v[166:169], v[122:125], v[86:89], v[166:169]
    ds_read_b64_tr_b16 v[140:141], v8 offset:25600
    v_mfma_f32_16x16x32_bf16 v[182:185], v[126:129], v[86:89], v[182:185]
    ds_read_b64_tr_b16 v[142:143], v9 offset:24576
    v_mfma_f32_16x16x32_bf16 v[186:189], v[126:129], v[90:93], v[186:189]
    ds_read_b64_tr_b16 v[144:145], v9 offset:25600
    v_mfma_f32_16x16x32_bf16 v[190:193], v[126:129], v[94:97], v[190:193]
    ds_read_b64_tr_b16 v[146:147], v10 offset:24576
    v_mfma_f32_16x16x32_bf16 v[194:197], v[126:129], v[98:101], v[194:197]
    ds_read_b64_tr_b16 v[148:149], v10 offset:25600
    v_mfma_f32_16x16x32_bf16 v[210:213], v[130:133], v[98:101], v[210:213]
    v_mfma_f32_16x16x32_bf16 v[206:209], v[130:133], v[94:97], v[206:209]
    v_mfma_f32_16x16x32_bf16 v[202:205], v[130:133], v[90:93], v[202:205]
    v_mfma_f32_16x16x32_bf16 v[198:201], v[130:133], v[86:89], v[198:201]
    v_mfma_f32_16x16x32_bf16 v[32:35], v[28:31], v[118:121], v[32:35]
    v_mfma_f32_16x16x32_bf16 v[36:39], v[28:31], v[122:125], v[36:39]
    s_waitcnt lgkmcnt(0)
    s_barrier
    v_mfma_f32_16x16x32_bf16 v[150:153], v[134:137], v[102:105], v[150:153]
    ds_read_b64_tr_b16 v[118:119], v7 offset:32768
    v_mfma_f32_16x16x32_bf16 v[154:157], v[134:137], v[106:109], v[154:157]
    ds_read_b64_tr_b16 v[120:121], v7 offset:33792
    v_mfma_f32_16x16x32_bf16 v[158:161], v[134:137], v[110:113], v[158:161]
    ds_read_b128 v[86:89], v5 offset:16384
    v_mfma_f32_16x16x32_bf16 v[162:165], v[134:137], v[114:117], v[162:165]
    ds_read_b128 v[90:93], v5 offset:18432
    v_mfma_f32_16x16x32_bf16 v[178:181], v[138:141], v[114:117], v[178:181]
    ds_read_b128 v[94:97], v5 offset:20480
    v_mfma_f32_16x16x32_bf16 v[174:177], v[138:141], v[110:113], v[174:177]
    ds_read_b128 v[98:101], v5 offset:22528
    v_mfma_f32_16x16x32_bf16 v[170:173], v[138:141], v[106:109], v[170:173]
    ds_read_b64_tr_b16 v[122:123], v8 offset:32768
    v_mfma_f32_16x16x32_bf16 v[166:169], v[138:141], v[102:105], v[166:169]
    ds_read_b64_tr_b16 v[124:125], v8 offset:33792
    v_mfma_f32_16x16x32_bf16 v[182:185], v[142:145], v[102:105], v[182:185]
    ds_read_b64_tr_b16 v[126:127], v9 offset:32768
    v_mfma_f32_16x16x32_bf16 v[186:189], v[142:145], v[106:109], v[186:189]
    ds_read_b64_tr_b16 v[128:129], v9 offset:33792
    v_mfma_f32_16x16x32_bf16 v[190:193], v[142:145], v[110:113], v[190:193]
    ds_read_b64_tr_b16 v[130:131], v10 offset:32768
    v_mfma_f32_16x16x32_bf16 v[194:197], v[142:145], v[114:117], v[194:197]
    ds_read_b64_tr_b16 v[132:133], v10 offset:33792
    v_mfma_f32_16x16x32_bf16 v[210:213], v[146:149], v[114:117], v[210:213]
    v_mfma_f32_16x16x32_bf16 v[206:209], v[146:149], v[110:113], v[206:209]
    v_mfma_f32_16x16x32_bf16 v[202:205], v[146:149], v[106:109], v[202:205]
    v_mfma_f32_16x16x32_bf16 v[198:201], v[146:149], v[102:105], v[198:201]
    v_mfma_f32_16x16x32_bf16 v[32:35], v[28:31], v[134:137], v[32:35]
    v_mfma_f32_16x16x32_bf16 v[36:39], v[28:31], v[138:141], v[36:39]
    s_waitcnt lgkmcnt(0)
    v_mfma_f32_16x16x32_bf16 v[150:153], v[118:121], v[86:89], v[150:153]
    ds_read_b64_tr_b16 v[134:135], v7 offset:40960
    v_mfma_f32_16x16x32_bf16 v[154:157], v[118:121], v[90:93], v[154:157]
    ds_read_b64_tr_b16 v[136:137], v7 offset:41984
    v_mfma_f32_16x16x32_bf16 v[158:161], v[118:121], v[94:97], v[158:161]
    ds_read_b128 v[102:105], v6 offset:16384
    v_mfma_f32_16x16x32_bf16 v[162:165], v[118:121], v[98:101], v[162:165]
    ds_read_b128 v[106:109], v6 offset:18432
    v_mfma_f32_16x16x32_bf16 v[178:181], v[122:125], v[98:101], v[178:181]
    ds_read_b128 v[110:113], v6 offset:20480
    v_mfma_f32_16x16x32_bf16 v[174:177], v[122:125], v[94:97], v[174:177]
    ds_read_b128 v[114:117], v6 offset:22528
    v_mfma_f32_16x16x32_bf16 v[170:173], v[122:125], v[90:93], v[170:173]
    ds_read_b64_tr_b16 v[138:139], v8 offset:40960
    v_mfma_f32_16x16x32_bf16 v[166:169], v[122:125], v[86:89], v[166:169]
    ds_read_b64_tr_b16 v[140:141], v8 offset:41984
    v_mfma_f32_16x16x32_bf16 v[182:185], v[126:129], v[86:89], v[182:185]
    ds_read_b64_tr_b16 v[142:143], v9 offset:40960
    v_mfma_f32_16x16x32_bf16 v[186:189], v[126:129], v[90:93], v[186:189]
    ds_read_b64_tr_b16 v[144:145], v9 offset:41984
    v_mfma_f32_16x16x32_bf16 v[190:193], v[126:129], v[94:97], v[190:193]
    ds_read_b64_tr_b16 v[146:147], v10 offset:40960
    v_mfma_f32_16x16x32_bf16 v[194:197], v[126:129], v[98:101], v[194:197]
    ds_read_b64_tr_b16 v[148:149], v10 offset:41984
    v_mfma_f32_16x16x32_bf16 v[210:213], v[130:133], v[98:101], v[210:213]
    v_mfma_f32_16x16x32_bf16 v[206:209], v[130:133], v[94:97], v[206:209]
    v_mfma_f32_16x16x32_bf16 v[202:205], v[130:133], v[90:93], v[202:205]
    v_mfma_f32_16x16x32_bf16 v[198:201], v[130:133], v[86:89], v[198:201]
    v_mfma_f32_16x16x32_bf16 v[32:35], v[28:31], v[118:121], v[32:35]
    v_mfma_f32_16x16x32_bf16 v[36:39], v[28:31], v[122:125], v[36:39]
    s_waitcnt lgkmcnt(0)
    s_barrier
    v_mfma_f32_16x16x32_bf16 v[150:153], v[134:137], v[102:105], v[150:153]
    ds_read_b64_tr_b16 v[118:119], v7 offset:49152
    v_mfma_f32_16x16x32_bf16 v[154:157], v[134:137], v[106:109], v[154:157]
    ds_read_b64_tr_b16 v[120:121], v7 offset:50176
    v_mfma_f32_16x16x32_bf16 v[158:161], v[134:137], v[110:113], v[158:161]
    ds_read_b128 v[86:89], v5 offset:32768
    v_mfma_f32_16x16x32_bf16 v[162:165], v[134:137], v[114:117], v[162:165]
    ds_read_b128 v[90:93], v5 offset:34816
    v_mfma_f32_16x16x32_bf16 v[178:181], v[138:141], v[114:117], v[178:181]
    ds_read_b128 v[94:97], v5 offset:36864
    v_mfma_f32_16x16x32_bf16 v[174:177], v[138:141], v[110:113], v[174:177]
    ds_read_b128 v[98:101], v5 offset:38912
    v_mfma_f32_16x16x32_bf16 v[170:173], v[138:141], v[106:109], v[170:173]
    ds_read_b64_tr_b16 v[122:123], v8 offset:49152
    v_mfma_f32_16x16x32_bf16 v[166:169], v[138:141], v[102:105], v[166:169]
    ds_read_b64_tr_b16 v[124:125], v8 offset:50176
    v_mfma_f32_16x16x32_bf16 v[182:185], v[142:145], v[102:105], v[182:185]
    ds_read_b64_tr_b16 v[126:127], v9 offset:49152
    v_mfma_f32_16x16x32_bf16 v[186:189], v[142:145], v[106:109], v[186:189]
    ds_read_b64_tr_b16 v[128:129], v9 offset:50176
    v_mfma_f32_16x16x32_bf16 v[190:193], v[142:145], v[110:113], v[190:193]
    ds_read_b64_tr_b16 v[130:131], v10 offset:49152
    v_mfma_f32_16x16x32_bf16 v[194:197], v[142:145], v[114:117], v[194:197]
    ds_read_b64_tr_b16 v[132:133], v10 offset:50176
    v_mfma_f32_16x16x32_bf16 v[210:213], v[146:149], v[114:117], v[210:213]
    v_mfma_f32_16x16x32_bf16 v[206:209], v[146:149], v[110:113], v[206:209]
    v_mfma_f32_16x16x32_bf16 v[202:205], v[146:149], v[106:109], v[202:205]
    v_mfma_f32_16x16x32_bf16 v[198:201], v[146:149], v[102:105], v[198:201]
    v_mfma_f32_16x16x32_bf16 v[32:35], v[28:31], v[134:137], v[32:35]
    v_mfma_f32_16x16x32_bf16 v[36:39], v[28:31], v[138:141], v[36:39]
    s_waitcnt lgkmcnt(0)
    v_mfma_f32_16x16x32_bf16 v[150:153], v[118:121], v[86:89], v[150:153]
    ds_read_b64_tr_b16 v[134:135], v7 offset:57344
    v_mfma_f32_16x16x32_bf16 v[154:157], v[118:121], v[90:93], v[154:157]
    ds_read_b64_tr_b16 v[136:137], v7 offset:58368
    v_mfma_f32_16x16x32_bf16 v[158:161], v[118:121], v[94:97], v[158:161]
    ds_read_b128 v[102:105], v6 offset:32768
    v_mfma_f32_16x16x32_bf16 v[162:165], v[118:121], v[98:101], v[162:165]
    ds_read_b128 v[106:109], v6 offset:34816
    v_mfma_f32_16x16x32_bf16 v[178:181], v[122:125], v[98:101], v[178:181]
    ds_read_b128 v[110:113], v6 offset:36864
    v_mfma_f32_16x16x32_bf16 v[174:177], v[122:125], v[94:97], v[174:177]
    ds_read_b128 v[114:117], v6 offset:38912
    v_mfma_f32_16x16x32_bf16 v[170:173], v[122:125], v[90:93], v[170:173]
    ds_read_b64_tr_b16 v[138:139], v8 offset:57344
    v_mfma_f32_16x16x32_bf16 v[166:169], v[122:125], v[86:89], v[166:169]
    ds_read_b64_tr_b16 v[140:141], v8 offset:58368
    v_mfma_f32_16x16x32_bf16 v[182:185], v[126:129], v[86:89], v[182:185]
    ds_read_b64_tr_b16 v[142:143], v9 offset:57344
    v_mfma_f32_16x16x32_bf16 v[186:189], v[126:129], v[90:93], v[186:189]
    ds_read_b64_tr_b16 v[144:145], v9 offset:58368
    v_mfma_f32_16x16x32_bf16 v[190:193], v[126:129], v[94:97], v[190:193]
    ds_read_b64_tr_b16 v[146:147], v10 offset:57344
    v_mfma_f32_16x16x32_bf16 v[194:197], v[126:129], v[98:101], v[194:197]
    ds_read_b64_tr_b16 v[148:149], v10 offset:58368
    v_mfma_f32_16x16x32_bf16 v[210:213], v[130:133], v[98:101], v[210:213]
    v_mfma_f32_16x16x32_bf16 v[206:209], v[130:133], v[94:97], v[206:209]
    v_mfma_f32_16x16x32_bf16 v[202:205], v[130:133], v[90:93], v[202:205]
    v_mfma_f32_16x16x32_bf16 v[198:201], v[130:133], v[86:89], v[198:201]
    v_mfma_f32_16x16x32_bf16 v[32:35], v[28:31], v[118:121], v[32:35]
    v_mfma_f32_16x16x32_bf16 v[36:39], v[28:31], v[122:125], v[36:39]
    s_waitcnt lgkmcnt(0)
    s_barrier
    v_mfma_f32_16x16x32_bf16 v[150:153], v[134:137], v[102:105], v[150:153]
    ds_read_b64_tr_b16 v[118:119], v7 offset:0
    v_mfma_f32_16x16x32_bf16 v[154:157], v[134:137], v[106:109], v[154:157]
    ds_read_b64_tr_b16 v[120:121], v7 offset:1024
    v_mfma_f32_16x16x32_bf16 v[158:161], v[134:137], v[110:113], v[158:161]
    ds_read_b128 v[86:89], v5 offset:49152
    v_mfma_f32_16x16x32_bf16 v[162:165], v[134:137], v[114:117], v[162:165]
    ds_read_b128 v[90:93], v5 offset:51200
    v_mfma_f32_16x16x32_bf16 v[178:181], v[138:141], v[114:117], v[178:181]
    ds_read_b128 v[94:97], v5 offset:53248
    v_mfma_f32_16x16x32_bf16 v[174:177], v[138:141], v[110:113], v[174:177]
    ds_read_b128 v[98:101], v5 offset:55296
    v_mfma_f32_16x16x32_bf16 v[170:173], v[138:141], v[106:109], v[170:173]
    ds_read_b64_tr_b16 v[122:123], v8 offset:0
    v_mfma_f32_16x16x32_bf16 v[166:169], v[138:141], v[102:105], v[166:169]
    ds_read_b64_tr_b16 v[124:125], v8 offset:1024
    v_mfma_f32_16x16x32_bf16 v[182:185], v[142:145], v[102:105], v[182:185]
    ds_read_b64_tr_b16 v[126:127], v9 offset:0
    v_mfma_f32_16x16x32_bf16 v[186:189], v[142:145], v[106:109], v[186:189]
    ds_read_b64_tr_b16 v[128:129], v9 offset:1024
    v_mfma_f32_16x16x32_bf16 v[190:193], v[142:145], v[110:113], v[190:193]
    ds_read_b64_tr_b16 v[130:131], v10 offset:0
    v_mfma_f32_16x16x32_bf16 v[194:197], v[142:145], v[114:117], v[194:197]
    ds_read_b64_tr_b16 v[132:133], v10 offset:1024
    v_mfma_f32_16x16x32_bf16 v[210:213], v[146:149], v[114:117], v[210:213]
    v_mfma_f32_16x16x32_bf16 v[206:209], v[146:149], v[110:113], v[206:209]
    v_mfma_f32_16x16x32_bf16 v[202:205], v[146:149], v[106:109], v[202:205]
    v_mfma_f32_16x16x32_bf16 v[198:201], v[146:149], v[102:105], v[198:201]
    v_mfma_f32_16x16x32_bf16 v[32:35], v[28:31], v[134:137], v[32:35]
    v_mfma_f32_16x16x32_bf16 v[36:39], v[28:31], v[138:141], v[36:39]
    s_waitcnt lgkmcnt(0)
    v_mfma_f32_16x16x32_bf16 v[150:153], v[118:121], v[86:89], v[150:153]
    ds_read_b64_tr_b16 v[134:135], v7 offset:8192
    v_mfma_f32_16x16x32_bf16 v[154:157], v[118:121], v[90:93], v[154:157]
    ds_read_b64_tr_b16 v[136:137], v7 offset:9216
    v_mfma_f32_16x16x32_bf16 v[158:161], v[118:121], v[94:97], v[158:161]
    ds_read_b128 v[102:105], v6 offset:49152
    v_mfma_f32_16x16x32_bf16 v[162:165], v[118:121], v[98:101], v[162:165]
    ds_read_b128 v[106:109], v6 offset:51200
    v_mfma_f32_16x16x32_bf16 v[178:181], v[122:125], v[98:101], v[178:181]
    ds_read_b128 v[110:113], v6 offset:53248
    v_mfma_f32_16x16x32_bf16 v[174:177], v[122:125], v[94:97], v[174:177]
    ds_read_b128 v[114:117], v6 offset:55296
    v_mfma_f32_16x16x32_bf16 v[170:173], v[122:125], v[90:93], v[170:173]
    ds_read_b64_tr_b16 v[138:139], v8 offset:8192
    v_mfma_f32_16x16x32_bf16 v[166:169], v[122:125], v[86:89], v[166:169]
    ds_read_b64_tr_b16 v[140:141], v8 offset:9216
    v_mfma_f32_16x16x32_bf16 v[182:185], v[126:129], v[86:89], v[182:185]
    ds_read_b64_tr_b16 v[142:143], v9 offset:8192
    v_mfma_f32_16x16x32_bf16 v[186:189], v[126:129], v[90:93], v[186:189]
    ds_read_b64_tr_b16 v[144:145], v9 offset:9216
    v_mfma_f32_16x16x32_bf16 v[190:193], v[126:129], v[94:97], v[190:193]
    ds_read_b64_tr_b16 v[146:147], v10 offset:8192
    v_mfma_f32_16x16x32_bf16 v[194:197], v[126:129], v[98:101], v[194:197]
    ds_read_b64_tr_b16 v[148:149], v10 offset:9216
    v_mfma_f32_16x16x32_bf16 v[210:213], v[130:133], v[98:101], v[210:213]
    v_mfma_f32_16x16x32_bf16 v[206:209], v[130:133], v[94:97], v[206:209]
    v_mfma_f32_16x16x32_bf16 v[202:205], v[130:133], v[90:93], v[202:205]
    v_mfma_f32_16x16x32_bf16 v[198:201], v[130:133], v[86:89], v[198:201]
    v_mfma_f32_16x16x32_bf16 v[32:35], v[28:31], v[118:121], v[32:35]
    v_mfma_f32_16x16x32_bf16 v[36:39], v[28:31], v[122:125], v[36:39]
    s_waitcnt lgkmcnt(0)
    s_barrier
    v_mfma_f32_16x16x32_bf16 v[150:153], v[134:137], v[102:105], v[150:153]
    ds_read_b64_tr_b16 v[118:119], v7 offset:16384
    v_mfma_f32_16x16x32_bf16 v[154:157], v[134:137], v[106:109], v[154:157]
    ds_read_b64_tr_b16 v[120:121], v7 offset:17408
    v_mfma_f32_16x16x32_bf16 v[158:161], v[134:137], v[110:113], v[158:161]
    ds_read_b128 v[86:89], v14 offset:0
    v_mfma_f32_16x16x32_bf16 v[162:165], v[134:137], v[114:117], v[162:165]
    ds_read_b128 v[90:93], v14 offset:2048
    v_mfma_f32_16x16x32_bf16 v[178:181], v[138:141], v[114:117], v[178:181]
    ds_read_b128 v[94:97], v14 offset:4096
    v_mfma_f32_16x16x32_bf16 v[174:177], v[138:141], v[110:113], v[174:177]
    ds_read_b128 v[98:101], v14 offset:6144
    v_mfma_f32_16x16x32_bf16 v[170:173], v[138:141], v[106:109], v[170:173]
    ds_read_b64_tr_b16 v[122:123], v8 offset:16384
    v_mfma_f32_16x16x32_bf16 v[166:169], v[138:141], v[102:105], v[166:169]
    ds_read_b64_tr_b16 v[124:125], v8 offset:17408
    v_mfma_f32_16x16x32_bf16 v[182:185], v[142:145], v[102:105], v[182:185]
    ds_read_b64_tr_b16 v[126:127], v9 offset:16384
    v_mfma_f32_16x16x32_bf16 v[186:189], v[142:145], v[106:109], v[186:189]
    ds_read_b64_tr_b16 v[128:129], v9 offset:17408
    v_mfma_f32_16x16x32_bf16 v[190:193], v[142:145], v[110:113], v[190:193]
    ds_read_b64_tr_b16 v[130:131], v10 offset:16384
    v_mfma_f32_16x16x32_bf16 v[194:197], v[142:145], v[114:117], v[194:197]
    ds_read_b64_tr_b16 v[132:133], v10 offset:17408
    v_mfma_f32_16x16x32_bf16 v[210:213], v[146:149], v[114:117], v[210:213]
    v_mfma_f32_16x16x32_bf16 v[206:209], v[146:149], v[110:113], v[206:209]
    v_mfma_f32_16x16x32_bf16 v[202:205], v[146:149], v[106:109], v[202:205]
    v_mfma_f32_16x16x32_bf16 v[198:201], v[146:149], v[102:105], v[198:201]
    v_mfma_f32_16x16x32_bf16 v[32:35], v[28:31], v[134:137], v[32:35]
    v_mfma_f32_16x16x32_bf16 v[36:39], v[28:31], v[138:141], v[36:39]
    s_waitcnt lgkmcnt(0)
    v_mfma_f32_16x16x32_bf16 v[150:153], v[118:121], v[86:89], v[150:153]
    ds_read_b64_tr_b16 v[134:135], v7 offset:24576
    v_mfma_f32_16x16x32_bf16 v[154:157], v[118:121], v[90:93], v[154:157]
    ds_read_b64_tr_b16 v[136:137], v7 offset:25600
    v_mfma_f32_16x16x32_bf16 v[158:161], v[118:121], v[94:97], v[158:161]
    ds_read_b128 v[102:105], v15 offset:0
    v_mfma_f32_16x16x32_bf16 v[162:165], v[118:121], v[98:101], v[162:165]
    ds_read_b128 v[106:109], v15 offset:2048
    v_mfma_f32_16x16x32_bf16 v[178:181], v[122:125], v[98:101], v[178:181]
    ds_read_b128 v[110:113], v15 offset:4096
    v_mfma_f32_16x16x32_bf16 v[174:177], v[122:125], v[94:97], v[174:177]
    ds_read_b128 v[114:117], v15 offset:6144
    v_mfma_f32_16x16x32_bf16 v[170:173], v[122:125], v[90:93], v[170:173]
    ds_read_b64_tr_b16 v[138:139], v8 offset:24576
    v_mfma_f32_16x16x32_bf16 v[166:169], v[122:125], v[86:89], v[166:169]
    ds_read_b64_tr_b16 v[140:141], v8 offset:25600
    v_mfma_f32_16x16x32_bf16 v[182:185], v[126:129], v[86:89], v[182:185]
    ds_read_b64_tr_b16 v[142:143], v9 offset:24576
    v_mfma_f32_16x16x32_bf16 v[186:189], v[126:129], v[90:93], v[186:189]
    ds_read_b64_tr_b16 v[144:145], v9 offset:25600
    v_mfma_f32_16x16x32_bf16 v[190:193], v[126:129], v[94:97], v[190:193]
    ds_read_b64_tr_b16 v[146:147], v10 offset:24576
    v_mfma_f32_16x16x32_bf16 v[194:197], v[126:129], v[98:101], v[194:197]
    ds_read_b64_tr_b16 v[148:149], v10 offset:25600
    v_mfma_f32_16x16x32_bf16 v[210:213], v[130:133], v[98:101], v[210:213]
    v_mfma_f32_16x16x32_bf16 v[206:209], v[130:133], v[94:97], v[206:209]
    v_mfma_f32_16x16x32_bf16 v[202:205], v[130:133], v[90:93], v[202:205]
    v_mfma_f32_16x16x32_bf16 v[198:201], v[130:133], v[86:89], v[198:201]
    v_mfma_f32_16x16x32_bf16 v[32:35], v[28:31], v[118:121], v[32:35]
    v_mfma_f32_16x16x32_bf16 v[36:39], v[28:31], v[122:125], v[36:39]
    s_waitcnt lgkmcnt(0)
    s_barrier
    v_mfma_f32_16x16x32_bf16 v[32:35], v[28:31], v[134:137], v[32:35]
    v_mfma_f32_16x16x32_bf16 v[36:39], v[28:31], v[138:141], v[36:39]
    v_mfma_f32_16x16x32_bf16 v[150:153], v[134:137], v[102:105], v[150:153]
    v_mfma_f32_16x16x32_bf16 v[154:157], v[134:137], v[106:109], v[154:157]
    v_mfma_f32_16x16x32_bf16 v[158:161], v[134:137], v[110:113], v[158:161]
    v_mfma_f32_16x16x32_bf16 v[162:165], v[134:137], v[114:117], v[162:165]
    v_mfma_f32_16x16x32_bf16 v[178:181], v[138:141], v[114:117], v[178:181]
    v_mfma_f32_16x16x32_bf16 v[174:177], v[138:141], v[110:113], v[174:177]
    v_mfma_f32_16x16x32_bf16 v[170:173], v[138:141], v[106:109], v[170:173]
    v_mfma_f32_16x16x32_bf16 v[166:169], v[138:141], v[102:105], v[166:169]
    v_mfma_f32_16x16x32_bf16 v[182:185], v[142:145], v[102:105], v[182:185]
    v_mfma_f32_16x16x32_bf16 v[186:189], v[142:145], v[106:109], v[186:189]
    v_mfma_f32_16x16x32_bf16 v[190:193], v[142:145], v[110:113], v[190:193]
    v_mfma_f32_16x16x32_bf16 v[194:197], v[142:145], v[114:117], v[194:197]
    v_mfma_f32_16x16x32_bf16 v[210:213], v[146:149], v[114:117], v[210:213]
    v_mfma_f32_16x16x32_bf16 v[206:209], v[146:149], v[110:113], v[206:209]
    v_mfma_f32_16x16x32_bf16 v[202:205], v[146:149], v[106:109], v[202:205]
    v_mfma_f32_16x16x32_bf16 v[198:201], v[146:149], v[102:105], v[198:201]
    s_mov_b64 exec, 0xffff
    ds_write_b32 v11, v32 offset:0
    ds_write_b32 v11, v36 offset:64
    s_mov_b64 exec, -1
    s_add_u32 m0, s50, 114688
    s_mul_i32 s16, s62, 221184
    buffer_load_dwordx4 v16, s[4:7], s16 offen offset:0 lds
    buffer_load_dwordx4 v17, s[4:7], s16 offen offset:1024 lds
    buffer_load_dwordx4 v18, s[4:7], s16 offen offset:2048 lds
    buffer_load_dwordx4 v19, s[4:7], s16 offen offset:3072 lds
    s_add_u32 s62, s62, 1
    s_cmp_eq_u32 s62, 10
    s_cselect_b32 s62, 0, s62
    s_waitcnt lgkmcnt(0)
    s_barrier
    s_add_u32 m0, s50, 131072
    s_mul_i32 s16, s62, 221184
    buffer_load_dwordx4 v16, s[4:7], s16 offen offset:0 lds
    buffer_load_dwordx4 v17, s[4:7], s16 offen offset:1024 lds
    buffer_load_dwordx4 v18, s[4:7], s16 offen offset:2048 lds
    buffer_load_dwordx4 v19, s[4:7], s16 offen offset:3072 lds
    s_add_u32 s62, s62, 1
    s_cmp_eq_u32 s62, 10
    s_cselect_b32 s62, 0, s62
    s_add_u32 m0, s50, 16384
    s_lshl_b32 s51, s17, 7
    buffer_load_dwordx4 v1, s[8:11], s51 offen offset:0 lds
    buffer_load_dwordx4 v2, s[8:11], s51 offen offset:1024 lds
    buffer_load_dwordx4 v3, s[8:11], s51 offen offset:2048 lds
    buffer_load_dwordx4 v4, s[8:11], s51 offen offset:3072 lds
    s_add_u32 s17, s17, 1
    s_cmp_eq_u32 s17, 10
    s_cselect_b32 s17, 0, s17
    v_and_b32 v26, 15, v0
    s_lshl_b32 s49, s44, 8
    v_lshl_add_u32 v26, v26, 2, s49
    ds_read_b32 v76, v26 offset:0
    ds_read_b32 v77, v26 offset:512
    ds_read_b32 v78, v26 offset:64
    ds_read_b32 v79, v26 offset:576
    ds_read_b32 v80, v26 offset:128
    ds_read_b32 v81, v26 offset:640
    ds_read_b32 v82, v26 offset:192
    ds_read_b32 v83, v26 offset:704
    v_lshrrev_b32 v27, 4, v0
    v_lshl_add_u32 v27, v27, 4, s59
    v_xor_b32 v26, 128, v27
    ds_read_b128 v[118:121], v27 offset:0
    ds_read_b128 v[122:125], v27 offset:64
    ds_read_b128 v[126:129], v26 offset:0
    ds_read_b128 v[130:133], v26 offset:64
    s_cmp_eq_u32 s55, 0
    s_cselect_b32 s58, 0x3ea52b5c, 1.0
    s_waitcnt lgkmcnt(0)
    v_mul_f32 v77, s58, v77
    v_mul_f32 v79, s58, v79
    v_mul_f32 v81, s58, v81
    v_mul_f32 v83, s58, v83
    v_mov_b32 v13, 4032
    ds_read_b32 v13, v13
    v_fmac_f32 v150, v118, v76
    v_fmac_f32 v151, v119, v76
    v_fmac_f32 v152, v120, v76
    v_fmac_f32 v153, v121, v76
    v_fmac_f32 v166, v122, v76
    v_fmac_f32 v167, v123, v76
    v_fmac_f32 v168, v124, v76
    v_fmac_f32 v169, v125, v76
    v_mul_f32 v150, v150, v77
    v_mul_f32 v151, v151, v77
    v_mul_f32 v152, v152, v77
    v_mul_f32 v153, v153, v77
    v_mul_f32 v166, v166, v77
    v_mul_f32 v167, v167, v77
    v_mul_f32 v168, v168, v77
    v_mul_f32 v169, v169, v77
    v_cvt_pk_bf16_f32 v214, v150, v151
    v_cvt_pk_bf16_f32 v215, v152, v153
    v_cvt_pk_bf16_f32 v216, v166, v167
    v_cvt_pk_bf16_f32 v217, v168, v169
    s_nop 1
    v_permlane16_swap_b32 v214, v216
    v_permlane16_swap_b32 v215, v217
    s_waitcnt vmcnt(4)
    s_barrier
    s_add_u32 m0, s50, 147456
    s_mul_i32 s16, s62, 221184
    buffer_load_dwordx4 v16, s[4:7], s16 offen offset:0 lds
    buffer_load_dwordx4 v17, s[4:7], s16 offen offset:1024 lds
    buffer_load_dwordx4 v18, s[4:7], s16 offen offset:2048 lds
    buffer_load_dwordx4 v19, s[4:7], s16 offen offset:3072 lds
    s_add_u32 s62, s62, 1
    s_cmp_eq_u32 s62, 10
    s_cselect_b32 s62, 0, s62
    s_add_u32 m0, s50, 32768
    s_lshl_b32 s51, s17, 7
    buffer_load_dwordx4 v1, s[8:11], s51 offen offset:0 lds
    buffer_load_dwordx4 v2, s[8:11], s51 offen offset:1024 lds
    buffer_load_dwordx4 v3, s[8:11], s51 offen offset:2048 lds
    buffer_load_dwordx4 v4, s[8:11], s51 offen offset:3072 lds
    s_add_u32 s17, s17, 1
    s_cmp_eq_u32 s17, 10
    s_cselect_b32 s17, 0, s17
    buffer_store_dwordx4 v[214:217], v72, s[20:23], 0 offen offset:0 sc1
    v_fmac_f32 v154, v118, v78
    v_fmac_f32 v155, v119, v78
    v_fmac_f32 v156, v120, v78
    v_fmac_f32 v157, v121, v78
    v_fmac_f32 v170, v122, v78
    v_fmac_f32 v171, v123, v78
    v_fmac_f32 v172, v124, v78
    v_fmac_f32 v173, v125, v78
    v_mul_f32 v154, v154, v79
    v_mul_f32 v155, v155, v79
    v_mul_f32 v156, v156, v79
    v_mul_f32 v157, v157, v79
    v_mul_f32 v170, v170, v79
    v_mul_f32 v171, v171, v79
    v_mul_f32 v172, v172, v79
    v_mul_f32 v173, v173, v79
    v_cvt_pk_bf16_f32 v218, v154, v155
    v_cvt_pk_bf16_f32 v219, v156, v157
    v_cvt_pk_bf16_f32 v220, v170, v171
    v_cvt_pk_bf16_f32 v221, v172, v173
    s_nop 1
    v_permlane16_swap_b32 v218, v220
    v_permlane16_swap_b32 v219, v221
    buffer_store_dwordx4 v[218:221], v72, s[20:23], 0 offen offset:256 sc1
    v_fmac_f32 v158, v118, v80
    v_fmac_f32 v159, v119, v80
    v_fmac_f32 v160, v120, v80
    v_fmac_f32 v161, v121, v80
    v_fmac_f32 v174, v122, v80
    v_fmac_f32 v175, v123, v80
    v_fmac_f32 v176, v124, v80
    v_fmac_f32 v177, v125, v80
    v_mul_f32 v158, v158, v81
    v_mul_f32 v159, v159, v81
    v_mul_f32 v160, v160, v81
    v_mul_f32 v161, v161, v81
    v_mul_f32 v174, v174, v81
    v_mul_f32 v175, v175, v81
    v_mul_f32 v176, v176, v81
    v_mul_f32 v177, v177, v81
    v_cvt_pk_bf16_f32 v222, v158, v159
    v_cvt_pk_bf16_f32 v223, v160, v161
    v_cvt_pk_bf16_f32 v224, v174, v175
    v_cvt_pk_bf16_f32 v225, v176, v177
    s_nop 1
    v_permlane16_swap_b32 v222, v224
    v_permlane16_swap_b32 v223, v225
    buffer_store_dwordx4 v[222:225], v73, s[20:23], 0 offen offset:0 sc1
    v_fmac_f32 v162, v118, v82
    v_fmac_f32 v163, v119, v82
    v_fmac_f32 v164, v120, v82
    v_fmac_f32 v165, v121, v82
    v_fmac_f32 v178, v122, v82
    v_fmac_f32 v179, v123, v82
    v_fmac_f32 v180, v124, v82
    v_fmac_f32 v181, v125, v82
    v_mul_f32 v162, v162, v83
    v_mul_f32 v163, v163, v83
    v_mul_f32 v164, v164, v83
    v_mul_f32 v165, v165, v83
    v_mul_f32 v178, v178, v83
    v_mul_f32 v179, v179, v83
    v_mul_f32 v180, v180, v83
    v_mul_f32 v181, v181, v83
    v_cvt_pk_bf16_f32 v226, v162, v163
    v_cvt_pk_bf16_f32 v227, v164, v165
    v_cvt_pk_bf16_f32 v228, v178, v179
    v_cvt_pk_bf16_f32 v229, v180, v181
    s_nop 1
    v_permlane16_swap_b32 v226, v228
    v_permlane16_swap_b32 v227, v229
    buffer_store_dwordx4 v[226:229], v73, s[20:23], 0 offen offset:256 sc1
    v_fmac_f32 v182, v126, v76
    v_fmac_f32 v183, v127, v76
    v_fmac_f32 v184, v128, v76
    v_fmac_f32 v185, v129, v76
    v_fmac_f32 v198, v130, v76
    v_fmac_f32 v199, v131, v76
    v_fmac_f32 v200, v132, v76
    v_fmac_f32 v201, v133, v76
    v_mul_f32 v182, v182, v77
    v_mul_f32 v183, v183, v77
    v_mul_f32 v184, v184, v77
    v_mul_f32 v185, v185, v77
    v_mul_f32 v198, v198, v77
    v_mul_f32 v199, v199, v77
    v_mul_f32 v200, v200, v77
    v_mul_f32 v201, v201, v77
    v_cvt_pk_bf16_f32 v230, v182, v183
    v_cvt_pk_bf16_f32 v231, v184, v185
    v_cvt_pk_bf16_f32 v232, v198, v199
    v_cvt_pk_bf16_f32 v233, v200, v201
    s_nop 1
    v_permlane16_swap_b32 v230, v232
    v_permlane16_swap_b32 v231, v233
    buffer_store_dwordx4 v[230:233], v74, s[20:23], 0 offen offset:0 sc1
    v_fmac_f32 v186, v126, v78
    v_fmac_f32 v187, v127, v78
    v_fmac_f32 v188, v128, v78
    v_fmac_f32 v189, v129, v78
    v_fmac_f32 v202, v130, v78
    v_fmac_f32 v203, v131, v78
    v_fmac_f32 v204, v132, v78
    v_fmac_f32 v205, v133, v78
    v_mul_f32 v186, v186, v79
    v_mul_f32 v187, v187, v79
    v_mul_f32 v188, v188, v79
    v_mul_f32 v189, v189, v79
    v_mul_f32 v202, v202, v79
    v_mul_f32 v203, v203, v79
    v_mul_f32 v204, v204, v79
    v_mul_f32 v205, v205, v79
    v_cvt_pk_bf16_f32 v234, v186, v187
    v_cvt_pk_bf16_f32 v235, v188, v189
    v_cvt_pk_bf16_f32 v236, v202, v203
    v_cvt_pk_bf16_f32 v237, v204, v205
    s_nop 1
    v_permlane16_swap_b32 v234, v236
    v_permlane16_swap_b32 v235, v237
    buffer_store_dwordx4 v[234:237], v74, s[20:23], 0 offen offset:256 sc1
    v_fmac_f32 v190, v126, v80
    v_fmac_f32 v191, v127, v80
    v_fmac_f32 v192, v128, v80
    v_fmac_f32 v193, v129, v80
    v_fmac_f32 v206, v130, v80
    v_fmac_f32 v207, v131, v80
    v_fmac_f32 v208, v132, v80
    v_fmac_f32 v209, v133, v80
    v_mul_f32 v190, v190, v81
    v_mul_f32 v191, v191, v81
    v_mul_f32 v192, v192, v81
    v_mul_f32 v193, v193, v81
    v_mul_f32 v206, v206, v81
    v_mul_f32 v207, v207, v81
    v_mul_f32 v208, v208, v81
    v_mul_f32 v209, v209, v81
    v_cvt_pk_bf16_f32 v238, v190, v191
    v_cvt_pk_bf16_f32 v239, v192, v193
    v_cvt_pk_bf16_f32 v240, v206, v207
    v_cvt_pk_bf16_f32 v241, v208, v209
    s_nop 1
    v_permlane16_swap_b32 v238, v240
    v_permlane16_swap_b32 v239, v241
    buffer_store_dwordx4 v[238:241], v75, s[20:23], 0 offen offset:0 sc1
    v_fmac_f32 v194, v126, v82
    v_fmac_f32 v195, v127, v82
    v_fmac_f32 v196, v128, v82
    v_fmac_f32 v197, v129, v82
    v_fmac_f32 v210, v130, v82
    v_fmac_f32 v211, v131, v82
    v_fmac_f32 v212, v132, v82
    v_fmac_f32 v213, v133, v82
    v_mul_f32 v194, v194, v83
    v_mul_f32 v195, v195, v83
    v_mul_f32 v196, v196, v83
    v_mul_f32 v197, v197, v83
    v_mul_f32 v210, v210, v83
    v_mul_f32 v211, v211, v83
    v_mul_f32 v212, v212, v83
    v_mul_f32 v213, v213, v83
    v_cvt_pk_bf16_f32 v242, v194, v195
    v_cvt_pk_bf16_f32 v243, v196, v197
    v_cvt_pk_bf16_f32 v244, v210, v211
    v_cvt_pk_bf16_f32 v245, v212, v213
    s_nop 1
    v_permlane16_swap_b32 v242, v244
    v_permlane16_swap_b32 v243, v245
    buffer_store_dwordx4 v[242:245], v75, s[20:23], 0 offen offset:256 sc1
    s_waitcnt vmcnt(12)
    s_barrier
    s_add_u32 m0, s50, 98304
    s_mul_i32 s16, s62, 221184
    buffer_load_dwordx4 v16, s[4:7], s16 offen offset:0 lds
    buffer_load_dwordx4 v17, s[4:7], s16 offen offset:1024 lds
    buffer_load_dwordx4 v18, s[4:7], s16 offen offset:2048 lds
    buffer_load_dwordx4 v19, s[4:7], s16 offen offset:3072 lds
    s_add_u32 s62, s62, 1
    s_cmp_eq_u32 s62, 10
    s_cselect_b32 s62, 0, s62
    s_add_u32 m0, s50, 114688
    s_mul_i32 s16, s62, 221184
    buffer_load_dwordx4 v16, s[4:7], s16 offen offset:0 lds
    buffer_load_dwordx4 v17, s[4:7], s16 offen offset:1024 lds
    buffer_load_dwordx4 v18, s[4:7], s16 offen offset:2048 lds
    buffer_load_dwordx4 v19, s[4:7], s16 offen offset:3072 lds
    s_add_u32 s62, s62, 1
    s_cmp_eq_u32 s62, 10
    s_cselect_b32 s62, 0, s62
    s_add_u32 m0, s50, 49152
    s_lshl_b32 s51, s17, 7
    buffer_load_dwordx4 v1, s[8:11], s51 offen offset:0 lds
    buffer_load_dwordx4 v2, s[8:11], s51 offen offset:1024 lds
    buffer_load_dwordx4 v3, s[8:11], s51 offen offset:2048 lds
    buffer_load_dwordx4 v4, s[8:11], s51 offen offset:3072 lds
    s_add_u32 s17, s17, 1
    s_cmp_eq_u32 s17, 10
    s_cselect_b32 s17, 0, s17
    s_waitcnt lgkmcnt(0)
    v_readfirstlane_b32 s61, v13
    s_waitcnt vmcnt(12)
    s_mov_b64 exec, 1
    buffer_store_dword v13, off, s[20:23], s46 sc1
    s_mov_b64 exec, -1
    s_waitcnt vmcnt(9)
    s_barrier
    s_add_u32 m0, s50, 131072
    s_mul_i32 s16, s62, 221184
    buffer_load_dwordx4 v16, s[4:7], s16 offen offset:0 lds
    buffer_load_dwordx4 v17, s[4:7], s16 offen offset:1024 lds
    buffer_load_dwordx4 v18, s[4:7], s16 offen offset:2048 lds
    buffer_load_dwordx4 v19, s[4:7], s16 offen offset:3072 lds
    s_add_u32 s62, s62, 1
    s_cmp_eq_u32 s62, 10
    s_cselect_b32 s62, 0, s62
    s_add_u32 m0, s50, 65536
    s_lshl_b32 s51, s17, 7
    buffer_load_dwordx4 v1, s[8:11], s51 offen offset:0 lds
    buffer_load_dwordx4 v2, s[8:11], s51 offen offset:1024 lds
    buffer_load_dwordx4 v3, s[8:11], s51 offen offset:2048 lds
    buffer_load_dwordx4 v4, s[8:11], s51 offen offset:3072 lds
    s_add_u32 s17, s17, 1
    s_cmp_eq_u32 s17, 10
    s_cselect_b32 s17, 0, s17
    v_mov_b32 v6, 0x3f803f80
    v_mov_b32 v172, v6
    v_mov_b32 v173, v6
    v_mov_b32 v174, v6
    v_mov_b32 v175, v6
    v_mov_b32 v176, v6
    v_mov_b32 v177, v6
    v_mov_b32 v178, v6
    v_mov_b32 v179, v6
    v_mov_b32 v180, v6
    v_mov_b32 v181, v6
    v_mov_b32 v182, v6
    v_mov_b32 v183, v6
    v_mov_b32 v120, 0
    v_mov_b32 v121, 0
    v_mov_b32 v122, 0
    v_mov_b32 v123, 0
    v_mov_b32 v184, 0
    v_mov_b32 v116, -1
    v_mov_b32 v185, 0
    v_mov_b32 v117, -1
    v_mov_b32 v186, 0
    v_mov_b32 v118, -1
    v_mov_b32 v187, 0
    v_mov_b32 v119, -1
    v_mfma_f32_32x32x16_bf16 v[124:139], v[120:123], v[120:123], 0
    v_mfma_f32_32x32x16_bf16 v[140:155], v[120:123], v[120:123], 0
    s_waitcnt vmcnt(9)
    s_barrier
    s_add_u32 m0, s50, 147456
    s_mul_i32 s16, s62, 221184
    buffer_load_dwordx4 v16, s[4:7], s16 offen offset:0 lds
    buffer_load_dwordx4 v17, s[4:7], s16 offen offset:1024 lds
    buffer_load_dwordx4 v18, s[4:7], s16 offen offset:2048 lds
    buffer_load_dwordx4 v19, s[4:7], s16 offen offset:3072 lds
    s_add_u32 s62, s62, 1
    s_cmp_eq_u32 s62, 10
    s_cselect_b32 s62, 0, s62
    s_add_u32 m0, s50, 81920
    s_lshl_b32 s51, s17, 7
    buffer_load_dwordx4 v1, s[8:11], s51 offen offset:0 lds
    buffer_load_dwordx4 v2, s[8:11], s51 offen offset:1024 lds
    buffer_load_dwordx4 v3, s[8:11], s51 offen offset:2048 lds
    buffer_load_dwordx4 v4, s[8:11], s51 offen offset:3072 lds
    s_add_u32 s17, s17, 1
    s_cmp_eq_u32 s17, 10
    s_cselect_b32 s17, 0, s17
    s_waitcnt vmcnt(8)
    s_barrier
    s_branch P2_SETUP
P1_B:
    s_lshl_b32 s49, s47, 12
    s_lshl_b32 s52, s45, 11
    s_add_u32 s49, s49, s52
    s_mul_i32 s56, s53, 110592
    s_add_u32 s56, s56, 8388608
    s_add_u32 s56, s56, s49
    s_lshl_b32 s57, s41, 1
    s_add_u32 s57, s57, s45
    s_cmp_ge_u32 s57, 27
    s_cselect_b32 s56, 0x2000000, s56
    v_lshl_add_u32 v72, v0, 4, s56
    v_add_u32 v73, 55296, v72
    v_add_u32 v74, 110592, v72
    v_add_u32 v75, 165888, v72
    s_load_dword s37, s[34:35], s46
    s_waitcnt vmcnt(8)
    s_barrier
    s_add_u32 m0, s50, 49152
    s_lshl_b32 s51, s62, 7
    buffer_load_dwordx4 v1, s[8:11], s51 offen offset:0 lds
    buffer_load_dwordx4 v2, s[8:11], s51 offen offset:1024 lds
    buffer_load_dwordx4 v3, s[8:11], s51 offen offset:2048 lds
    buffer_load_dwordx4 v4, s[8:11], s51 offen offset:3072 lds
    s_add_u32 m0, s50, 131072
    s_mul_i32 s16, s62, 245760
    buffer_load_dwordx4 v16, s[12:15], s16 offen offset:0 lds
    buffer_load_dwordx4 v17, s[12:15], s16 offen offset:1024 lds
    buffer_load_dwordx4 v18, s[12:15], s16 offen offset:2048 lds
    buffer_load_dwordx4 v19, s[12:15], s16 offen offset:3072 lds
    s_add_u32 s62, s62, 1
    s_cmp_eq_u32 s62, 10
    s_cselect_b32 s62, 0, s62
    s_waitcnt vmcnt(8)
    s_barrier
    s_add_u32 m0, s50, 65536
    s_lshl_b32 s51, s62, 7
    buffer_load_dwordx4 v1, s[8:11], s51 offen offset:0 lds
    buffer_load_dwordx4 v2, s[8:11], s51 offen offset:1024 lds
    buffer_load_dwordx4 v3, s[8:11], s51 offen offset:2048 lds
    buffer_load_dwordx4 v4, s[8:11], s51 offen offset:3072 lds
    s_add_u32 m0, s50, 147456
    s_mul_i32 s16, s62, 245760
    buffer_load_dwordx4 v16, s[12:15], s16 offen offset:0 lds
    buffer_load_dwordx4 v17, s[12:15], s16 offen offset:1024 lds
    buffer_load_dwordx4 v18, s[12:15], s16 offen offset:2048 lds
    buffer_load_dwordx4 v19, s[12:15], s16 offen offset:3072 lds
    s_add_u32 s62, s62, 1
    s_cmp_eq_u32 s62, 10
    s_cselect_b32 s62, 0, s62
    s_mov_b32 s56, 0xc0135761
    s_mov_b32 s57, 0xc0135761
    v_mov_b32 v84, 0xbdd2d3e8
    v_mov_b32 v85, 0xbdd2d3e8
    s_waitcnt vmcnt(8)
    s_barrier
    s_add_u32 m0, s50, 81920
    s_lshl_b32 s51, s62, 7
    buffer_load_dwordx4 v1, s[8:11], s51 offen offset:0 lds
    buffer_load_dwordx4 v2, s[8:11], s51 offen offset:1024 lds
    buffer_load_dwordx4 v3, s[8:11], s51 offen offset:2048 lds
    buffer_load_dwordx4 v4, s[8:11], s51 offen offset:3072 lds
    s_add_u32 m0, s50, 98304
    s_mul_i32 s16, s62, 245760
    buffer_load_dwordx4 v16, s[12:15], s16 offen offset:0 lds
    buffer_load_dwordx4 v17, s[12:15], s16 offen offset:1024 lds
    buffer_load_dwordx4 v18, s[12:15], s16 offen offset:2048 lds
    buffer_load_dwordx4 v19, s[12:15], s16 offen offset:3072 lds
    s_add_u32 s62, s62, 1
    s_cmp_eq_u32 s62, 10
    s_cselect_b32 s62, 0, s62
    v_lshrrev_b32 v20, 4, v0
    v_lshlrev_b32 v20, 3, v20
    s_lshl_b32 s49, s47, 8
    s_lshl_b32 s52, s45, 7
    s_add_u32 s49, s49, s52
    s_xor_b32 s52, s44, 0
    s_lshl_b32 s52, s52, 6
    s_add_u32 s52, s52, s49
    buffer_load_dwordx2 v[56:57], v20, s[24:27], s52 offen offset:0
    buffer_load_dwordx2 v[58:59], v20, s[24:27], s52 offen offset:32
    s_xor_b32 s52, s44, 1
    s_lshl_b32 s52, s52, 6
    s_add_u32 s52, s52, s49
    buffer_load_dwordx2 v[60:61], v20, s[24:27], s52 offen offset:0
    buffer_load_dwordx2 v[62:63], v20, s[24:27], s52 offen offset:32
    s_waitcnt vmcnt(12)
    s_barrier
    s_add_u32 m0, s50, 16384
    s_lshl_b32 s51, s62, 7
    buffer_load_dwordx4 v1, s[8:11], s51 offen offset:0 lds
    buffer_load_dwordx4 v2, s[8:11], s51 offen offset:1024 lds
    buffer_load_dwordx4 v3, s[8:11], s51 offen offset:2048 lds
    buffer_load_dwordx4 v4, s[8:11], s51 offen offset:3072 lds
    s_add_u32 m0, s50, 114688
    s_mul_i32 s16, s62, 245760
    buffer_load_dwordx4 v16, s[12:15], s16 offen offset:0 lds
    buffer_load_dwordx4 v17, s[12:15], s16 offen offset:1024 lds
    buffer_load_dwordx4 v18, s[12:15], s16 offen offset:2048 lds
    buffer_load_dwordx4 v19, s[12:15], s16 offen offset:3072 lds
    s_add_u32 s62, s62, 1
    s_cmp_eq_u32 s62, 10
    s_cselect_b32 s62, 0, s62
    s_waitcnt vmcnt(12)
    s_barrier
    s_add_u32 m0, s50, 32768
    s_lshl_b32 s51, s62, 7
    buffer_load_dwordx4 v1, s[8:11], s51 offen offset:0 lds
    buffer_load_dwordx4 v2, s[8:11], s51 offen offset:1024 lds
    buffer_load_dwordx4 v3, s[8:11], s51 offen offset:2048 lds
    buffer_load_dwordx4 v4, s[8:11], s51 offen offset:3072 lds
    s_add_u32 m0, s50, 131072
    s_mul_i32 s16, s62, 245760
    buffer_load_dwordx4 v16, s[12:15], s16 offen offset:0 lds
    buffer_load_dwordx4 v17, s[12:15], s16 offen offset:1024 lds
    buffer_load_dwordx4 v18, s[12:15], s16 offen offset:2048 lds
    buffer_load_dwordx4 v19, s[12:15], s16 offen offset:3072 lds
    s_add_u32 s62, s62, 1
    s_cmp_eq_u32 s62, 10
    s_cselect_b32 s62, 0, s62
    s_waitcnt vmcnt(8)
    s_barrier
    s_add_u32 m0, s50, 49152
    s_lshl_b32 s51, s62, 7
    buffer_load_dwordx4 v1, s[8:11], s51 offen offset:0 lds
    buffer_load_dwordx4 v2, s[8:11], s51 offen offset:1024 lds
    buffer_load_dwordx4 v3, s[8:11], s51 offen offset:2048 lds
    buffer_load_dwordx4 v4, s[8:11], s51 offen offset:3072 lds
    s_add_u32 m0, s50, 147456
    s_mul_i32 s16, s62, 245760
    buffer_load_dwordx4 v16, s[12:15], s16 offen offset:0 lds
    buffer_load_dwordx4 v17, s[12:15], s16 offen offset:1024 lds
    buffer_load_dwordx4 v18, s[12:15], s16 offen offset:2048 lds
    buffer_load_dwordx4 v19, s[12:15], s16 offen offset:3072 lds
    s_add_u32 s62, s62, 1
    s_cmp_eq_u32 s62, 10
    s_cselect_b32 s62, 0, s62
    s_waitcnt vmcnt(8)
    s_waitcnt lgkmcnt(0)
    s_barrier
    s_add_u32 m0, s50, 65536
    s_lshl_b32 s51, s62, 7
    buffer_load_dwordx4 v1, s[8:11], s51 offen offset:0 lds
    buffer_load_dwordx4 v2, s[8:11], s51 offen offset:1024 lds
    buffer_load_dwordx4 v3, s[8:11], s51 offen offset:2048 lds
    buffer_load_dwordx4 v4, s[8:11], s51 offen offset:3072 lds
    s_add_u32 m0, s50, 98304
    s_mul_i32 s16, s62, 245760
    buffer_load_dwordx4 v16, s[12:15], s16 offen offset:0 lds
    buffer_load_dwordx4 v17, s[12:15], s16 offen offset:1024 lds
    buffer_load_dwordx4 v18, s[12:15], s16 offen offset:2048 lds
    buffer_load_dwordx4 v19, s[12:15], s16 offen offset:3072 lds
    s_add_u32 s62, s62, 1
    s_cmp_eq_u32 s62, 10
    s_cselect_b32 s62, 0, s62
    v_lshlrev_b32 v40, 16, v56
    v_and_b32 v41, 0xffff0000, v56
    v_lshlrev_b32 v42, 16, v57
    v_and_b32 v43, 0xffff0000, v57
    v_lshlrev_b32 v44, 16, v58
    v_and_b32 v45, 0xffff0000, v58
    v_lshlrev_b32 v46, 16, v59
    v_and_b32 v47, 0xffff0000, v59
    s_waitcnt vmcnt(8)
    s_barrier
    s_add_u32 m0, s50, 81920
    s_lshl_b32 s51, s62, 7
    buffer_load_dwordx4 v1, s[8:11], s51 offen offset:0 lds
    buffer_load_dwordx4 v2, s[8:11], s51 offen offset:1024 lds
    buffer_load_dwordx4 v3, s[8:11], s51 offen offset:2048 lds
    buffer_load_dwordx4 v4, s[8:11], s51 offen offset:3072 lds
    s_add_u32 m0, s50, 114688
    s_mul_i32 s16, s62, 245760
    buffer_load_dwordx4 v16, s[12:15], s16 offen offset:0 lds
    buffer_load_dwordx4 v17, s[12:15], s16 offen offset:1024 lds
    buffer_load_dwordx4 v18, s[12:15], s16 offen offset:2048 lds
    buffer_load_dwordx4 v19, s[12:15], s16 offen offset:3072 lds
    s_add_u32 s62, s62, 1
    s_cmp_eq_u32 s62, 10
    s_cselect_b32 s62, 0, s62
    v_lshlrev_b32 v48, 16, v60
    v_and_b32 v49, 0xffff0000, v60
    v_lshlrev_b32 v50, 16, v61
    v_and_b32 v51, 0xffff0000, v61
    v_lshlrev_b32 v52, 16, v62
    v_and_b32 v53, 0xffff0000, v62
    v_lshlrev_b32 v54, 16, v63
    v_and_b32 v55, 0xffff0000, v63
    s_waitcnt vmcnt(8)
    s_barrier
    v_lshlrev_b32 v12, 4, v0
    s_lshl_b32 s36, s40, 1
    s_add_u32 s36, s36, s45
    s_lshl_b32 s36, s36, 10
    s_add_u32 s36, s36, 26230784
    buffer_load_dword v13, off, s[96:99], 0 sc1
    buffer_load_dwordx4 v[102:105], v12, s[20:23], s36 offen sc1
    v_mul_u32_u24 v27, 3456, v26
    s_lshl_b32 s49, s47, 8
    v_add3_u32 v16, v27, v24, s49
    v_add_u32 v17, 12800, v16
    v_xor_b32 v25, 128, v24
    v_add3_u32 v19, v27, v25, s49
    v_add_u32 v18, 25600, v19
    v_add_u32 v19, 38400, v19
    s_mov_b32 s62, s60
    s_add_u32 m0, s50, 131072
    s_mul_i32 s16, s62, 221184
    buffer_load_dwordx4 v16, s[4:7], s16 offen offset:0 lds
    buffer_load_dwordx4 v17, s[4:7], s16 offen offset:1024 lds
    buffer_load_dwordx4 v18, s[4:7], s16 offen offset:2048 lds
    buffer_load_dwordx4 v19, s[4:7], s16 offen offset:3072 lds
    s_add_u32 s62, s62, 1
    s_cmp_eq_u32 s62, 10
    s_cselect_b32 s62, 0, s62
    s_add_u32 m0, s50, 147456
    s_mul_i32 s16, s62, 221184
    buffer_load_dwordx4 v16, s[4:7], s16 offen offset:0 lds
    buffer_load_dwordx4 v17, s[4:7], s16 offen offset:1024 lds
    buffer_load_dwordx4 v18, s[4:7], s16 offen offset:2048 lds
    buffer_load_dwordx4 v19, s[4:7], s16 offen offset:3072 lds
    s_add_u32 s62, s62, 1
    s_cmp_eq_u32 s62, 10
    s_cselect_b32 s62, 0, s62
    s_waitcnt vmcnt(10)
    s_barrier
    s_add_u32 m0, s50, 98304
    s_mul_i32 s16, s62, 221184
    buffer_load_dwordx4 v16, s[4:7], s16 offen offset:0 lds
    buffer_load_dwordx4 v17, s[4:7], s16 offen offset:1024 lds
    buffer_load_dwordx4 v18, s[4:7], s16 offen offset:2048 lds
    buffer_load_dwordx4 v19, s[4:7], s16 offen offset:3072 lds
    s_add_u32 s62, s62, 1
    s_cmp_eq_u32 s62, 10
    s_cselect_b32 s62, 0, s62
    s_waitcnt vmcnt(8)
    s_barrier
    ds_read_b64_tr_b16 v[118:119], v7 offset:32768
    ds_read_b64_tr_b16 v[120:121], v7 offset:33792
    ds_read_b128 v[86:89], v5 offset:0
    ds_read_b128 v[90:93], v5 offset:2048
    ds_read_b128 v[94:97], v5 offset:4096
    ds_read_b128 v[98:101], v5 offset:6144
    ds_read_b64_tr_b16 v[122:123], v8 offset:32768
    ds_read_b64_tr_b16 v[124:125], v8 offset:33792
    ds_read_b64_tr_b16 v[126:127], v9 offset:32768
    ds_read_b64_tr_b16 v[128:129], v9 offset:33792
    ds_read_b64_tr_b16 v[130:131], v10 offset:32768
    ds_read_b64_tr_b16 v[132:133], v10 offset:33792
    v_mov_b32 v21, s37
    s_mov_b32 s63, 30000
    v_readfirstlane_b32 s48, v21
TAGL_1:
    v_readfirstlane_b32 s61, v13
    s_cmp_lg_u32 s61, s48
    s_cselect_b32 s49, s61, 0
    s_cmp_lg_u32 s49, 0
    s_cbranch_scc1 TAGD_2
    s_sleep 2
    buffer_load_dword v13, off, s[96:99], 0 sc1
    s_waitcnt vmcnt(0)
    s_sub_u32 s63, s63, 1
    s_cmp_lg_u32 s63, 0
    s_cbranch_scc1 TAGL_1
TAGD_2:
    v_mov_b32 v20, 4032
    ds_write_b32 v20, v13
    s_mov_b32 s63, 30000
P1_SW_3:
    v_xor_b32 v103, s61, v103
    v_xor_b32 v105, s61, v105
    v_or_b32 v103, v103, v105
    v_cmp_ne_u32 vcc, 0, v103
    s_cbranch_vccz P1_SD_4
    s_sleep 4
    buffer_load_dwordx4 v[102:105], v12, s[20:23], s36 offen sc1
    s_sub_u32 s63, s63, 1
    s_cmp_lg_u32 s63, 0
    s_waitcnt vmcnt(0)
    s_cbranch_scc1 P1_SW_3
P1_SD_4:
    v_add_f32 v103, 0x3727c5ac, v104
    v_rsq_f32 v103, v103
    s_lshl_b32 s48, s45, 8
    v_mul_f32 v104, v104, v103
    v_mul_f32 v104, v104, v103
    v_add_f32 v104, 0x3727c5ac, v104
    v_rsq_f32 v104, v104
    v_lshl_add_u32 v105, v0, 2, s48
    v_mul_f32 v104, v103, v104
    ds_write_b32 v105, v102 offset:0
    ds_write_b32 v105, v103 offset:512
    ds_write_b32 v105, v104 offset:1024
    s_waitcnt lgkmcnt(0)
    v_mfma_f32_16x16x32_bf16 v[150:153], v[118:121], v[86:89], 0
    ds_read_b64_tr_b16 v[134:135], v7 offset:40960
    v_mfma_f32_16x16x32_bf16 v[154:157], v[118:121], v[90:93], 0
    ds_read_b64_tr_b16 v[136:137], v7 offset:41984
    v_mfma_f32_16x16x32_bf16 v[158:161], v[118:121], v[94:97], 0
    ds_read_b128 v[102:105], v6 offset:0
    v_mfma_f32_16x16x32_bf16 v[162:165], v[118:121], v[98:101], 0
    ds_read_b128 v[106:109], v6 offset:2048
    v_mfma_f32_16x16x32_bf16 v[178:181], v[122:125], v[98:101], 0
    ds_read_b128 v[110:113], v6 offset:4096
    v_mfma_f32_16x16x32_bf16 v[174:177], v[122:125], v[94:97], 0
    ds_read_b128 v[114:117], v6 offset:6144
    v_mfma_f32_16x16x32_bf16 v[170:173], v[122:125], v[90:93], 0
    ds_read_b64_tr_b16 v[138:139], v8 offset:40960
    v_mfma_f32_16x16x32_bf16 v[166:169], v[122:125], v[86:89], 0
    ds_read_b64_tr_b16 v[140:141], v8 offset:41984
    v_mfma_f32_16x16x32_bf16 v[182:185], v[126:129], v[86:89], 0
    ds_read_b64_tr_b16 v[142:143], v9 offset:40960
    v_mfma_f32_16x16x32_bf16 v[186:189], v[126:129], v[90:93], 0
    ds_read_b64_tr_b16 v[144:145], v9 offset:41984
    v_mfma_f32_16x16x32_bf16 v[190:193], v[126:129], v[94:97], 0
    ds_read_b64_tr_b16 v[146:147], v10 offset:40960
    v_mfma_f32_16x16x32_bf16 v[194:197], v[126:129], v[98:101], 0
    ds_read_b64_tr_b16 v[148:149], v10 offset:41984
    v_mfma_f32_16x16x32_bf16 v[210:213], v[130:133], v[98:101], 0
    v_mfma_f32_16x16x32_bf16 v[206:209], v[130:133], v[94:97], 0
    v_mfma_f32_16x16x32_bf16 v[202:205], v[130:133], v[90:93], 0
    v_mfma_f32_16x16x32_bf16 v[198:201], v[130:133], v[86:89], 0
    v_mfma_f32_16x16x32_bf16 v[32:35], v[28:31], v[118:121], 0
    v_mfma_f32_16x16x32_bf16 v[36:39], v[28:31], v[122:125], 0
    s_waitcnt vmcnt(4)
    s_waitcnt lgkmcnt(0)
    s_barrier
    v_mfma_f32_16x16x32_bf16 v[150:153], v[134:137], v[102:105], v[150:153]
    ds_read_b64_tr_b16 v[118:119], v7 offset:49152
    v_mfma_f32_16x16x32_bf16 v[154:157], v[134:137], v[106:109], v[154:157]
    ds_read_b64_tr_b16 v[120:121], v7 offset:50176
    v_mfma_f32_16x16x32_bf16 v[158:161], v[134:137], v[110:113], v[158:161]
    ds_read_b128 v[86:89], v5 offset:16384
    v_mfma_f32_16x16x32_bf16 v[162:165], v[134:137], v[114:117], v[162:165]
    ds_read_b128 v[90:93], v5 offset:18432
    v_mfma_f32_16x16x32_bf16 v[178:181], v[138:141], v[114:117], v[178:181]
    ds_read_b128 v[94:97], v5 offset:20480
    v_mfma_f32_16x16x32_bf16 v[174:177], v[138:141], v[110:113], v[174:177]
    ds_read_b128 v[98:101], v5 offset:22528
    v_mfma_f32_16x16x32_bf16 v[170:173], v[138:141], v[106:109], v[170:173]
    ds_read_b64_tr_b16 v[122:123], v8 offset:49152
    v_mfma_f32_16x16x32_bf16 v[166:169], v[138:141], v[102:105], v[166:169]
    ds_read_b64_tr_b16 v[124:125], v8 offset:50176
    v_mfma_f32_16x16x32_bf16 v[182:185], v[142:145], v[102:105], v[182:185]
    ds_read_b64_tr_b16 v[126:127], v9 offset:49152
    v_mfma_f32_16x16x32_bf16 v[186:189], v[142:145], v[106:109], v[186:189]
    ds_read_b64_tr_b16 v[128:129], v9 offset:50176
    v_mfma_f32_16x16x32_bf16 v[190:193], v[142:145], v[110:113], v[190:193]
    ds_read_b64_tr_b16 v[130:131], v10 offset:49152
    v_mfma_f32_16x16x32_bf16 v[194:197], v[142:145], v[114:117], v[194:197]
    ds_read_b64_tr_b16 v[132:133], v10 offset:50176
    v_mfma_f32_16x16x32_bf16 v[210:213], v[146:149], v[114:117], v[210:213]
    v_mfma_f32_16x16x32_bf16 v[206:209], v[146:149], v[110:113], v[206:209]
    v_mfma_f32_16x16x32_bf16 v[202:205], v[146:149], v[106:109], v[202:205]
    v_mfma_f32_16x16x32_bf16 v[198:201], v[146:149], v[102:105], v[198:201]
    v_mfma_f32_16x16x32_bf16 v[32:35], v[28:31], v[134:137], v[32:35]
    v_mfma_f32_16x16x32_bf16 v[36:39], v[28:31], v[138:141], v[36:39]
    s_waitcnt lgkmcnt(0)
    v_mfma_f32_16x16x32_bf16 v[150:153], v[118:121], v[86:89], v[150:153]
    ds_read_b64_tr_b16 v[134:135], v7 offset:57344
    v_mfma_f32_16x16x32_bf16 v[154:157], v[118:121], v[90:93], v[154:157]
    ds_read_b64_tr_b16 v[136:137], v7 offset:58368
    v_mfma_f32_16x16x32_bf16 v[158:161], v[118:121], v[94:97], v[158:161]
    ds_read_b128 v[102:105], v6 offset:16384
    v_mfma_f32_16x16x32_bf16 v[162:165], v[118:121], v[98:101], v[162:165]
    ds_read_b128 v[106:109], v6 offset:18432
    v_mfma_f32_16x16x32_bf16 v[178:181], v[122:125], v[98:101], v[178:181]
    ds_read_b128 v[110:113], v6 offset:20480
    v_mfma_f32_16x16x32_bf16 v[174:177], v[122:125], v[94:97], v[174:177]
    ds_read_b128 v[114:117], v6 offset:22528
    v_mfma_f32_16x16x32_bf16 v[170:173], v[122:125], v[90:93], v[170:173]
    ds_read_b64_tr_b16 v[138:139], v8 offset:57344
    v_mfma_f32_16x16x32_bf16 v[166:169], v[122:125], v[86:89], v[166:169]
    ds_read_b64_tr_b16 v[140:141], v8 offset:58368
    v_mfma_f32_16x16x32_bf16 v[182:185], v[126:129], v[86:89], v[182:185]
    ds_read_b64_tr_b16 v[142:143], v9 offset:57344
    v_mfma_f32_16x16x32_bf16 v[186:189], v[126:129], v[90:93], v[186:189]
    ds_read_b64_tr_b16 v[144:145], v9 offset:58368
    v_mfma_f32_16x16x32_bf16 v[190:193], v[126:129], v[94:97], v[190:193]
    ds_read_b64_tr_b16 v[146:147], v10 offset:57344
    v_mfma_f32_16x16x32_bf16 v[194:197], v[126:129], v[98:101], v[194:197]
    ds_read_b64_tr_b16 v[148:149], v10 offset:58368
    v_mfma_f32_16x16x32_bf16 v[210:213], v[130:133], v[98:101], v[210:213]
    v_mfma_f32_16x16x32_bf16 v[206:209], v[130:133], v[94:97], v[206:209]
    v_mfma_f32_16x16x32_bf16 v[202:205], v[130:133], v[90:93], v[202:205]
    v_mfma_f32_16x16x32_bf16 v[198:201], v[130:133], v[86:89], v[198:201]
    v_mfma_f32_16x16x32_bf16 v[32:35], v[28:31], v[118:121], v[32:35]
    v_mfma_f32_16x16x32_bf16 v[36:39], v[28:31], v[122:125], v[36:39]
    s_waitcnt vmcnt(0)
    s_waitcnt lgkmcnt(0)
    s_barrier
    v_mfma_f32_16x16x32_bf16 v[150:153], v[134:137], v[102:105], v[150:153]
    ds_read_b64_tr_b16 v[118:119], v7 offset:0
    v_mfma_f32_16x16x32_bf16 v[154:157], v[134:137], v[106:109], v[154:157]
    ds_read_b64_tr_b16 v[120:121], v7 offset:1024
    v_mfma_f32_16x16x32_bf16 v[158:161], v[134:137], v[110:113], v[158:161]
    ds_read_b128 v[86:89], v5 offset:32768
    v_mfma_f32_16x16x32_bf16 v[162:165], v[134:137], v[114:117], v[162:165]
    ds_read_b128 v[90:93], v5 offset:34816
    v_mfma_f32_16x16x32_bf16 v[178:181], v[138:141], v[114:117], v[178:181]
    ds_read_b128 v[94:97], v5 offset:36864
    v_mfma_f32_16x16x32_bf16 v[174:177], v[138:141], v[110:113], v[174:177]
    ds_read_b128 v[98:101], v5 offset:38912
    v_mfma_f32_16x16x32_bf16 v[170:173], v[138:141], v[106:109], v[170:173]
    ds_read_b64_tr_b16 v[122:123], v8 offset:0
    v_mfma_f32_16x16x32_bf16 v[166:169], v[138:141], v[102:105], v[166:169]
    ds_read_b64_tr_b16 v[124:125], v8 offset:1024
    v_mfma_f32_16x16x32_bf16 v[182:185], v[142:145], v[102:105], v[182:185]
    ds_read_b64_tr_b16 v[126:127], v9 offset:0
    v_mfma_f32_16x16x32_bf16 v[186:189], v[142:145], v[106:109], v[186:189]
    ds_read_b64_tr_b16 v[128:129], v9 offset:1024
    v_mfma_f32_16x16x32_bf16 v[190:193], v[142:145], v[110:113], v[190:193]
    ds_read_b64_tr_b16 v[130:131], v10 offset:0
    v_mfma_f32_16x16x32_bf16 v[194:197], v[142:145], v[114:117], v[194:197]
    ds_read_b64_tr_b16 v[132:133], v10 offset:1024
    v_mfma_f32_16x16x32_bf16 v[210:213], v[146:149], v[114:117], v[210:213]
    v_mfma_f32_16x16x32_bf16 v[206:209], v[146:149], v[110:113], v[206:209]
    v_mfma_f32_16x16x32_bf16 v[202:205], v[146:149], v[106:109], v[202:205]
    v_mfma_f32_16x16x32_bf16 v[198:201], v[146:149], v[102:105], v[198:201]
    v_mfma_f32_16x16x32_bf16 v[32:35], v[28:31], v[134:137], v[32:35]
    v_mfma_f32_16x16x32_bf16 v[36:39], v[28:31], v[138:141], v[36:39]
    s_waitcnt lgkmcnt(0)
    v_mfma_f32_16x16x32_bf16 v[150:153], v[118:121], v[86:89], v[150:153]
    ds_read_b64_tr_b16 v[134:135], v7 offset:8192
    v_mfma_f32_16x16x32_bf16 v[154:157], v[118:121], v[90:93], v[154:157]
    ds_read_b64_tr_b16 v[136:137], v7 offset:9216
    v_mfma_f32_16x16x32_bf16 v[158:161], v[118:121], v[94:97], v[158:161]
    ds_read_b128 v[102:105], v6 offset:32768
    v_mfma_f32_16x16x32_bf16 v[162:165], v[118:121], v[98:101], v[162:165]
    ds_read_b128 v[106:109], v6 offset:34816
    v_mfma_f32_16x16x32_bf16 v[178:181], v[122:125], v[98:101], v[178:181]
    ds_read_b128 v[110:113], v6 offset:36864
    v_mfma_f32_16x16x32_bf16 v[174:177], v[122:125], v[94:97], v[174:177]
    ds_read_b128 v[114:117], v6 offset:38912
    v_mfma_f32_16x16x32_bf16 v[170:173], v[122:125], v[90:93], v[170:173]
    ds_read_b64_tr_b16 v[138:139], v8 offset:8192
    v_mfma_f32_16x16x32_bf16 v[166:169], v[122:125], v[86:89], v[166:169]
    ds_read_b64_tr_b16 v[140:141], v8 offset:9216
    v_mfma_f32_16x16x32_bf16 v[182:185], v[126:129], v[86:89], v[182:185]
    ds_read_b64_tr_b16 v[142:143], v9 offset:8192
    v_mfma_f32_16x16x32_bf16 v[186:189], v[126:129], v[90:93], v[186:189]
    ds_read_b64_tr_b16 v[144:145], v9 offset:9216
    v_mfma_f32_16x16x32_bf16 v[190:193], v[126:129], v[94:97], v[190:193]
    ds_read_b64_tr_b16 v[146:147], v10 offset:8192
    v_mfma_f32_16x16x32_bf16 v[194:197], v[126:129], v[98:101], v[194:197]
    ds_read_b64_tr_b16 v[148:149], v10 offset:9216
    v_mfma_f32_16x16x32_bf16 v[210:213], v[130:133], v[98:101], v[210:213]
    v_mfma_f32_16x16x32_bf16 v[206:209], v[130:133], v[94:97], v[206:209]
    v_mfma_f32_16x16x32_bf16 v[202:205], v[130:133], v[90:93], v[202:205]
    v_mfma_f32_16x16x32_bf16 v[198:201], v[130:133], v[86:89], v[198:201]
    v_mfma_f32_16x16x32_bf16 v[32:35], v[28:31], v[118:121], v[32:35]
    v_mfma_f32_16x16x32_bf16 v[36:39], v[28:31], v[122:125], v[36:39]
    s_waitcnt lgkmcnt(0)
    v_and_b32 v26, 15, v0
    s_lshl_b32 s49, s44, 8
    v_lshl_add_u32 v26, v26, 2, s49
    ds_read_b32 v76, v26 offset:0
    ds_read_b32 v77, v26 offset:1024
    ds_read_b32 v78, v26 offset:64
    ds_read_b32 v79, v26 offset:1088
    ds_read_b32 v80, v26 offset:128
    ds_read_b32 v81, v26 offset:1152
    ds_read_b32 v82, v26 offset:192
    ds_read_b32 v83, v26 offset:1216
    v_lshrrev_b32 v27, 4, v0
    v_lshl_add_u32 v27, v27, 4, s59
    v_xor_b32 v26, 128, v27
    v_mfma_f32_16x16x32_bf16 v[150:153], v[134:137], v[102:105], v[150:153]
    ds_read_b64_tr_b16 v[118:119], v7 offset:16384
    v_mfma_f32_16x16x32_bf16 v[154:157], v[134:137], v[106:109], v[154:157]
    ds_read_b64_tr_b16 v[120:121], v7 offset:17408
    v_mfma_f32_16x16x32_bf16 v[158:161], v[134:137], v[110:113], v[158:161]
    ds_read_b128 v[86:89], v5 offset:49152
    v_mfma_f32_16x16x32_bf16 v[162:165], v[134:137], v[114:117], v[162:165]
    ds_read_b128 v[90:93], v5 offset:51200
    v_mfma_f32_16x16x32_bf16 v[178:181], v[138:141], v[114:117], v[178:181]
    ds_read_b128 v[94:97], v5 offset:53248
    v_mfma_f32_16x16x32_bf16 v[174:177], v[138:141], v[110:113], v[174:177]
    ds_read_b128 v[98:101], v5 offset:55296
    v_mfma_f32_16x16x32_bf16 v[170:173], v[138:141], v[106:109], v[170:173]
    ds_read_b64_tr_b16 v[122:123], v8 offset:16384
    v_mfma_f32_16x16x32_bf16 v[166:169], v[138:141], v[102:105], v[166:169]
    ds_read_b64_tr_b16 v[124:125], v8 offset:17408
    v_mfma_f32_16x16x32_bf16 v[182:185], v[142:145], v[102:105], v[182:185]
    ds_read_b64_tr_b16 v[126:127], v9 offset:16384
    v_mfma_f32_16x16x32_bf16 v[186:189], v[142:145], v[106:109], v[186:189]
    ds_read_b64_tr_b16 v[128:129], v9 offset:17408
    v_mfma_f32_16x16x32_bf16 v[190:193], v[142:145], v[110:113], v[190:193]
    ds_read_b64_tr_b16 v[130:131], v10 offset:16384
    v_mfma_f32_16x16x32_bf16 v[194:197], v[142:145], v[114:117], v[194:197]
    ds_read_b64_tr_b16 v[132:133], v10 offset:17408
    v_mfma_f32_16x16x32_bf16 v[210:213], v[146:149], v[114:117], v[210:213]
    v_mfma_f32_16x16x32_bf16 v[206:209], v[146:149], v[110:113], v[206:209]
    v_mfma_f32_16x16x32_bf16 v[202:205], v[146:149], v[106:109], v[202:205]
    v_mfma_f32_16x16x32_bf16 v[198:201], v[146:149], v[102:105], v[198:201]
    v_mfma_f32_16x16x32_bf16 v[32:35], v[28:31], v[134:137], v[32:35]
    v_mfma_f32_16x16x32_bf16 v[36:39], v[28:31], v[138:141], v[36:39]
    s_waitcnt lgkmcnt(0)
    v_mfma_f32_16x16x32_bf16 v[150:153], v[118:121], v[86:89], v[150:153]
    ds_read_b64_tr_b16 v[134:135], v7 offset:24576
    v_mfma_f32_16x16x32_bf16 v[154:157], v[118:121], v[90:93], v[154:157]
    ds_read_b64_tr_b16 v[136:137], v7 offset:25600
    v_mfma_f32_16x16x32_bf16 v[158:161], v[118:121], v[94:97], v[158:161]
    ds_read_b128 v[102:105], v6 offset:49152
    v_mfma_f32_16x16x32_bf16 v[162:165], v[118:121], v[98:101], v[162:165]
    ds_read_b128 v[106:109], v6 offset:51200
    v_mfma_f32_16x16x32_bf16 v[178:181], v[122:125], v[98:101], v[178:181]
    ds_read_b128 v[110:113], v6 offset:53248
    v_mfma_f32_16x16x32_bf16 v[174:177], v[122:125], v[94:97], v[174:177]
    ds_read_b128 v[114:117], v6 offset:55296
    v_mfma_f32_16x16x32_bf16 v[170:173], v[122:125], v[90:93], v[170:173]
    ds_read_b64_tr_b16 v[138:139], v8 offset:24576
    v_mfma_f32_16x16x32_bf16 v[166:169], v[122:125], v[86:89], v[166:169]
    ds_read_b64_tr_b16 v[140:141], v8 offset:25600
    v_mfma_f32_16x16x32_bf16 v[182:185], v[126:129], v[86:89], v[182:185]
    ds_read_b64_tr_b16 v[142:143], v9 offset:24576
    v_mfma_f32_16x16x32_bf16 v[186:189], v[126:129], v[90:93], v[186:189]
    ds_read_b64_tr_b16 v[144:145], v9 offset:25600
    v_mfma_f32_16x16x32_bf16 v[190:193], v[126:129], v[94:97], v[190:193]
    ds_read_b64_tr_b16 v[146:147], v10 offset:24576
    v_mfma_f32_16x16x32_bf16 v[194:197], v[126:129], v[98:101], v[194:197]
    ds_read_b64_tr_b16 v[148:149], v10 offset:25600
    v_mfma_f32_16x16x32_bf16 v[210:213], v[130:133], v[98:101], v[210:213]
    v_mfma_f32_16x16x32_bf16 v[206:209], v[130:133], v[94:97], v[206:209]
    v_mfma_f32_16x16x32_bf16 v[202:205], v[130:133], v[90:93], v[202:205]
    v_mfma_f32_16x16x32_bf16 v[198:201], v[130:133], v[86:89], v[198:201]
    v_mfma_f32_16x16x32_bf16 v[32:35], v[28:31], v[118:121], v[32:35]
    v_mfma_f32_16x16x32_bf16 v[36:39], v[28:31], v[122:125], v[36:39]
    s_waitcnt lgkmcnt(0)
    v_mfma_f32_16x16x32_bf16 v[150:153], v[134:137], v[102:105], v[150:153]
    ds_read_b64_tr_b16 v[118:119], v7 offset:32768
    v_mfma_f32_16x16x32_bf16 v[154:157], v[134:137], v[106:109], v[154:157]
    ds_read_b64_tr_b16 v[120:121], v7 offset:33792
    v_mfma_f32_16x16x32_bf16 v[158:161], v[134:137], v[110:113], v[158:161]
    ds_read_b128 v[86:89], v14 offset:0
    v_mfma_f32_16x16x32_bf16 v[162:165], v[134:137], v[114:117], v[162:165]
    ds_read_b128 v[90:93], v14 offset:2048
    v_mfma_f32_16x16x32_bf16 v[178:181], v[138:141], v[114:117], v[178:181]
    ds_read_b128 v[94:97], v14 offset:4096
    v_mfma_f32_16x16x32_bf16 v[174:177], v[138:141], v[110:113], v[174:177]
    ds_read_b128 v[98:101], v14 offset:6144
    v_mfma_f32_16x16x32_bf16 v[170:173], v[138:141], v[106:109], v[170:173]
    ds_read_b64_tr_b16 v[122:123], v8 offset:32768
    v_mfma_f32_16x16x32_bf16 v[166:169], v[138:141], v[102:105], v[166:169]
    ds_read_b64_tr_b16 v[124:125], v8 offset:33792
    v_mfma_f32_16x16x32_bf16 v[182:185], v[142:145], v[102:105], v[182:185]
    ds_read_b64_tr_b16 v[126:127], v9 offset:32768
    v_mfma_f32_16x16x32_bf16 v[186:189], v[142:145], v[106:109], v[186:189]
    ds_read_b64_tr_b16 v[128:129], v9 offset:33792
    v_mfma_f32_16x16x32_bf16 v[190:193], v[142:145], v[110:113], v[190:193]
    ds_read_b64_tr_b16 v[130:131], v10 offset:32768
    v_mfma_f32_16x16x32_bf16 v[194:197], v[142:145], v[114:117], v[194:197]
    ds_read_b64_tr_b16 v[132:133], v10 offset:33792
    v_mfma_f32_16x16x32_bf16 v[210:213], v[146:149], v[114:117], v[210:213]
    v_mfma_f32_16x16x32_bf16 v[206:209], v[146:149], v[110:113], v[206:209]
    v_mfma_f32_16x16x32_bf16 v[202:205], v[146:149], v[106:109], v[202:205]
    v_mfma_f32_16x16x32_bf16 v[198:201], v[146:149], v[102:105], v[198:201]
    v_mfma_f32_16x16x32_bf16 v[32:35], v[28:31], v[134:137], v[32:35]
    v_mfma_f32_16x16x32_bf16 v[36:39], v[28:31], v[138:141], v[36:39]
    s_waitcnt lgkmcnt(0)
    v_mfma_f32_16x16x32_bf16 v[150:153], v[118:121], v[86:89], v[150:153]
    ds_read_b64_tr_b16 v[134:135], v7 offset:40960
    v_mfma_f32_16x16x32_bf16 v[154:157], v[118:121], v[90:93], v[154:157]
    ds_read_b64_tr_b16 v[136:137], v7 offset:41984
    v_mfma_f32_16x16x32_bf16 v[158:161], v[118:121], v[94:97], v[158:161]
    ds_read_b128 v[102:105], v15 offset:0
    v_mfma_f32_16x16x32_bf16 v[162:165], v[118:121], v[98:101], v[162:165]
    ds_read_b128 v[106:109], v15 offset:2048
    v_mfma_f32_16x16x32_bf16 v[178:181], v[122:125], v[98:101], v[178:181]
    ds_read_b128 v[110:113], v15 offset:4096
    v_mfma_f32_16x16x32_bf16 v[174:177], v[122:125], v[94:97], v[174:177]
    ds_read_b128 v[114:117], v15 offset:6144
    v_mfma_f32_16x16x32_bf16 v[170:173], v[122:125], v[90:93], v[170:173]
    ds_read_b64_tr_b16 v[138:139], v8 offset:40960
    v_mfma_f32_16x16x32_bf16 v[166:169], v[122:125], v[86:89], v[166:169]
    ds_read_b64_tr_b16 v[140:141], v8 offset:41984
    v_mfma_f32_16x16x32_bf16 v[182:185], v[126:129], v[86:89], v[182:185]
    ds_read_b64_tr_b16 v[142:143], v9 offset:40960
    v_mfma_f32_16x16x32_bf16 v[186:189], v[126:129], v[90:93], v[186:189]
    ds_read_b64_tr_b16 v[144:145], v9 offset:41984
    v_mfma_f32_16x16x32_bf16 v[190:193], v[126:129], v[94:97], v[190:193]
    ds_read_b64_tr_b16 v[146:147], v10 offset:40960
    v_mfma_f32_16x16x32_bf16 v[194:197], v[126:129], v[98:101], v[194:197]
    ds_read_b64_tr_b16 v[148:149], v10 offset:41984
    v_mfma_f32_16x16x32_bf16 v[210:213], v[130:133], v[98:101], v[210:213]
    v_mfma_f32_16x16x32_bf16 v[206:209], v[130:133], v[94:97], v[206:209]
    v_mfma_f32_16x16x32_bf16 v[202:205], v[130:133], v[90:93], v[202:205]
    v_mfma_f32_16x16x32_bf16 v[198:201], v[130:133], v[86:89], v[198:201]
    v_mfma_f32_16x16x32_bf16 v[32:35], v[28:31], v[118:121], v[32:35]
    v_mfma_f32_16x16x32_bf16 v[36:39], v[28:31], v[122:125], v[36:39]
    s_waitcnt lgkmcnt(0)
    s_barrier
    v_mfma_f32_16x16x32_bf16 v[150:153], v[134:137], v[102:105], v[150:153]
    ds_read_b64_tr_b16 v[118:119], v7 offset:49152
    v_mfma_f32_16x16x32_bf16 v[154:157], v[134:137], v[106:109], v[154:157]
    ds_read_b64_tr_b16 v[120:121], v7 offset:50176
    v_mfma_f32_16x16x32_bf16 v[158:161], v[134:137], v[110:113], v[158:161]
    ds_read_b128 v[86:89], v5 offset:0
    v_mfma_f32_16x16x32_bf16 v[162:165], v[134:137], v[114:117], v[162:165]
    ds_read_b128 v[90:93], v5 offset:2048
    v_mfma_f32_16x16x32_bf16 v[178:181], v[138:141], v[114:117], v[178:181]
    ds_read_b128 v[94:97], v5 offset:4096
    v_mfma_f32_16x16x32_bf16 v[174:177], v[138:141], v[110:113], v[174:177]
    ds_read_b128 v[98:101], v5 offset:6144
    v_mfma_f32_16x16x32_bf16 v[170:173], v[138:141], v[106:109], v[170:173]
    ds_read_b64_tr_b16 v[122:123], v8 offset:49152
    v_mfma_f32_16x16x32_bf16 v[166:169], v[138:141], v[102:105], v[166:169]
    ds_read_b64_tr_b16 v[124:125], v8 offset:50176
    v_mfma_f32_16x16x32_bf16 v[182:185], v[142:145], v[102:105], v[182:185]
    ds_read_b64_tr_b16 v[126:127], v9 offset:49152
    v_mfma_f32_16x16x32_bf16 v[186:189], v[142:145], v[106:109], v[186:189]
    ds_read_b64_tr_b16 v[128:129], v9 offset:50176
    v_mfma_f32_16x16x32_bf16 v[190:193], v[142:145], v[110:113], v[190:193]
    ds_read_b64_tr_b16 v[130:131], v10 offset:49152
    v_mfma_f32_16x16x32_bf16 v[194:197], v[142:145], v[114:117], v[194:197]
    ds_read_b64_tr_b16 v[132:133], v10 offset:50176
    v_mfma_f32_16x16x32_bf16 v[210:213], v[146:149], v[114:117], v[210:213]
    v_mfma_f32_16x16x32_bf16 v[206:209], v[146:149], v[110:113], v[206:209]
    v_mfma_f32_16x16x32_bf16 v[202:205], v[146:149], v[106:109], v[202:205]
    v_mfma_f32_16x16x32_bf16 v[198:201], v[146:149], v[102:105], v[198:201]
    v_mfma_f32_16x16x32_bf16 v[32:35], v[28:31], v[134:137], v[32:35]
    v_mfma_f32_16x16x32_bf16 v[36:39], v[28:31], v[138:141], v[36:39]
    s_waitcnt lgkmcnt(0)
    v_mfma_f32_16x16x32_bf16 v[150:153], v[118:121], v[86:89], v[150:153]
    ds_read_b64_tr_b16 v[134:135], v7 offset:57344
    v_mfma_f32_16x16x32_bf16 v[154:157], v[118:121], v[90:93], v[154:157]
    ds_read_b64_tr_b16 v[136:137], v7 offset:58368
    v_mfma_f32_16x16x32_bf16 v[158:161], v[118:121], v[94:97], v[158:161]
    ds_read_b128 v[102:105], v6 offset:0
    v_mfma_f32_16x16x32_bf16 v[162:165], v[118:121], v[98:101], v[162:165]
    ds_read_b128 v[106:109], v6 offset:2048
    v_mfma_f32_16x16x32_bf16 v[178:181], v[122:125], v[98:101], v[178:181]
    ds_read_b128 v[110:113], v6 offset:4096
    v_mfma_f32_16x16x32_bf16 v[174:177], v[122:125], v[94:97], v[174:177]
    ds_read_b128 v[114:117], v6 offset:6144
    v_mfma_f32_16x16x32_bf16 v[170:173], v[122:125], v[90:93], v[170:173]
    ds_read_b64_tr_b16 v[138:139], v8 offset:57344
    v_mfma_f32_16x16x32_bf16 v[166:169], v[122:125], v[86:89], v[166:169]
    ds_read_b64_tr_b16 v[140:141], v8 offset:58368
    v_mfma_f32_16x16x32_bf16 v[182:185], v[126:129], v[86:89], v[182:185]
    ds_read_b64_tr_b16 v[142:143], v9 offset:57344
    v_mfma_f32_16x16x32_bf16 v[186:189], v[126:129], v[90:93], v[186:189]
    ds_read_b64_tr_b16 v[144:145], v9 offset:58368
    v_mfma_f32_16x16x32_bf16 v[190:193], v[126:129], v[94:97], v[190:193]
    ds_read_b64_tr_b16 v[146:147], v10 offset:57344
    v_mfma_f32_16x16x32_bf16 v[194:197], v[126:129], v[98:101], v[194:197]
    ds_read_b64_tr_b16 v[148:149], v10 offset:58368
    v_mfma_f32_16x16x32_bf16 v[210:213], v[130:133], v[98:101], v[210:213]
    v_mfma_f32_16x16x32_bf16 v[206:209], v[130:133], v[94:97], v[206:209]
    v_mfma_f32_16x16x32_bf16 v[202:205], v[130:133], v[90:93], v[202:205]
    v_mfma_f32_16x16x32_bf16 v[198:201], v[130:133], v[86:89], v[198:201]
    v_mfma_f32_16x16x32_bf16 v[32:35], v[28:31], v[118:121], v[32:35]
    v_mfma_f32_16x16x32_bf16 v[36:39], v[28:31], v[122:125], v[36:39]
    s_waitcnt lgkmcnt(0)
    s_barrier
    v_mfma_f32_16x16x32_bf16 v[150:153], v[134:137], v[102:105], v[150:153]
    ds_read_b64_tr_b16 v[118:119], v7 offset:0
    v_mfma_f32_16x16x32_bf16 v[154:157], v[134:137], v[106:109], v[154:157]
    ds_read_b64_tr_b16 v[120:121], v7 offset:1024
    v_mfma_f32_16x16x32_bf16 v[158:161], v[134:137], v[110:113], v[158:161]
    ds_read_b128 v[86:89], v5 offset:16384
    v_mfma_f32_16x16x32_bf16 v[162:165], v[134:137], v[114:117], v[162:165]
    ds_read_b128 v[90:93], v5 offset:18432
    v_mfma_f32_16x16x32_bf16 v[178:181], v[138:141], v[114:117], v[178:181]
    ds_read_b128 v[94:97], v5 offset:20480
    v_mfma_f32_16x16x32_bf16 v[174:177], v[138:141], v[110:113], v[174:177]
    ds_read_b128 v[98:101], v5 offset:22528
    v_mfma_f32_16x16x32_bf16 v[170:173], v[138:141], v[106:109], v[170:173]
    ds_read_b64_tr_b16 v[122:123], v8 offset:0
    v_mfma_f32_16x16x32_bf16 v[166:169], v[138:141], v[102:105], v[166:169]
    ds_read_b64_tr_b16 v[124:125], v8 offset:1024
    v_mfma_f32_16x16x32_bf16 v[182:185], v[142:145], v[102:105], v[182:185]
    ds_read_b64_tr_b16 v[126:127], v9 offset:0
    v_mfma_f32_16x16x32_bf16 v[186:189], v[142:145], v[106:109], v[186:189]
    ds_read_b64_tr_b16 v[128:129], v9 offset:1024
    v_mfma_f32_16x16x32_bf16 v[190:193], v[142:145], v[110:113], v[190:193]
    ds_read_b64_tr_b16 v[130:131], v10 offset:0
    v_mfma_f32_16x16x32_bf16 v[194:197], v[142:145], v[114:117], v[194:197]
    ds_read_b64_tr_b16 v[132:133], v10 offset:1024
    v_mfma_f32_16x16x32_bf16 v[210:213], v[146:149], v[114:117], v[210:213]
    v_mfma_f32_16x16x32_bf16 v[206:209], v[146:149], v[110:113], v[206:209]
    v_mfma_f32_16x16x32_bf16 v[202:205], v[146:149], v[106:109], v[202:205]
    v_mfma_f32_16x16x32_bf16 v[198:201], v[146:149], v[102:105], v[198:201]
    v_mfma_f32_16x16x32_bf16 v[32:35], v[28:31], v[134:137], v[32:35]
    v_mfma_f32_16x16x32_bf16 v[36:39], v[28:31], v[138:141], v[36:39]
    s_waitcnt lgkmcnt(0)
    v_mfma_f32_16x16x32_bf16 v[150:153], v[118:121], v[86:89], v[150:153]
    ds_read_b64_tr_b16 v[134:135], v7 offset:8192
    v_mfma_f32_16x16x32_bf16 v[154:157], v[118:121], v[90:93], v[154:157]
    ds_read_b64_tr_b16 v[136:137], v7 offset:9216
    v_mfma_f32_16x16x32_bf16 v[158:161], v[118:121], v[94:97], v[158:161]
    ds_read_b128 v[102:105], v6 offset:16384
    v_mfma_f32_16x16x32_bf16 v[162:165], v[118:121], v[98:101], v[162:165]
    ds_read_b128 v[106:109], v6 offset:18432
    v_mfma_f32_16x16x32_bf16 v[178:181], v[122:125], v[98:101], v[178:181]
    ds_read_b128 v[110:113], v6 offset:20480
    v_mfma_f32_16x16x32_bf16 v[174:177], v[122:125], v[94:97], v[174:177]
    ds_read_b128 v[114:117], v6 offset:22528
    v_mfma_f32_16x16x32_bf16 v[170:173], v[122:125], v[90:93], v[170:173]
    ds_read_b64_tr_b16 v[138:139], v8 offset:8192
    v_mfma_f32_16x16x32_bf16 v[166:169], v[122:125], v[86:89], v[166:169]
    ds_read_b64_tr_b16 v[140:141], v8 offset:9216
    v_mfma_f32_16x16x32_bf16 v[182:185], v[126:129], v[86:89], v[182:185]
    ds_read_b64_tr_b16 v[142:143], v9 offset:8192
    v_mfma_f32_16x16x32_bf16 v[186:189], v[126:129], v[90:93], v[186:189]
    ds_read_b64_tr_b16 v[144:145], v9 offset:9216
    v_mfma_f32_16x16x32_bf16 v[190:193], v[126:129], v[94:97], v[190:193]
    ds_read_b64_tr_b16 v[146:147], v10 offset:8192
    v_mfma_f32_16x16x32_bf16 v[194:197], v[126:129], v[98:101], v[194:197]
    ds_read_b64_tr_b16 v[148:149], v10 offset:9216
    v_mfma_f32_16x16x32_bf16 v[210:213], v[130:133], v[98:101], v[210:213]
    v_mfma_f32_16x16x32_bf16 v[206:209], v[130:133], v[94:97], v[206:209]
    v_mfma_f32_16x16x32_bf16 v[202:205], v[130:133], v[90:93], v[202:205]
    v_mfma_f32_16x16x32_bf16 v[198:201], v[130:133], v[86:89], v[198:201]
    v_mfma_f32_16x16x32_bf16 v[32:35], v[28:31], v[118:121], v[32:35]
    v_mfma_f32_16x16x32_bf16 v[36:39], v[28:31], v[122:125], v[36:39]
    s_waitcnt lgkmcnt(0)
    s_barrier
    v_mfma_f32_16x16x32_bf16 v[150:153], v[134:137], v[102:105], v[150:153]
    ds_read_b64_tr_b16 v[118:119], v7 offset:16384
    v_mfma_f32_16x16x32_bf16 v[154:157], v[134:137], v[106:109], v[154:157]
    ds_read_b64_tr_b16 v[120:121], v7 offset:17408
    v_mfma_f32_16x16x32_bf16 v[158:161], v[134:137], v[110:113], v[158:161]
    ds_read_b128 v[86:89], v5 offset:32768
    v_mfma_f32_16x16x32_bf16 v[162:165], v[134:137], v[114:117], v[162:165]
    ds_read_b128 v[90:93], v5 offset:34816
    v_mfma_f32_16x16x32_bf16 v[178:181], v[138:141], v[114:117], v[178:181]
    ds_read_b128 v[94:97], v5 offset:36864
    v_mfma_f32_16x16x32_bf16 v[174:177], v[138:141], v[110:113], v[174:177]
    ds_read_b128 v[98:101], v5 offset:38912
    v_mfma_f32_16x16x32_bf16 v[170:173], v[138:141], v[106:109], v[170:173]
    ds_read_b64_tr_b16 v[122:123], v8 offset:16384
    v_mfma_f32_16x16x32_bf16 v[166:169], v[138:141], v[102:105], v[166:169]
    ds_read_b64_tr_b16 v[124:125], v8 offset:17408
    v_mfma_f32_16x16x32_bf16 v[182:185], v[142:145], v[102:105], v[182:185]
    ds_read_b64_tr_b16 v[126:127], v9 offset:16384
    v_mfma_f32_16x16x32_bf16 v[186:189], v[142:145], v[106:109], v[186:189]
    ds_read_b64_tr_b16 v[128:129], v9 offset:17408
    v_mfma_f32_16x16x32_bf16 v[190:193], v[142:145], v[110:113], v[190:193]
    ds_read_b64_tr_b16 v[130:131], v10 offset:16384
    v_mfma_f32_16x16x32_bf16 v[194:197], v[142:145], v[114:117], v[194:197]
    ds_read_b64_tr_b16 v[132:133], v10 offset:17408
    v_mfma_f32_16x16x32_bf16 v[210:213], v[146:149], v[114:117], v[210:213]
    v_mfma_f32_16x16x32_bf16 v[206:209], v[146:149], v[110:113], v[206:209]
    v_mfma_f32_16x16x32_bf16 v[202:205], v[146:149], v[106:109], v[202:205]
    v_mfma_f32_16x16x32_bf16 v[198:201], v[146:149], v[102:105], v[198:201]
    v_mfma_f32_16x16x32_bf16 v[32:35], v[28:31], v[134:137], v[32:35]
    v_mfma_f32_16x16x32_bf16 v[36:39], v[28:31], v[138:141], v[36:39]
    s_waitcnt lgkmcnt(0)
    v_mfma_f32_16x16x32_bf16 v[150:153], v[118:121], v[86:89], v[150:153]
    ds_read_b64_tr_b16 v[134:135], v7 offset:24576
    v_mfma_f32_16x16x32_bf16 v[154:157], v[118:121], v[90:93], v[154:157]
    ds_read_b64_tr_b16 v[136:137], v7 offset:25600
    v_mfma_f32_16x16x32_bf16 v[158:161], v[118:121], v[94:97], v[158:161]
    ds_read_b128 v[102:105], v6 offset:32768
    v_mfma_f32_16x16x32_bf16 v[162:165], v[118:121], v[98:101], v[162:165]
    ds_read_b128 v[106:109], v6 offset:34816
    v_mfma_f32_16x16x32_bf16 v[178:181], v[122:125], v[98:101], v[178:181]
    ds_read_b128 v[110:113], v6 offset:36864
    v_mfma_f32_16x16x32_bf16 v[174:177], v[122:125], v[94:97], v[174:177]
    ds_read_b128 v[114:117], v6 offset:38912
    v_mfma_f32_16x16x32_bf16 v[170:173], v[122:125], v[90:93], v[170:173]
    ds_read_b64_tr_b16 v[138:139], v8 offset:24576
    v_mfma_f32_16x16x32_bf16 v[166:169], v[122:125], v[86:89], v[166:169]
    ds_read_b64_tr_b16 v[140:141], v8 offset:25600
    v_mfma_f32_16x16x32_bf16 v[182:185], v[126:129], v[86:89], v[182:185]
    ds_read_b64_tr_b16 v[142:143], v9 offset:24576
    v_mfma_f32_16x16x32_bf16 v[186:189], v[126:129], v[90:93], v[186:189]
    ds_read_b64_tr_b16 v[144:145], v9 offset:25600
    v_mfma_f32_16x16x32_bf16 v[190:193], v[126:129], v[94:97], v[190:193]
    ds_read_b64_tr_b16 v[146:147], v10 offset:24576
    v_mfma_f32_16x16x32_bf16 v[194:197], v[126:129], v[98:101], v[194:197]
    ds_read_b64_tr_b16 v[148:149], v10 offset:25600
    v_mfma_f32_16x16x32_bf16 v[210:213], v[130:133], v[98:101], v[210:213]
    v_mfma_f32_16x16x32_bf16 v[206:209], v[130:133], v[94:97], v[206:209]
    v_mfma_f32_16x16x32_bf16 v[202:205], v[130:133], v[90:93], v[202:205]
    v_mfma_f32_16x16x32_bf16 v[198:201], v[130:133], v[86:89], v[198:201]
    v_mfma_f32_16x16x32_bf16 v[32:35], v[28:31], v[118:121], v[32:35]
    v_mfma_f32_16x16x32_bf16 v[36:39], v[28:31], v[122:125], v[36:39]
    s_waitcnt lgkmcnt(0)
    s_barrier
    v_mfma_f32_16x16x32_bf16 v[150:153], v[134:137], v[102:105], v[150:153]
    ds_read_b64_tr_b16 v[118:119], v7 offset:32768
    v_mfma_f32_16x16x32_bf16 v[154:157], v[134:137], v[106:109], v[154:157]
    ds_read_b64_tr_b16 v[120:121], v7 offset:33792
    v_mfma_f32_16x16x32_bf16 v[158:161], v[134:137], v[110:113], v[158:161]
    ds_read_b128 v[86:89], v5 offset:49152
    v_mfma_f32_16x16x32_bf16 v[162:165], v[134:137], v[114:117], v[162:165]
    ds_read_b128 v[90:93], v5 offset:51200
    v_mfma_f32_16x16x32_bf16 v[178:181], v[138:141], v[114:117], v[178:181]
    ds_read_b128 v[94:97], v5 offset:53248
    v_mfma_f32_16x16x32_bf16 v[174:177], v[138:141], v[110:113], v[174:177]
    ds_read_b128 v[98:101], v5 offset:55296
    v_mfma_f32_16x16x32_bf16 v[170:173], v[138:141], v[106:109], v[170:173]
    ds_read_b64_tr_b16 v[122:123], v8 offset:32768
    v_mfma_f32_16x16x32_bf16 v[166:169], v[138:141], v[102:105], v[166:169]
    ds_read_b64_tr_b16 v[124:125], v8 offset:33792
    v_mfma_f32_16x16x32_bf16 v[182:185], v[142:145], v[102:105], v[182:185]
    ds_read_b64_tr_b16 v[126:127], v9 offset:32768
    v_mfma_f32_16x16x32_bf16 v[186:189], v[142:145], v[106:109], v[186:189]
    ds_read_b64_tr_b16 v[128:129], v9 offset:33792
    v_mfma_f32_16x16x32_bf16 v[190:193], v[142:145], v[110:113], v[190:193]
    ds_read_b64_tr_b16 v[130:131], v10 offset:32768
    v_mfma_f32_16x16x32_bf16 v[194:197], v[142:145], v[114:117], v[194:197]
    ds_read_b64_tr_b16 v[132:133], v10 offset:33792
    v_mfma_f32_16x16x32_bf16 v[210:213], v[146:149], v[114:117], v[210:213]
    v_mfma_f32_16x16x32_bf16 v[206:209], v[146:149], v[110:113], v[206:209]
    v_mfma_f32_16x16x32_bf16 v[202:205], v[146:149], v[106:109], v[202:205]
    v_mfma_f32_16x16x32_bf16 v[198:201], v[146:149], v[102:105], v[198:201]
    v_mfma_f32_16x16x32_bf16 v[32:35], v[28:31], v[134:137], v[32:35]
    v_mfma_f32_16x16x32_bf16 v[36:39], v[28:31], v[138:141], v[36:39]
    s_waitcnt lgkmcnt(0)
    v_mfma_f32_16x16x32_bf16 v[150:153], v[118:121], v[86:89], v[150:153]
    ds_read_b64_tr_b16 v[134:135], v7 offset:40960
    v_mfma_f32_16x16x32_bf16 v[154:157], v[118:121], v[90:93], v[154:157]
    ds_read_b64_tr_b16 v[136:137], v7 offset:41984
    v_mfma_f32_16x16x32_bf16 v[158:161], v[118:121], v[94:97], v[158:161]
    ds_read_b128 v[102:105], v6 offset:49152
    v_mfma_f32_16x16x32_bf16 v[162:165], v[118:121], v[98:101], v[162:165]
    ds_read_b128 v[106:109], v6 offset:51200
    v_mfma_f32_16x16x32_bf16 v[178:181], v[122:125], v[98:101], v[178:181]
    ds_read_b128 v[110:113], v6 offset:53248
    v_mfma_f32_16x16x32_bf16 v[174:177], v[122:125], v[94:97], v[174:177]
    ds_read_b128 v[114:117], v6 offset:55296
    v_mfma_f32_16x16x32_bf16 v[170:173], v[122:125], v[90:93], v[170:173]
    ds_read_b64_tr_b16 v[138:139], v8 offset:40960
    v_mfma_f32_16x16x32_bf16 v[166:169], v[122:125], v[86:89], v[166:169]
    ds_read_b64_tr_b16 v[140:141], v8 offset:41984
    v_mfma_f32_16x16x32_bf16 v[182:185], v[126:129], v[86:89], v[182:185]
    ds_read_b64_tr_b16 v[142:143], v9 offset:40960
    v_mfma_f32_16x16x32_bf16 v[186:189], v[126:129], v[90:93], v[186:189]
    ds_read_b64_tr_b16 v[144:145], v9 offset:41984
    v_mfma_f32_16x16x32_bf16 v[190:193], v[126:129], v[94:97], v[190:193]
    ds_read_b64_tr_b16 v[146:147], v10 offset:40960
    v_mfma_f32_16x16x32_bf16 v[194:197], v[126:129], v[98:101], v[194:197]
    ds_read_b64_tr_b16 v[148:149], v10 offset:41984
    v_mfma_f32_16x16x32_bf16 v[210:213], v[130:133], v[98:101], v[210:213]
    v_mfma_f32_16x16x32_bf16 v[206:209], v[130:133], v[94:97], v[206:209]
    v_mfma_f32_16x16x32_bf16 v[202:205], v[130:133], v[90:93], v[202:205]
    v_mfma_f32_16x16x32_bf16 v[198:201], v[130:133], v[86:89], v[198:201]
    v_mfma_f32_16x16x32_bf16 v[32:35], v[28:31], v[118:121], v[32:35]
    v_mfma_f32_16x16x32_bf16 v[36:39], v[28:31], v[122:125], v[36:39]
    s_waitcnt lgkmcnt(0)
    s_barrier
    v_mfma_f32_16x16x32_bf16 v[150:153], v[134:137], v[102:105], v[150:153]
    ds_read_b64_tr_b16 v[118:119], v7 offset:49152
    v_mfma_f32_16x16x32_bf16 v[154:157], v[134:137], v[106:109], v[154:157]
    ds_read_b64_tr_b16 v[120:121], v7 offset:50176
    v_mfma_f32_16x16x32_bf16 v[158:161], v[134:137], v[110:113], v[158:161]
    ds_read_b128 v[86:89], v14 offset:0
    v_mfma_f32_16x16x32_bf16 v[162:165], v[134:137], v[114:117], v[162:165]
    ds_read_b128 v[90:93], v14 offset:2048
    v_mfma_f32_16x16x32_bf16 v[178:181], v[138:141], v[114:117], v[178:181]
    ds_read_b128 v[94:97], v14 offset:4096
    v_mfma_f32_16x16x32_bf16 v[174:177], v[138:141], v[110:113], v[174:177]
    ds_read_b128 v[98:101], v14 offset:6144
    v_mfma_f32_16x16x32_bf16 v[170:173], v[138:141], v[106:109], v[170:173]
    ds_read_b64_tr_b16 v[122:123], v8 offset:49152
    v_mfma_f32_16x16x32_bf16 v[166:169], v[138:141], v[102:105], v[166:169]
    ds_read_b64_tr_b16 v[124:125], v8 offset:50176
    v_mfma_f32_16x16x32_bf16 v[182:185], v[142:145], v[102:105], v[182:185]
    ds_read_b64_tr_b16 v[126:127], v9 offset:49152
    v_mfma_f32_16x16x32_bf16 v[186:189], v[142:145], v[106:109], v[186:189]
    ds_read_b64_tr_b16 v[128:129], v9 offset:50176
    v_mfma_f32_16x16x32_bf16 v[190:193], v[142:145], v[110:113], v[190:193]
    ds_read_b64_tr_b16 v[130:131], v10 offset:49152
    v_mfma_f32_16x16x32_bf16 v[194:197], v[142:145], v[114:117], v[194:197]
    ds_read_b64_tr_b16 v[132:133], v10 offset:50176
    v_mfma_f32_16x16x32_bf16 v[210:213], v[146:149], v[114:117], v[210:213]
    v_mfma_f32_16x16x32_bf16 v[206:209], v[146:149], v[110:113], v[206:209]
    v_mfma_f32_16x16x32_bf16 v[202:205], v[146:149], v[106:109], v[202:205]
    v_mfma_f32_16x16x32_bf16 v[198:201], v[146:149], v[102:105], v[198:201]
    v_mfma_f32_16x16x32_bf16 v[32:35], v[28:31], v[134:137], v[32:35]
    v_mfma_f32_16x16x32_bf16 v[36:39], v[28:31], v[138:141], v[36:39]
    s_waitcnt lgkmcnt(0)
    v_mfma_f32_16x16x32_bf16 v[150:153], v[118:121], v[86:89], v[150:153]
    ds_read_b64_tr_b16 v[134:135], v7 offset:57344
    v_mfma_f32_16x16x32_bf16 v[154:157], v[118:121], v[90:93], v[154:157]
    ds_read_b64_tr_b16 v[136:137], v7 offset:58368
    v_mfma_f32_16x16x32_bf16 v[158:161], v[118:121], v[94:97], v[158:161]
    ds_read_b128 v[102:105], v15 offset:0
    v_mfma_f32_16x16x32_bf16 v[162:165], v[118:121], v[98:101], v[162:165]
    ds_read_b128 v[106:109], v15 offset:2048
    v_mfma_f32_16x16x32_bf16 v[178:181], v[122:125], v[98:101], v[178:181]
    ds_read_b128 v[110:113], v15 offset:4096
    v_mfma_f32_16x16x32_bf16 v[174:177], v[122:125], v[94:97], v[174:177]
    ds_read_b128 v[114:117], v15 offset:6144
    v_mfma_f32_16x16x32_bf16 v[170:173], v[122:125], v[90:93], v[170:173]
    ds_read_b64_tr_b16 v[138:139], v8 offset:57344
    v_mfma_f32_16x16x32_bf16 v[166:169], v[122:125], v[86:89], v[166:169]
    ds_read_b64_tr_b16 v[140:141], v8 offset:58368
    v_mfma_f32_16x16x32_bf16 v[182:185], v[126:129], v[86:89], v[182:185]
    ds_read_b64_tr_b16 v[142:143], v9 offset:57344
    v_mfma_f32_16x16x32_bf16 v[186:189], v[126:129], v[90:93], v[186:189]
    ds_read_b64_tr_b16 v[144:145], v9 offset:58368
    v_mfma_f32_16x16x32_bf16 v[190:193], v[126:129], v[94:97], v[190:193]
    ds_read_b64_tr_b16 v[146:147], v10 offset:57344
    v_mfma_f32_16x16x32_bf16 v[194:197], v[126:129], v[98:101], v[194:197]
    ds_read_b64_tr_b16 v[148:149], v10 offset:58368
    v_mfma_f32_16x16x32_bf16 v[210:213], v[130:133], v[98:101], v[210:213]
    v_mfma_f32_16x16x32_bf16 v[206:209], v[130:133], v[94:97], v[206:209]
    v_mfma_f32_16x16x32_bf16 v[202:205], v[130:133], v[90:93], v[202:205]
    v_mfma_f32_16x16x32_bf16 v[198:201], v[130:133], v[86:89], v[198:201]
    v_mfma_f32_16x16x32_bf16 v[32:35], v[28:31], v[118:121], v[32:35]
    v_mfma_f32_16x16x32_bf16 v[36:39], v[28:31], v[122:125], v[36:39]
    s_waitcnt lgkmcnt(0)
    v_mfma_f32_16x16x32_bf16 v[32:35], v[28:31], v[134:137], v[32:35]
    v_mfma_f32_16x16x32_bf16 v[36:39], v[28:31], v[138:141], v[36:39]
    v_mfma_f32_16x16x32_bf16 v[150:153], v[134:137], v[102:105], v[150:153]
    v_mfma_f32_16x16x32_bf16 v[154:157], v[134:137], v[106:109], v[154:157]
    v_mfma_f32_16x16x32_bf16 v[158:161], v[134:137], v[110:113], v[158:161]
    v_mfma_f32_16x16x32_bf16 v[162:165], v[134:137], v[114:117], v[162:165]
    v_mfma_f32_16x16x32_bf16 v[178:181], v[138:141], v[114:117], v[178:181]
    v_mfma_f32_16x16x32_bf16 v[174:177], v[138:141], v[110:113], v[174:177]
    v_mfma_f32_16x16x32_bf16 v[170:173], v[138:141], v[106:109], v[170:173]
    v_mfma_f32_16x16x32_bf16 v[166:169], v[138:141], v[102:105], v[166:169]
    s_mov_b64 exec, 0xffff
    ds_write_b32 v11, v32 offset:0
    ds_write_b32 v11, v36 offset:64
    s_mov_b64 exec, -1
    v_mov_b32 v20, s19
    v_lshlrev_b32 v20, 2, v20
    v_mov_b32 v21, 1
    s_waitcnt lgkmcnt(0)
    ds_write_b32 v20, v21 offset:4080
    v_xor_b32 v20, 8, v20
    v_mfma_f32_16x16x32_bf16 v[182:185], v[142:145], v[102:105], v[182:185]
    v_mfma_f32_16x16x32_bf16 v[186:189], v[142:145], v[106:109], v[186:189]
    v_mfma_f32_16x16x32_bf16 v[190:193], v[142:145], v[110:113], v[190:193]
    v_mfma_f32_16x16x32_bf16 v[194:197], v[142:145], v[114:117], v[194:197]
    v_mfma_f32_16x16x32_bf16 v[210:213], v[146:149], v[114:117], v[210:213]
    v_mfma_f32_16x16x32_bf16 v[206:209], v[146:149], v[110:113], v[206:209]
    v_mfma_f32_16x16x32_bf16 v[202:205], v[146:149], v[106:109], v[202:205]
    v_mfma_f32_16x16x32_bf16 v[198:201], v[146:149], v[102:105], v[198:201]
    s_mov_b32 s63, 240000
P1_CSW_5:
    ds_read_b32 v21, v20 offset:4080
    s_waitcnt lgkmcnt(0)
    v_cmp_eq_u32 vcc, 0, v21
    s_cbranch_vccz P1_CSD_6
    s_sub_u32 s63, s63, 1
    s_cmp_lg_u32 s63, 0
    s_cbranch_scc1 P1_CSW_5
P1_CSD_6:
    ds_read_b128 v[118:121], v27 offset:0
    ds_read_b128 v[122:125], v27 offset:64
    ds_read_b128 v[126:129], v26 offset:0
    ds_read_b128 v[130:133], v26 offset:64
    s_nop 2
    s_waitcnt lgkmcnt(2)
    v_pk_fma_f32 v[150:151], v[118:119], v[76:77], v[150:151] op_sel:[0,0,0] op_sel_hi:[1,0,1]
    v_pk_fma_f32 v[152:153], v[120:121], v[76:77], v[152:153] op_sel:[0,0,0] op_sel_hi:[1,0,1]
    v_pk_fma_f32 v[166:167], v[122:123], v[76:77], v[166:167] op_sel:[0,0,0] op_sel_hi:[1,0,1]
    v_pk_fma_f32 v[168:169], v[124:125], v[76:77], v[168:169] op_sel:[0,0,0] op_sel_hi:[1,0,1]
    v_pk_fma_f32 v[150:151], v[150:151], v[76:77], v[40:41] op_sel:[0,1,0] op_sel_hi:[1,1,1]
    v_pk_fma_f32 v[152:153], v[152:153], v[76:77], v[42:43] op_sel:[0,1,0] op_sel_hi:[1,1,1]
    v_pk_fma_f32 v[166:167], v[166:167], v[76:77], v[44:45] op_sel:[0,1,0] op_sel_hi:[1,1,1]
    v_pk_fma_f32 v[168:169], v[168:169], v[76:77], v[46:47] op_sel:[0,1,0] op_sel_hi:[1,1,1]
    v_pk_mul_f32 v[56:57], v[150:151], v[150:151]
    v_pk_mul_f32 v[58:59], v[152:153], v[152:153]
    v_pk_mul_f32 v[60:61], v[166:167], v[166:167]
    v_pk_mul_f32 v[62:63], v[168:169], v[168:169]
    v_pk_fma_f32 v[56:57], v[56:57], v[84:85], s[56:57]
    v_pk_fma_f32 v[58:59], v[58:59], v[84:85], s[56:57]
    v_pk_fma_f32 v[60:61], v[60:61], v[84:85], s[56:57]
    v_pk_fma_f32 v[62:63], v[62:63], v[84:85], s[56:57]
    v_pk_mul_f32 v[56:57], v[56:57], v[150:151]
    v_pk_mul_f32 v[58:59], v[58:59], v[152:153]
    v_pk_mul_f32 v[60:61], v[60:61], v[166:167]
    v_pk_mul_f32 v[62:63], v[62:63], v[168:169]
    v_exp_f32 v56, v56
    v_pk_fma_f32 v[154:155], v[118:119], v[78:79], v[154:155] op_sel:[0,0,0] op_sel_hi:[1,0,1]
    v_exp_f32 v57, v57
    v_pk_fma_f32 v[156:157], v[120:121], v[78:79], v[156:157] op_sel:[0,0,0] op_sel_hi:[1,0,1]
    v_exp_f32 v58, v58
    v_pk_fma_f32 v[170:171], v[122:123], v[78:79], v[170:171] op_sel:[0,0,0] op_sel_hi:[1,0,1]
    v_exp_f32 v59, v59
    v_pk_fma_f32 v[172:173], v[124:125], v[78:79], v[172:173] op_sel:[0,0,0] op_sel_hi:[1,0,1]
    v_pk_fma_f32 v[154:155], v[154:155], v[78:79], v[40:41] op_sel:[0,1,0] op_sel_hi:[1,1,1]
    v_exp_f32 v60, v60
    v_pk_fma_f32 v[156:157], v[156:157], v[78:79], v[42:43] op_sel:[0,1,0] op_sel_hi:[1,1,1]
    v_exp_f32 v61, v61
    v_pk_fma_f32 v[170:171], v[170:171], v[78:79], v[44:45] op_sel:[0,1,0] op_sel_hi:[1,1,1]
    v_exp_f32 v62, v62
    v_pk_fma_f32 v[172:173], v[172:173], v[78:79], v[46:47] op_sel:[0,1,0] op_sel_hi:[1,1,1]
    v_exp_f32 v63, v63
    v_pk_mul_f32 v[64:65], v[154:155], v[154:155]
    v_pk_mul_f32 v[66:67], v[156:157], v[156:157]
    v_pk_add_f32 v[56:57], v[56:57], 1.0 op_sel_hi:[1,0]
    v_pk_add_f32 v[58:59], v[58:59], 1.0 op_sel_hi:[1,0]
    v_pk_add_f32 v[60:61], v[60:61], 1.0 op_sel_hi:[1,0]
    v_pk_add_f32 v[62:63], v[62:63], 1.0 op_sel_hi:[1,0]
    v_rcp_f32 v56, v56
    v_pk_mul_f32 v[68:69], v[170:171], v[170:171]
    v_rcp_f32 v57, v57
    v_pk_mul_f32 v[70:71], v[172:173], v[172:173]
    v_rcp_f32 v58, v58
    v_pk_fma_f32 v[64:65], v[64:65], v[84:85], s[56:57]
    v_rcp_f32 v59, v59
    v_pk_fma_f32 v[66:67], v[66:67], v[84:85], s[56:57]
    v_pk_fma_f32 v[68:69], v[68:69], v[84:85], s[56:57]
    v_rcp_f32 v60, v60
    v_pk_fma_f32 v[70:71], v[70:71], v[84:85], s[56:57]
    v_rcp_f32 v61, v61
    v_pk_mul_f32 v[64:65], v[64:65], v[154:155]
    v_rcp_f32 v62, v62
    v_pk_mul_f32 v[66:67], v[66:67], v[156:157]
    v_rcp_f32 v63, v63
    v_pk_mul_f32 v[68:69], v[68:69], v[170:171]
    v_pk_mul_f32 v[70:71], v[70:71], v[172:173]
    v_exp_f32 v64, v64
    v_pk_mul_f32 v[150:151], v[150:151], v[56:57]
    v_exp_f32 v65, v65
    v_pk_mul_f32 v[152:153], v[152:153], v[58:59]
    v_pk_mul_f32 v[166:167], v[166:167], v[60:61]
    v_exp_f32 v66, v66
    v_pk_mul_f32 v[168:169], v[168:169], v[62:63]
    v_cvt_pk_bf16_f32 v214, v150, v151
    v_exp_f32 v67, v67
    v_cvt_pk_bf16_f32 v215, v152, v153
    v_cvt_pk_bf16_f32 v216, v166, v167
    v_exp_f32 v68, v68
    v_cvt_pk_bf16_f32 v217, v168, v169
    v_exp_f32 v69, v69
    v_pk_fma_f32 v[158:159], v[118:119], v[80:81], v[158:159] op_sel:[0,0,0] op_sel_hi:[1,0,1]
    v_pk_fma_f32 v[160:161], v[120:121], v[80:81], v[160:161] op_sel:[0,0,0] op_sel_hi:[1,0,1]
    v_exp_f32 v70, v70
    v_pk_fma_f32 v[174:175], v[122:123], v[80:81], v[174:175] op_sel:[0,0,0] op_sel_hi:[1,0,1]
    v_pk_fma_f32 v[176:177], v[124:125], v[80:81], v[176:177] op_sel:[0,0,0] op_sel_hi:[1,0,1]
    v_exp_f32 v71, v71
    v_pk_fma_f32 v[158:159], v[158:159], v[80:81], v[40:41] op_sel:[0,1,0] op_sel_hi:[1,1,1]
    v_pk_fma_f32 v[160:161], v[160:161], v[80:81], v[42:43] op_sel:[0,1,0] op_sel_hi:[1,1,1]
    v_pk_add_f32 v[64:65], v[64:65], 1.0 op_sel_hi:[1,0]
    v_pk_add_f32 v[66:67], v[66:67], 1.0 op_sel_hi:[1,0]
    v_pk_add_f32 v[68:69], v[68:69], 1.0 op_sel_hi:[1,0]
    v_pk_add_f32 v[70:71], v[70:71], 1.0 op_sel_hi:[1,0]
    v_rcp_f32 v64, v64
    v_pk_fma_f32 v[174:175], v[174:175], v[80:81], v[44:45] op_sel:[0,1,0] op_sel_hi:[1,1,1]
    v_rcp_f32 v65, v65
    v_pk_fma_f32 v[176:177], v[176:177], v[80:81], v[46:47] op_sel:[0,1,0] op_sel_hi:[1,1,1]
    v_pk_mul_f32 v[56:57], v[158:159], v[158:159]
    v_rcp_f32 v66, v66
    v_pk_mul_f32 v[58:59], v[160:161], v[160:161]
    v_pk_mul_f32 v[60:61], v[174:175], v[174:175]
    v_rcp_f32 v67, v67
    v_pk_mul_f32 v[62:63], v[176:177], v[176:177]
    v_pk_fma_f32 v[56:57], v[56:57], v[84:85], s[56:57]
    v_rcp_f32 v68, v68
    v_pk_fma_f32 v[58:59], v[58:59], v[84:85], s[56:57]
    v_rcp_f32 v69, v69
    v_pk_fma_f32 v[60:61], v[60:61], v[84:85], s[56:57]
    v_pk_fma_f32 v[62:63], v[62:63], v[84:85], s[56:57]
    v_rcp_f32 v70, v70
    v_pk_mul_f32 v[56:57], v[56:57], v[158:159]
    v_pk_mul_f32 v[58:59], v[58:59], v[160:161]
    v_rcp_f32 v71, v71
    v_pk_mul_f32 v[60:61], v[60:61], v[174:175]
    v_pk_mul_f32 v[62:63], v[62:63], v[176:177]
    v_exp_f32 v56, v56
    v_pk_mul_f32 v[154:155], v[154:155], v[64:65]
    v_exp_f32 v57, v57
    v_pk_mul_f32 v[156:157], v[156:157], v[66:67]
    v_pk_mul_f32 v[170:171], v[170:171], v[68:69]
    v_exp_f32 v58, v58
    v_pk_mul_f32 v[172:173], v[172:173], v[70:71]
    v_cvt_pk_bf16_f32 v218, v154, v155
    v_exp_f32 v59, v59
    v_cvt_pk_bf16_f32 v219, v156, v157
    v_cvt_pk_bf16_f32 v220, v170, v171
    v_exp_f32 v60, v60
    v_cvt_pk_bf16_f32 v221, v172, v173
    v_exp_f32 v61, v61
    v_pk_fma_f32 v[162:163], v[118:119], v[82:83], v[162:163] op_sel:[0,0,0] op_sel_hi:[1,0,1]
    v_pk_fma_f32 v[164:165], v[120:121], v[82:83], v[164:165] op_sel:[0,0,0] op_sel_hi:[1,0,1]
    v_exp_f32 v62, v62
    v_pk_fma_f32 v[178:179], v[122:123], v[82:83], v[178:179] op_sel:[0,0,0] op_sel_hi:[1,0,1]
    v_pk_fma_f32 v[180:181], v[124:125], v[82:83], v[180:181] op_sel:[0,0,0] op_sel_hi:[1,0,1]
    v_exp_f32 v63, v63
    v_pk_fma_f32 v[162:163], v[162:163], v[82:83], v[40:41] op_sel:[0,1,0] op_sel_hi:[1,1,1]
    v_pk_fma_f32 v[164:165], v[164:165], v[82:83], v[42:43] op_sel:[0,1,0] op_sel_hi:[1,1,1]
    v_pk_add_f32 v[56:57], v[56:57], 1.0 op_sel_hi:[1,0]
    v_pk_add_f32 v[58:59], v[58:59], 1.0 op_sel_hi:[1,0]
    v_pk_add_f32 v[60:61], v[60:61], 1.0 op_sel_hi:[1,0]
    v_pk_add_f32 v[62:63], v[62:63], 1.0 op_sel_hi:[1,0]
    v_rcp_f32 v56, v56
    v_pk_fma_f32 v[178:179], v[178:179], v[82:83], v[44:45] op_sel:[0,1,0] op_sel_hi:[1,1,1]
    v_rcp_f32 v57, v57
    v_pk_fma_f32 v[180:181], v[180:181], v[82:83], v[46:47] op_sel:[0,1,0] op_sel_hi:[1,1,1]
    v_pk_mul_f32 v[64:65], v[162:163], v[162:163]
    v_rcp_f32 v58, v58
    v_pk_mul_f32 v[66:67], v[164:165], v[164:165]
    v_pk_mul_f32 v[68:69], v[178:179], v[178:179]
    v_rcp_f32 v59, v59
    v_pk_mul_f32 v[70:71], v[180:181], v[180:181]
    v_pk_fma_f32 v[64:65], v[64:65], v[84:85], s[56:57]
    v_rcp_f32 v60, v60
    v_pk_fma_f32 v[66:67], v[66:67], v[84:85], s[56:57]
    v_rcp_f32 v61, v61
    v_pk_fma_f32 v[68:69], v[68:69], v[84:85], s[56:57]
    v_pk_fma_f32 v[70:71], v[70:71], v[84:85], s[56:57]
    v_rcp_f32 v62, v62
    v_pk_mul_f32 v[64:65], v[64:65], v[162:163]
    v_pk_mul_f32 v[66:67], v[66:67], v[164:165]
    v_rcp_f32 v63, v63
    v_pk_mul_f32 v[68:69], v[68:69], v[178:179]
    v_pk_mul_f32 v[70:71], v[70:71], v[180:181]
    v_exp_f32 v64, v64
    v_pk_mul_f32 v[158:159], v[158:159], v[56:57]
    v_exp_f32 v65, v65
    v_pk_mul_f32 v[160:161], v[160:161], v[58:59]
    v_pk_mul_f32 v[174:175], v[174:175], v[60:61]
    v_exp_f32 v66, v66
    v_pk_mul_f32 v[176:177], v[176:177], v[62:63]
    v_cvt_pk_bf16_f32 v222, v158, v159
    v_exp_f32 v67, v67
    v_cvt_pk_bf16_f32 v223, v160, v161
    v_cvt_pk_bf16_f32 v224, v174, v175
    v_exp_f32 v68, v68
    v_cvt_pk_bf16_f32 v225, v176, v177
    v_exp_f32 v69, v69
    s_waitcnt lgkmcnt(0)
    v_pk_fma_f32 v[182:183], v[126:127], v[76:77], v[182:183] op_sel:[0,0,0] op_sel_hi:[1,0,1]
    v_exp_f32 v70, v70
    v_pk_fma_f32 v[184:185], v[128:129], v[76:77], v[184:185] op_sel:[0,0,0] op_sel_hi:[1,0,1]
    v_pk_fma_f32 v[198:199], v[130:131], v[76:77], v[198:199] op_sel:[0,0,0] op_sel_hi:[1,0,1]
    v_exp_f32 v71, v71
    v_pk_fma_f32 v[200:201], v[132:133], v[76:77], v[200:201] op_sel:[0,0,0] op_sel_hi:[1,0,1]
    v_pk_fma_f32 v[182:183], v[182:183], v[76:77], v[48:49] op_sel:[0,1,0] op_sel_hi:[1,1,1]
    v_pk_add_f32 v[64:65], v[64:65], 1.0 op_sel_hi:[1,0]
    v_pk_add_f32 v[66:67], v[66:67], 1.0 op_sel_hi:[1,0]
    v_pk_add_f32 v[68:69], v[68:69], 1.0 op_sel_hi:[1,0]
    v_pk_add_f32 v[70:71], v[70:71], 1.0 op_sel_hi:[1,0]
    v_rcp_f32 v64, v64
    v_pk_fma_f32 v[184:185], v[184:185], v[76:77], v[50:51] op_sel:[0,1,0] op_sel_hi:[1,1,1]
    v_rcp_f32 v65, v65
    v_pk_fma_f32 v[198:199], v[198:199], v[76:77], v[52:53] op_sel:[0,1,0] op_sel_hi:[1,1,1]
    v_pk_fma_f32 v[200:201], v[200:201], v[76:77], v[54:55] op_sel:[0,1,0] op_sel_hi:[1,1,1]
    v_rcp_f32 v66, v66
    v_pk_mul_f32 v[56:57], v[182:183], v[182:183]
    v_pk_mul_f32 v[58:59], v[184:185], v[184:185]
    v_rcp_f32 v67, v67
    v_pk_mul_f32 v[60:61], v[198:199], v[198:199]
    v_pk_mul_f32 v[62:63], v[200:201], v[200:201]
    v_rcp_f32 v68, v68
    v_pk_fma_f32 v[56:57], v[56:57], v[84:85], s[56:57]
    v_pk_fma_f32 v[58:59], v[58:59], v[84:85], s[56:57]
    v_rcp_f32 v69, v69
    v_pk_fma_f32 v[60:61], v[60:61], v[84:85], s[56:57]
    v_pk_fma_f32 v[62:63], v[62:63], v[84:85], s[56:57]
    v_rcp_f32 v70, v70
    v_pk_mul_f32 v[56:57], v[56:57], v[182:183]
    v_pk_mul_f32 v[58:59], v[58:59], v[184:185]
    v_rcp_f32 v71, v71
    v_pk_mul_f32 v[60:61], v[60:61], v[198:199]
    v_pk_mul_f32 v[62:63], v[62:63], v[200:201]
    v_exp_f32 v56, v56
    v_pk_mul_f32 v[162:163], v[162:163], v[64:65]
    v_exp_f32 v57, v57
    v_pk_mul_f32 v[164:165], v[164:165], v[66:67]
    v_pk_mul_f32 v[178:179], v[178:179], v[68:69]
    v_exp_f32 v58, v58
    v_pk_mul_f32 v[180:181], v[180:181], v[70:71]
    v_cvt_pk_bf16_f32 v226, v162, v163
    v_exp_f32 v59, v59
    v_cvt_pk_bf16_f32 v227, v164, v165
    v_cvt_pk_bf16_f32 v228, v178, v179
    v_exp_f32 v60, v60
    v_cvt_pk_bf16_f32 v229, v180, v181
    v_exp_f32 v61, v61
    v_pk_fma_f32 v[186:187], v[126:127], v[78:79], v[186:187] op_sel:[0,0,0] op_sel_hi:[1,0,1]
    v_pk_fma_f32 v[188:189], v[128:129], v[78:79], v[188:189] op_sel:[0,0,0] op_sel_hi:[1,0,1]
    v_exp_f32 v62, v62
    v_pk_fma_f32 v[202:203], v[130:131], v[78:79], v[202:203] op_sel:[0,0,0] op_sel_hi:[1,0,1]
    v_pk_fma_f32 v[204:205], v[132:133], v[78:79], v[204:205] op_sel:[0,0,0] op_sel_hi:[1,0,1]
    v_exp_f32 v63, v63
    v_pk_fma_f32 v[186:187], v[186:187], v[78:79], v[48:49] op_sel:[0,1,0] op_sel_hi:[1,1,1]
    v_pk_fma_f32 v[188:189], v[188:189], v[78:79], v[50:51] op_sel:[0,1,0] op_sel_hi:[1,1,1]
    v_pk_add_f32 v[56:57], v[56:57], 1.0 op_sel_hi:[1,0]
    v_pk_add_f32 v[58:59], v[58:59], 1.0 op_sel_hi:[1,0]
    v_pk_add_f32 v[60:61], v[60:61], 1.0 op_sel_hi:[1,0]
    v_pk_add_f32 v[62:63], v[62:63], 1.0 op_sel_hi:[1,0]
    v_rcp_f32 v56, v56
    v_pk_fma_f32 v[202:203], v[202:203], v[78:79], v[52:53] op_sel:[0,1,0] op_sel_hi:[1,1,1]
    v_rcp_f32 v57, v57
    v_pk_fma_f32 v[204:205], v[204:205], v[78:79], v[54:55] op_sel:[0,1,0] op_sel_hi:[1,1,1]
    v_pk_mul_f32 v[64:65], v[186:187], v[186:187]
    v_rcp_f32 v58, v58
    v_pk_mul_f32 v[66:67], v[188:189], v[188:189]
    v_pk_mul_f32 v[68:69], v[202:203], v[202:203]
    v_rcp_f32 v59, v59
    v_pk_mul_f32 v[70:71], v[204:205], v[204:205]
    v_pk_fma_f32 v[64:65], v[64:65], v[84:85], s[56:57]
    v_rcp_f32 v60, v60
    v_pk_fma_f32 v[66:67], v[66:67], v[84:85], s[56:57]
    v_rcp_f32 v61, v61
    v_pk_fma_f32 v[68:69], v[68:69], v[84:85], s[56:57]
    v_pk_fma_f32 v[70:71], v[70:71], v[84:85], s[56:57]
    v_rcp_f32 v62, v62
    v_pk_mul_f32 v[64:65], v[64:65], v[186:187]
    v_pk_mul_f32 v[66:67], v[66:67], v[188:189]
    v_rcp_f32 v63, v63
    v_pk_mul_f32 v[68:69], v[68:69], v[202:203]
    v_pk_mul_f32 v[70:71], v[70:71], v[204:205]
    v_exp_f32 v64, v64
    v_pk_mul_f32 v[182:183], v[182:183], v[56:57]
    v_exp_f32 v65, v65
    v_pk_mul_f32 v[184:185], v[184:185], v[58:59]
    v_pk_mul_f32 v[198:199], v[198:199], v[60:61]
    v_exp_f32 v66, v66
    v_pk_mul_f32 v[200:201], v[200:201], v[62:63]
    v_cvt_pk_bf16_f32 v230, v182, v183
    v_exp_f32 v67, v67
    v_cvt_pk_bf16_f32 v231, v184, v185
    v_cvt_pk_bf16_f32 v232, v198, v199
    v_exp_f32 v68, v68
    v_cvt_pk_bf16_f32 v233, v200, v201
    v_exp_f32 v69, v69
    v_pk_fma_f32 v[190:191], v[126:127], v[80:81], v[190:191] op_sel:[0,0,0] op_sel_hi:[1,0,1]
    v_pk_fma_f32 v[192:193], v[128:129], v[80:81], v[192:193] op_sel:[0,0,0] op_sel_hi:[1,0,1]
    v_exp_f32 v70, v70
    v_pk_fma_f32 v[206:207], v[130:131], v[80:81], v[206:207] op_sel:[0,0,0] op_sel_hi:[1,0,1]
    v_pk_fma_f32 v[208:209], v[132:133], v[80:81], v[208:209] op_sel:[0,0,0] op_sel_hi:[1,0,1]
    v_exp_f32 v71, v71
    v_pk_fma_f32 v[190:191], v[190:191], v[80:81], v[48:49] op_sel:[0,1,0] op_sel_hi:[1,1,1]
    v_pk_fma_f32 v[192:193], v[192:193], v[80:81], v[50:51] op_sel:[0,1,0] op_sel_hi:[1,1,1]
    v_pk_add_f32 v[64:65], v[64:65], 1.0 op_sel_hi:[1,0]
    v_pk_add_f32 v[66:67], v[66:67], 1.0 op_sel_hi:[1,0]
    v_pk_add_f32 v[68:69], v[68:69], 1.0 op_sel_hi:[1,0]
    v_pk_add_f32 v[70:71], v[70:71], 1.0 op_sel_hi:[1,0]
    v_rcp_f32 v64, v64
    v_pk_fma_f32 v[206:207], v[206:207], v[80:81], v[52:53] op_sel:[0,1,0] op_sel_hi:[1,1,1]
    v_rcp_f32 v65, v65
    v_pk_fma_f32 v[208:209], v[208:209], v[80:81], v[54:55] op_sel:[0,1,0] op_sel_hi:[1,1,1]
    v_pk_mul_f32 v[56:57], v[190:191], v[190:191]
    v_rcp_f32 v66, v66
    v_pk_mul_f32 v[58:59], v[192:193], v[192:193]
    v_pk_mul_f32 v[60:61], v[206:207], v[206:207]
    v_rcp_f32 v67, v67
    v_pk_mul_f32 v[62:63], v[208:209], v[208:209]
    v_pk_fma_f32 v[56:57], v[56:57], v[84:85], s[56:57]
    v_rcp_f32 v68, v68
    v_pk_fma_f32 v[58:59], v[58:59], v[84:85], s[56:57]
    v_rcp_f32 v69, v69
    v_pk_fma_f32 v[60:61], v[60:61], v[84:85], s[56:57]
    v_pk_fma_f32 v[62:63], v[62:63], v[84:85], s[56:57]
    v_rcp_f32 v70, v70
    v_pk_mul_f32 v[56:57], v[56:57], v[190:191]
    v_pk_mul_f32 v[58:59], v[58:59], v[192:193]
    v_rcp_f32 v71, v71
    v_pk_mul_f32 v[60:61], v[60:61], v[206:207]
    v_pk_mul_f32 v[62:63], v[62:63], v[208:209]
    v_exp_f32 v56, v56
    v_pk_mul_f32 v[186:187], v[186:187], v[64:65]
    v_exp_f32 v57, v57
    v_pk_mul_f32 v[188:189], v[188:189], v[66:67]
    v_pk_mul_f32 v[202:203], v[202:203], v[68:69]
    v_exp_f32 v58, v58
    v_pk_mul_f32 v[204:205], v[204:205], v[70:71]
    v_cvt_pk_bf16_f32 v234, v186, v187
    v_exp_f32 v59, v59
    v_cvt_pk_bf16_f32 v235, v188, v189
    v_cvt_pk_bf16_f32 v236, v202, v203
    v_exp_f32 v60, v60
    v_cvt_pk_bf16_f32 v237, v204, v205
    v_exp_f32 v61, v61
    v_pk_fma_f32 v[194:195], v[126:127], v[82:83], v[194:195] op_sel:[0,0,0] op_sel_hi:[1,0,1]
    v_pk_fma_f32 v[196:197], v[128:129], v[82:83], v[196:197] op_sel:[0,0,0] op_sel_hi:[1,0,1]
    v_exp_f32 v62, v62
    v_pk_fma_f32 v[210:211], v[130:131], v[82:83], v[210:211] op_sel:[0,0,0] op_sel_hi:[1,0,1]
    v_pk_fma_f32 v[212:213], v[132:133], v[82:83], v[212:213] op_sel:[0,0,0] op_sel_hi:[1,0,1]
    v_exp_f32 v63, v63
    v_pk_fma_f32 v[194:195], v[194:195], v[82:83], v[48:49] op_sel:[0,1,0] op_sel_hi:[1,1,1]
    v_pk_fma_f32 v[196:197], v[196:197], v[82:83], v[50:51] op_sel:[0,1,0] op_sel_hi:[1,1,1]
    v_pk_add_f32 v[56:57], v[56:57], 1.0 op_sel_hi:[1,0]
    v_pk_add_f32 v[58:59], v[58:59], 1.0 op_sel_hi:[1,0]
    v_pk_add_f32 v[60:61], v[60:61], 1.0 op_sel_hi:[1,0]
    v_pk_add_f32 v[62:63], v[62:63], 1.0 op_sel_hi:[1,0]
    v_rcp_f32 v56, v56
    v_pk_fma_f32 v[210:211], v[210:211], v[82:83], v[52:53] op_sel:[0,1,0] op_sel_hi:[1,1,1]
    v_rcp_f32 v57, v57
    v_pk_fma_f32 v[212:213], v[212:213], v[82:83], v[54:55] op_sel:[0,1,0] op_sel_hi:[1,1,1]
    v_pk_mul_f32 v[64:65], v[194:195], v[194:195]
    v_rcp_f32 v58, v58
    v_pk_mul_f32 v[66:67], v[196:197], v[196:197]
    v_pk_mul_f32 v[68:69], v[210:211], v[210:211]
    v_rcp_f32 v59, v59
    v_pk_mul_f32 v[70:71], v[212:213], v[212:213]
    v_pk_fma_f32 v[64:65], v[64:65], v[84:85], s[56:57]
    v_rcp_f32 v60, v60
    v_pk_fma_f32 v[66:67], v[66:67], v[84:85], s[56:57]
    v_rcp_f32 v61, v61
    v_pk_fma_f32 v[68:69], v[68:69], v[84:85], s[56:57]
    v_pk_fma_f32 v[70:71], v[70:71], v[84:85], s[56:57]
    v_rcp_f32 v62, v62
    v_pk_mul_f32 v[64:65], v[64:65], v[194:195]
    v_pk_mul_f32 v[66:67], v[66:67], v[196:197]
    v_rcp_f32 v63, v63
    v_pk_mul_f32 v[68:69], v[68:69], v[210:211]
    v_pk_mul_f32 v[70:71], v[70:71], v[212:213]
    v_exp_f32 v64, v64
    v_exp_f32 v65, v65
    v_pk_mul_f32 v[190:191], v[190:191], v[56:57]
    v_exp_f32 v66, v66
    v_exp_f32 v67, v67
    v_pk_mul_f32 v[192:193], v[192:193], v[58:59]
    v_exp_f32 v68, v68
    v_exp_f32 v69, v69
    v_pk_mul_f32 v[206:207], v[206:207], v[60:61]
    v_exp_f32 v70, v70
    v_exp_f32 v71, v71
    v_pk_mul_f32 v[208:209], v[208:209], v[62:63]
    v_pk_add_f32 v[64:65], v[64:65], 1.0 op_sel_hi:[1,0]
    v_pk_add_f32 v[66:67], v[66:67], 1.0 op_sel_hi:[1,0]
    v_pk_add_f32 v[68:69], v[68:69], 1.0 op_sel_hi:[1,0]
    v_pk_add_f32 v[70:71], v[70:71], 1.0 op_sel_hi:[1,0]
    v_rcp_f32 v64, v64
    v_rcp_f32 v65, v65
    v_cvt_pk_bf16_f32 v238, v190, v191
    v_rcp_f32 v66, v66
    v_rcp_f32 v67, v67
    v_cvt_pk_bf16_f32 v239, v192, v193
    v_rcp_f32 v68, v68
    v_rcp_f32 v69, v69
    v_cvt_pk_bf16_f32 v240, v206, v207
    v_rcp_f32 v70, v70
    v_rcp_f32 v71, v71
    v_cvt_pk_bf16_f32 v241, v208, v209
    v_pk_mul_f32 v[194:195], v[194:195], v[64:65]
    v_pk_mul_f32 v[196:197], v[196:197], v[66:67]
    v_pk_mul_f32 v[210:211], v[210:211], v[68:69]
    v_pk_mul_f32 v[212:213], v[212:213], v[70:71]
    v_cvt_pk_bf16_f32 v242, v194, v195
    v_cvt_pk_bf16_f32 v243, v196, v197
    v_cvt_pk_bf16_f32 v244, v210, v211
    v_cvt_pk_bf16_f32 v245, v212, v213
    s_barrier
    s_setprio 2
    s_branch P2_SETUP
M_LIGHT:
    s_load_dwordx4 s[32:35], s[0:1], 72
    s_lshl3_add_u32 s44, s2, s3
    s_cmp_lg_u32 s44, 8
    s_cbranch_scc1 P1_SIDE
    v_lshlrev_b32 v1, 4, v0
    s_waitcnt lgkmcnt(0)
    s_mov_b32 s20, s34
    s_and_b32 s21, s35, 0xffff
    s_mov_b32 s22, 0x2000000
    s_mov_b32 s23, 0x00020000
    s_mov_b32 s96, s32
    s_and_b32 s97, s33, 0xffff
    s_mov_b32 s98, 0x100
    s_mov_b32 s99, 0x00020000
    s_mov_b32 s44, 26214400
    buffer_load_dwordx4 v[8:11], v1, s[20:23], s44 offen offset:0 sc1
    buffer_load_dwordx4 v[12:15], v1, s[20:23], s44 offen offset:1024 sc1
    buffer_load_dwordx4 v[16:19], v1, s[20:23], s44 offen offset:2048 sc1
    buffer_load_dwordx4 v[20:23], v1, s[20:23], s44 offen offset:3072 sc1
    s_mov_b32 s44, 26218496
    buffer_load_dwordx4 v[24:27], v1, s[20:23], s44 offen offset:0 sc1
    buffer_load_dwordx4 v[28:31], v1, s[20:23], s44 offen offset:1024 sc1
    buffer_load_dwordx4 v[32:35], v1, s[20:23], s44 offen offset:2048 sc1
    buffer_load_dwordx4 v[36:39], v1, s[20:23], s44 offen offset:3072 sc1
    s_mov_b32 s44, 26222592
    buffer_load_dwordx4 v[40:43], v1, s[20:23], s44 offen offset:0 sc1
    buffer_load_dwordx4 v[44:47], v1, s[20:23], s44 offen offset:1024 sc1
    buffer_load_dwordx4 v[48:51], v1, s[20:23], s44 offen offset:2048 sc1
    buffer_load_dwordx4 v[52:55], v1, s[20:23], s44 offen offset:3072 sc1
    s_mov_b32 s44, 26226688
    buffer_load_dwordx4 v[56:59], v1, s[20:23], s44 offen offset:0 sc1
    buffer_load_dwordx4 v[60:63], v1, s[20:23], s44 offen offset:1024 sc1
    s_waitcnt vmcnt(0)
    v_readfirstlane_b32 s44, v8
M_TAG_NEXT:
    s_add_u32 s44, s44, 1
    s_max_u32 s44, s44, 1
    v_mov_b32 v2, -1
    v_xor_b32 v3, s44, v8
    v_xor_b32 v4, s44, v9
    v_min3_u32 v2, v2, v3, v4
    v_xor_b32 v3, s44, v10
    v_xor_b32 v4, s44, v11
    v_min3_u32 v2, v2, v3, v4
    v_xor_b32 v3, s44, v12
    v_xor_b32 v4, s44, v13
    v_min3_u32 v2, v2, v3, v4
    v_xor_b32 v3, s44, v14
    v_xor_b32 v4, s44, v15
    v_min3_u32 v2, v2, v3, v4
    v_xor_b32 v3, s44, v16
    v_xor_b32 v4, s44, v17
    v_min3_u32 v2, v2, v3, v4
    v_xor_b32 v3, s44, v18
    v_xor_b32 v4, s44, v19
    v_min3_u32 v2, v2, v3, v4
    v_xor_b32 v3, s44, v20
    v_xor_b32 v4, s44, v21
    v_min3_u32 v2, v2, v3, v4
    v_xor_b32 v3, s44, v22
    v_xor_b32 v4, s44, v23
    v_min3_u32 v2, v2, v3, v4
    v_xor_b32 v3, s44, v24
    v_xor_b32 v4, s44, v25
    v_min3_u32 v2, v2, v3, v4
    v_xor_b32 v3, s44, v26
    v_xor_b32 v4, s44, v27
    v_min3_u32 v2, v2, v3, v4
    v_xor_b32 v3, s44, v28
    v_xor_b32 v4, s44, v29
    v_min3_u32 v2, v2, v3, v4
    v_xor_b32 v3, s44, v30
    v_xor_b32 v4, s44, v31
    v_min3_u32 v2, v2, v3, v4
    v_xor_b32 v3, s44, v32
    v_xor_b32 v4, s44, v33
    v_min3_u32 v2, v2, v3, v4
    v_xor_b32 v3, s44, v34
    v_xor_b32 v4, s44, v35
    v_min3_u32 v2, v2, v3, v4
    v_xor_b32 v3, s44, v36
    v_xor_b32 v4, s44, v37
    v_min3_u32 v2, v2, v3, v4
    v_xor_b32 v3, s44, v38
    v_xor_b32 v4, s44, v39
    v_min3_u32 v2, v2, v3, v4
    v_xor_b32 v3, s44, v40
    v_xor_b32 v4, s44, v41
    v_min3_u32 v2, v2, v3, v4
    v_xor_b32 v3, s44, v42
    v_xor_b32 v4, s44, v43
    v_min3_u32 v2, v2, v3, v4
    v_xor_b32 v3, s44, v44
    v_xor_b32 v4, s44, v45
    v_min3_u32 v2, v2, v3, v4
    v_xor_b32 v3, s44, v46
    v_xor_b32 v4, s44, v47
    v_min3_u32 v2, v2, v3, v4
    v_xor_b32 v3, s44, v48
    v_xor_b32 v4, s44, v49
    v_min3_u32 v2, v2, v3, v4
    v_xor_b32 v3, s44, v50
    v_xor_b32 v4, s44, v51
    v_min3_u32 v2, v2, v3, v4
    v_xor_b32 v3, s44, v52
    v_xor_b32 v4, s44, v53
    v_min3_u32 v2, v2, v3, v4
    v_xor_b32 v3, s44, v54
    v_xor_b32 v4, s44, v55
    v_min3_u32 v2, v2, v3, v4
    v_xor_b32 v3, s44, v56
    v_xor_b32 v4, s44, v57
    v_min3_u32 v2, v2, v3, v4
    v_xor_b32 v3, s44, v58
    v_xor_b32 v4, s44, v59
    v_min3_u32 v2, v2, v3, v4
    v_xor_b32 v3, s44, v60
    v_xor_b32 v4, s44, v61
    v_min3_u32 v2, v2, v3, v4
    v_xor_b32 v3, s44, v62
    v_xor_b32 v4, s44, v63
    v_min3_u32 v2, v2, v3, v4
    v_cmp_eq_u32 vcc, 0, v2
    s_cbranch_vccnz M_TAG_NEXT
    v_mov_b32 v2, s44
    s_mov_b64 exec, 1
    buffer_store_dword v2, off, s[96:99], 0 sc1
    s_mov_b64 exec, -1
P1_SIDE:
    s_load_dwordx2 s[58:59], s[0:1], 48
    s_xor_b32 s43, s40, 15
    s_lshl_b32 s43, s43, 3
    s_add_u32 s43, s43, s3
    s_mul_i32 s50, s3, 20480
    v_lshlrev_b32 v1, 4, v0
    s_waitcnt lgkmcnt(0)
    s_mov_b32 s16, s8
    s_and_b32 s17, s9, 0xffff
    s_mov_b32 s18, 0x280000
    s_mov_b32 s19, 0x00020000
    s_mov_b32 s8, s58
    s_and_b32 s9, s59, 0xffff
    s_mov_b32 s10, 0x21c000
    s_mov_b32 s11, 0x00020000
    s_mov_b32 s20, s34
    s_and_b32 s21, s35, 0xffff
    s_mov_b32 s22, 0x2000000
    s_mov_b32 s23, 0x00020000
    s_mov_b32 s96, s32
    s_and_b32 s97, s33, 0xffff
    s_mov_b32 s98, 0x100
    s_mov_b32 s99, 0x00020000
P1_SIDE_GO:
    v_lshrrev_b32 v2, 3, v0
    v_mul_u32_u24 v2, 1280, v2
    v_and_b32 v3, 7, v0
    v_lshl_add_u32 v2, v3, 4, v2
    s_lshl_b32 s44, s40, 3
    s_add_u32 s44, s44, s3
    s_mul_i32 s45, s44, 20480
    s_add_u32 s47, s45, 10240
    buffer_load_dwordx4 v[8:11], v2, s[16:19], s45 offen offset:0
    buffer_load_dwordx4 v[12:15], v2, s[16:19], s45 offen offset:128
    buffer_load_dwordx4 v[16:19], v2, s[16:19], s45 offen offset:256
    buffer_load_dwordx4 v[20:23], v2, s[16:19], s45 offen offset:384
    buffer_load_dwordx4 v[24:27], v2, s[16:19], s45 offen offset:512
    buffer_load_dwordx4 v[28:31], v2, s[16:19], s45 offen offset:640
    buffer_load_dwordx4 v[32:35], v2, s[16:19], s45 offen offset:768
    buffer_load_dwordx4 v[36:39], v2, s[16:19], s45 offen offset:896
    buffer_load_dwordx4 v[40:43], v2, s[16:19], s45 offen offset:1024
    buffer_load_dwordx4 v[44:47], v2, s[16:19], s45 offen offset:1152
    buffer_load_dwordx4 v[48:51], v2, s[16:19], s47 offen offset:0
    buffer_load_dwordx4 v[52:55], v2, s[16:19], s47 offen offset:128
    buffer_load_dwordx4 v[56:59], v2, s[16:19], s47 offen offset:256
    buffer_load_dwordx4 v[60:63], v2, s[16:19], s47 offen offset:384
    buffer_load_dwordx4 v[64:67], v2, s[16:19], s47 offen offset:512
    buffer_load_dwordx4 v[68:71], v2, s[16:19], s47 offen offset:640
    buffer_load_dwordx4 v[72:75], v2, s[16:19], s47 offen offset:768
    buffer_load_dwordx4 v[76:79], v2, s[16:19], s47 offen offset:896
    buffer_load_dwordx4 v[80:83], v2, s[16:19], s47 offen offset:1024
    buffer_load_dwordx4 v[84:87], v2, s[16:19], s47 offen offset:1152
    s_lshl_b32 s46, s43, 2
    s_add_u32 s46, s46, 26226688
    buffer_load_dword v89, off, s[20:23], s46 sc1
    s_mov_b32 s47, 0x3f803f80
    v_mov_b32 v4, 0
    v_mov_b32 v5, 0
    v_mov_b32 v6, 0
    v_mov_b32 v7, 0
    s_waitcnt vmcnt(20)
    v_dot2c_f32_bf16 v4, s47, v8
    v_dot2c_f32_bf16 v6, v8, v8
    v_dot2c_f32_bf16 v4, s47, v9
    v_dot2c_f32_bf16 v6, v9, v9
    v_dot2c_f32_bf16 v4, s47, v10
    v_dot2c_f32_bf16 v6, v10, v10
    v_dot2c_f32_bf16 v4, s47, v11
    v_dot2c_f32_bf16 v6, v11, v11
    s_waitcnt vmcnt(19)
    v_dot2c_f32_bf16 v4, s47, v12
    v_dot2c_f32_bf16 v6, v12, v12
    v_dot2c_f32_bf16 v4, s47, v13
    v_dot2c_f32_bf16 v6, v13, v13
    v_dot2c_f32_bf16 v4, s47, v14
    v_dot2c_f32_bf16 v6, v14, v14
    v_dot2c_f32_bf16 v4, s47, v15
    v_dot2c_f32_bf16 v6, v15, v15
    s_waitcnt vmcnt(18)
    v_dot2c_f32_bf16 v4, s47, v16
    v_dot2c_f32_bf16 v6, v16, v16
    v_dot2c_f32_bf16 v4, s47, v17
    v_dot2c_f32_bf16 v6, v17, v17
    v_dot2c_f32_bf16 v4, s47, v18
    v_dot2c_f32_bf16 v6, v18, v18
    v_dot2c_f32_bf16 v4, s47, v19
    v_dot2c_f32_bf16 v6, v19, v19
    s_waitcnt vmcnt(17)
    v_dot2c_f32_bf16 v4, s47, v20
    v_dot2c_f32_bf16 v6, v20, v20
    v_dot2c_f32_bf16 v4, s47, v21
    v_dot2c_f32_bf16 v6, v21, v21
    v_dot2c_f32_bf16 v4, s47, v22
    v_dot2c_f32_bf16 v6, v22, v22
    v_dot2c_f32_bf16 v4, s47, v23
    v_dot2c_f32_bf16 v6, v23, v23
    s_waitcnt vmcnt(16)
    v_dot2c_f32_bf16 v4, s47, v24
    v_dot2c_f32_bf16 v6, v24, v24
    v_dot2c_f32_bf16 v4, s47, v25
    v_dot2c_f32_bf16 v6, v25, v25
    v_dot2c_f32_bf16 v4, s47, v26
    v_dot2c_f32_bf16 v6, v26, v26
    v_dot2c_f32_bf16 v4, s47, v27
    v_dot2c_f32_bf16 v6, v27, v27
    s_waitcnt vmcnt(15)
    v_dot2c_f32_bf16 v4, s47, v28
    v_dot2c_f32_bf16 v6, v28, v28
    v_dot2c_f32_bf16 v4, s47, v29
    v_dot2c_f32_bf16 v6, v29, v29
    v_dot2c_f32_bf16 v4, s47, v30
    v_dot2c_f32_bf16 v6, v30, v30
    v_dot2c_f32_bf16 v4, s47, v31
    v_dot2c_f32_bf16 v6, v31, v31
    s_waitcnt vmcnt(14)
    v_dot2c_f32_bf16 v4, s47, v32
    v_dot2c_f32_bf16 v6, v32, v32
    v_dot2c_f32_bf16 v4, s47, v33
    v_dot2c_f32_bf16 v6, v33, v33
    v_dot2c_f32_bf16 v4, s47, v34
    v_dot2c_f32_bf16 v6, v34, v34
    v_dot2c_f32_bf16 v4, s47, v35
    v_dot2c_f32_bf16 v6, v35, v35
    s_waitcnt vmcnt(13)
    v_dot2c_f32_bf16 v4, s47, v36
    v_dot2c_f32_bf16 v6, v36, v36
    v_dot2c_f32_bf16 v4, s47, v37
    v_dot2c_f32_bf16 v6, v37, v37
    v_dot2c_f32_bf16 v4, s47, v38
    v_dot2c_f32_bf16 v6, v38, v38
    v_dot2c_f32_bf16 v4, s47, v39
    v_dot2c_f32_bf16 v6, v39, v39
    s_waitcnt vmcnt(12)
    v_dot2c_f32_bf16 v4, s47, v40
    v_dot2c_f32_bf16 v6, v40, v40
    v_dot2c_f32_bf16 v4, s47, v41
    v_dot2c_f32_bf16 v6, v41, v41
    v_dot2c_f32_bf16 v4, s47, v42
    v_dot2c_f32_bf16 v6, v42, v42
    v_dot2c_f32_bf16 v4, s47, v43
    v_dot2c_f32_bf16 v6, v43, v43
    s_waitcnt vmcnt(11)
    v_dot2c_f32_bf16 v4, s47, v44
    v_dot2c_f32_bf16 v6, v44, v44
    v_dot2c_f32_bf16 v4, s47, v45
    v_dot2c_f32_bf16 v6, v45, v45
    v_dot2c_f32_bf16 v4, s47, v46
    v_dot2c_f32_bf16 v6, v46, v46
    v_dot2c_f32_bf16 v4, s47, v47
    v_dot2c_f32_bf16 v6, v47, v47
    s_waitcnt vmcnt(10)
    v_dot2c_f32_bf16 v5, s47, v48
    v_dot2c_f32_bf16 v7, v48, v48
    v_dot2c_f32_bf16 v5, s47, v49
    v_dot2c_f32_bf16 v7, v49, v49
    v_dot2c_f32_bf16 v5, s47, v50
    v_dot2c_f32_bf16 v7, v50, v50
    v_dot2c_f32_bf16 v5, s47, v51
    v_dot2c_f32_bf16 v7, v51, v51
    s_waitcnt vmcnt(9)
    v_dot2c_f32_bf16 v5, s47, v52
    v_dot2c_f32_bf16 v7, v52, v52
    v_dot2c_f32_bf16 v5, s47, v53
    v_dot2c_f32_bf16 v7, v53, v53
    v_dot2c_f32_bf16 v5, s47, v54
    v_dot2c_f32_bf16 v7, v54, v54
    v_dot2c_f32_bf16 v5, s47, v55
    v_dot2c_f32_bf16 v7, v55, v55
    s_waitcnt vmcnt(8)
    v_dot2c_f32_bf16 v5, s47, v56
    v_dot2c_f32_bf16 v7, v56, v56
    v_dot2c_f32_bf16 v5, s47, v57
    v_dot2c_f32_bf16 v7, v57, v57
    v_dot2c_f32_bf16 v5, s47, v58
    v_dot2c_f32_bf16 v7, v58, v58
    v_dot2c_f32_bf16 v5, s47, v59
    v_dot2c_f32_bf16 v7, v59, v59
    s_waitcnt vmcnt(7)
    v_dot2c_f32_bf16 v5, s47, v60
    v_dot2c_f32_bf16 v7, v60, v60
    v_dot2c_f32_bf16 v5, s47, v61
    v_dot2c_f32_bf16 v7, v61, v61
    v_dot2c_f32_bf16 v5, s47, v62
    v_dot2c_f32_bf16 v7, v62, v62
    v_dot2c_f32_bf16 v5, s47, v63
    v_dot2c_f32_bf16 v7, v63, v63
    s_waitcnt vmcnt(6)
    v_dot2c_f32_bf16 v5, s47, v64
    v_dot2c_f32_bf16 v7, v64, v64
    v_dot2c_f32_bf16 v5, s47, v65
    v_dot2c_f32_bf16 v7, v65, v65
    v_dot2c_f32_bf16 v5, s47, v66
    v_dot2c_f32_bf16 v7, v66, v66
    v_dot2c_f32_bf16 v5, s47, v67
    v_dot2c_f32_bf16 v7, v67, v67
    buffer_load_dword v88, off, s[96:99], 0 sc1
    s_waitcnt vmcnt(6)
    v_dot2c_f32_bf16 v5, s47, v68
    v_dot2c_f32_bf16 v7, v68, v68
    v_dot2c_f32_bf16 v5, s47, v69
    v_dot2c_f32_bf16 v7, v69, v69
    v_dot2c_f32_bf16 v5, s47, v70
    v_dot2c_f32_bf16 v7, v70, v70
    v_dot2c_f32_bf16 v5, s47, v71
    v_dot2c_f32_bf16 v7, v71, v71
    s_waitcnt vmcnt(5)
    v_dot2c_f32_bf16 v5, s47, v72
    v_dot2c_f32_bf16 v7, v72, v72
    v_dot2c_f32_bf16 v5, s47, v73
    v_dot2c_f32_bf16 v7, v73, v73
    v_dot2c_f32_bf16 v5, s47, v74
    v_dot2c_f32_bf16 v7, v74, v74
    v_dot2c_f32_bf16 v5, s47, v75
    v_dot2c_f32_bf16 v7, v75, v75
    s_waitcnt vmcnt(4)
    v_dot2c_f32_bf16 v5, s47, v76
    v_dot2c_f32_bf16 v7, v76, v76
    v_dot2c_f32_bf16 v5, s47, v77
    v_dot2c_f32_bf16 v7, v77, v77
    v_dot2c_f32_bf16 v5, s47, v78
    v_dot2c_f32_bf16 v7, v78, v78
    v_dot2c_f32_bf16 v5, s47, v79
    v_dot2c_f32_bf16 v7, v79, v79
    s_waitcnt vmcnt(3)
    v_dot2c_f32_bf16 v5, s47, v80
    v_dot2c_f32_bf16 v7, v80, v80
    v_dot2c_f32_bf16 v5, s47, v81
    v_dot2c_f32_bf16 v7, v81, v81
    v_dot2c_f32_bf16 v5, s47, v82
    v_dot2c_f32_bf16 v7, v82, v82
    v_dot2c_f32_bf16 v5, s47, v83
    v_dot2c_f32_bf16 v7, v83, v83
    s_waitcnt vmcnt(2)
    v_dot2c_f32_bf16 v5, s47, v84
    v_dot2c_f32_bf16 v7, v84, v84
    v_dot2c_f32_bf16 v5, s47, v85
    v_dot2c_f32_bf16 v7, v85, v85
    v_dot2c_f32_bf16 v5, s47, v86
    v_dot2c_f32_bf16 v7, v86, v86
    v_dot2c_f32_bf16 v5, s47, v87
    v_dot2c_f32_bf16 v7, v87, v87
    s_nop 3
    v_add_f32_dpp v4, v4, v4 quad_perm:[1,0,3,2] row_mask:0xf bank_mask:0xf
    v_add_f32_dpp v5, v5, v5 quad_perm:[1,0,3,2] row_mask:0xf bank_mask:0xf
    v_add_f32_dpp v6, v6, v6 quad_perm:[1,0,3,2] row_mask:0xf bank_mask:0xf
    v_add_f32_dpp v7, v7, v7 quad_perm:[1,0,3,2] row_mask:0xf bank_mask:0xf
    v_add_f32_dpp v4, v4, v4 quad_perm:[2,3,0,1] row_mask:0xf bank_mask:0xf
    v_add_f32_dpp v5, v5, v5 quad_perm:[2,3,0,1] row_mask:0xf bank_mask:0xf
    v_add_f32_dpp v6, v6, v6 quad_perm:[2,3,0,1] row_mask:0xf bank_mask:0xf
    v_add_f32_dpp v7, v7, v7 quad_perm:[2,3,0,1] row_mask:0xf bank_mask:0xf
    v_add_f32_dpp v4, v4, v4 row_half_mirror row_mask:0xf bank_mask:0xf
    v_add_f32_dpp v5, v5, v5 row_half_mirror row_mask:0xf bank_mask:0xf
    v_add_f32_dpp v6, v6, v6 row_half_mirror row_mask:0xf bank_mask:0xf
    v_add_f32_dpp v7, v7, v7 row_half_mirror row_mask:0xf bank_mask:0xf
    v_and_b32 v8, 1, v0
    v_cmp_eq_u32 vcc, 1, v8
    v_lshrrev_b32 v9, 3, v0
    v_lshl_add_u32 v9, v8, 3, v9
    v_cndmask_b32 v4, v4, v5, vcc
    v_cndmask_b32 v6, v6, v7, vcc
    v_mul_f32 v10, 0x3acccccd, v4
    v_mul_f32 v13, 0x3acccccd, v6
    v_fma_f32 v13, -v10, v10, v13
    v_max_f32 v12, 0, v13
    v_sub_f32 v10, 0, v10
    v_lshlrev_b32 v9, 4, v9
    s_lshl_b32 s45, s44, 8
    s_add_u32 s45, s45, 26230784
    s_waitcnt vmcnt(0)
    s_mov_b32 s63, 30000
    v_readfirstlane_b32 s48, v89
TAGL_7:
    v_readfirstlane_b32 s61, v88
    s_cmp_lg_u32 s61, s48
    s_cselect_b32 s49, s61, 0
    s_cmp_lg_u32 s49, 0
    s_cbranch_scc1 TAGD_8
    s_sleep 2
    buffer_load_dword v88, off, s[96:99], 0 sc1
    s_waitcnt vmcnt(0)
    s_sub_u32 s63, s63, 1
    s_cmp_lg_u32 s63, 0
    s_cbranch_scc1 TAGL_7
TAGD_8:
    v_mov_b32 v11, s61
    v_mov_b32 v13, s61
    s_mov_b32 exec_lo, 0x03030303
    s_mov_b32 exec_hi, 0x03030303
    buffer_store_dwordx4 v[10:13], v9, s[20:23], s45 offen sc1
    s_mov_b64 exec, -1
    s_barrier
    v_bfe_u32 v2, v0, 2, 2
    v_and_b32 v3, 3, v0
    v_lshrrev_b32 v4, 3, v0
    v_and_b32 v5, 7, v0
    v_lshlrev_b32 v30, 4, v5
    s_mul_i32 s42, s40, 7
    s_add_u32 s42, s42, s3
    s_cmp_eq_u32 s3, 7
    s_cbranch_scc1 P1_SIDE_WO
    s_cmp_ge_u32 s42, 108
    s_cbranch_scc1 P1_SIDE_WO
    v_and_b32 v6, 3, v4
    v_lshrrev_b32 v7, 2, v4
    v_lshl_add_u32 v6, v7, 4, v6
    v_mul_u32_u24 v6, 1280, v6
    v_add_u32 v6, v6, v30
    s_lshr_b32 s44, s42, 1
    s_and_b32 s46, s42, 1
    s_mul_i32 s47, s44, 40960
    s_mul_i32 s48, s46, 640
    s_add_u32 s47, s47, s48
    s_add_u32 m0, s50, 0
    s_add_u32 s45, s47, 0
    buffer_load_dwordx4 v6, s[8:11], s45 offen lds
    s_add_u32 m0, s50, 1024
    s_add_u32 s45, s47, 128
    buffer_load_dwordx4 v6, s[8:11], s45 offen lds
    s_add_u32 m0, s50, 2048
    s_add_u32 s45, s47, 256
    buffer_load_dwordx4 v6, s[8:11], s45 offen lds
    s_add_u32 m0, s50, 3072
    s_add_u32 s45, s47, 384
    buffer_load_dwordx4 v6, s[8:11], s45 offen lds
    s_add_u32 m0, s50, 4096
    s_add_u32 s45, s47, 512
    buffer_load_dwordx4 v6, s[8:11], s45 offen lds
    s_add_u32 m0, s50, 5120
    s_add_u32 s45, s47, 5120
    buffer_load_dwordx4 v6, s[8:11], s45 offen lds
    s_add_u32 m0, s50, 6144
    s_add_u32 s45, s47, 5248
    buffer_load_dwordx4 v6, s[8:11], s45 offen lds
    s_add_u32 m0, s50, 7168
    s_add_u32 s45, s47, 5376
    buffer_load_dwordx4 v6, s[8:11], s45 offen lds
    s_add_u32 m0, s50, 8192
    s_add_u32 s45, s47, 5504
    buffer_load_dwordx4 v6, s[8:11], s45 offen lds
    s_add_u32 m0, s50, 9216
    s_add_u32 s45, s47, 5632
    buffer_load_dwordx4 v6, s[8:11], s45 offen lds
    s_add_u32 m0, s50, 10240
    s_add_u32 s45, s47, 10240
    buffer_load_dwordx4 v6, s[8:11], s45 offen lds
    s_add_u32 m0, s50, 11264
    s_add_u32 s45, s47, 10368
    buffer_load_dwordx4 v6, s[8:11], s45 offen lds
    s_add_u32 m0, s50, 12288
    s_add_u32 s45, s47, 10496
    buffer_load_dwordx4 v6, s[8:11], s45 offen lds
    s_add_u32 m0, s50, 13312
    s_add_u32 s45, s47, 10624
    buffer_load_dwordx4 v6, s[8:11], s45 offen lds
    s_add_u32 m0, s50, 14336
    s_add_u32 s45, s47, 10752
    buffer_load_dwordx4 v6, s[8:11], s45 offen lds
    s_add_u32 m0, s50, 15360
    s_add_u32 s45, s47, 15360
    buffer_load_dwordx4 v6, s[8:11], s45 offen lds
    s_add_u32 m0, s50, 16384
    s_add_u32 s45, s47, 15488
    buffer_load_dwordx4 v6, s[8:11], s45 offen lds
    s_add_u32 m0, s50, 17408
    s_add_u32 s45, s47, 15616
    buffer_load_dwordx4 v6, s[8:11], s45 offen lds
    s_add_u32 m0, s50, 18432
    s_add_u32 s45, s47, 15744
    buffer_load_dwordx4 v6, s[8:11], s45 offen lds
    s_add_u32 m0, s50, 19456
    s_add_u32 s45, s47, 15872
    buffer_load_dwordx4 v6, s[8:11], s45 offen lds
    v_lshrrev_b32 v7, 4, v0
    v_mul_u32_u24 v7, 5120, v7
    v_lshl_add_u32 v7, v2, 7, v7
    v_lshl_add_u32 v7, v3, 3, v7
    v_add_u32 v7, s50, v7
    s_mul_i32 s47, s46, 216
    s_add_u32 s47, s47, s44
    s_mul_i32 s47, s47, 5120
    s_add_u32 s47, s47, 15728640
    s_waitcnt vmcnt(0)
    ds_read_b64_tr_b16 v[32:33], v7 offset:0
    ds_read_b64_tr_b16 v[34:35], v7 offset:512
    ds_read_b64_tr_b16 v[36:37], v7 offset:32
    ds_read_b64_tr_b16 v[38:39], v7 offset:544
    ds_read_b64_tr_b16 v[40:41], v7 offset:64
    ds_read_b64_tr_b16 v[42:43], v7 offset:576
    ds_read_b64_tr_b16 v[44:45], v7 offset:96
    ds_read_b64_tr_b16 v[46:47], v7 offset:608
    ds_read_b64_tr_b16 v[48:49], v7 offset:1024
    ds_read_b64_tr_b16 v[50:51], v7 offset:1536
    s_waitcnt lgkmcnt(0)
    s_add_u32 s45, s47, 0
    buffer_store_dwordx4 v[32:35], v1, s[20:23], s45 offen sc1
    s_add_u32 s45, s47, 1024
    buffer_store_dwordx4 v[36:39], v1, s[20:23], s45 offen sc1
    s_add_u32 s45, s47, 2048
    buffer_store_dwordx4 v[40:43], v1, s[20:23], s45 offen sc1
    s_add_u32 s45, s47, 3072
    buffer_store_dwordx4 v[44:47], v1, s[20:23], s45 offen sc1
    s_add_u32 s45, s47, 4096
    buffer_store_dwordx4 v[48:51], v1, s[20:23], s45 offen sc1
    ds_read_b64_tr_b16 v[52:53], v7 offset:1056
    ds_read_b64_tr_b16 v[54:55], v7 offset:1568
    ds_read_b64_tr_b16 v[56:57], v7 offset:1088
    ds_read_b64_tr_b16 v[58:59], v7 offset:1600
    ds_read_b64_tr_b16 v[60:61], v7 offset:1120
    ds_read_b64_tr_b16 v[62:63], v7 offset:1632
    ds_read_b64_tr_b16 v[64:65], v7 offset:2048
    ds_read_b64_tr_b16 v[66:67], v7 offset:2560
    ds_read_b64_tr_b16 v[68:69], v7 offset:2080
    ds_read_b64_tr_b16 v[70:71], v7 offset:2592
    s_waitcnt lgkmcnt(0)
    s_add_u32 s45, s47, 276480
    buffer_store_dwordx4 v[52:55], v1, s[20:23], s45 offen sc1
    s_add_u32 s45, s47, 277504
    buffer_store_dwordx4 v[56:59], v1, s[20:23], s45 offen sc1
    s_add_u32 s45, s47, 278528
    buffer_store_dwordx4 v[60:63], v1, s[20:23], s45 offen sc1
    s_add_u32 s45, s47, 279552
    buffer_store_dwordx4 v[64:67], v1, s[20:23], s45 offen sc1
    s_add_u32 s45, s47, 280576
    buffer_store_dwordx4 v[68:71], v1, s[20:23], s45 offen sc1
    ds_read_b64_tr_b16 v[72:73], v7 offset:2112
    ds_read_b64_tr_b16 v[74:75], v7 offset:2624
    ds_read_b64_tr_b16 v[76:77], v7 offset:2144
    ds_read_b64_tr_b16 v[78:79], v7 offset:2656
    ds_read_b64_tr_b16 v[80:81], v7 offset:3072
    ds_read_b64_tr_b16 v[82:83], v7 offset:3584
    ds_read_b64_tr_b16 v[84:85], v7 offset:3104
    ds_read_b64_tr_b16 v[86:87], v7 offset:3616
    ds_read_b64_tr_b16 v[88:89], v7 offset:3136
    ds_read_b64_tr_b16 v[90:91], v7 offset:3648
    s_waitcnt lgkmcnt(0)
    s_add_u32 s45, s47, 552960
    buffer_store_dwordx4 v[72:75], v1, s[20:23], s45 offen sc1
    s_add_u32 s45, s47, 553984
    buffer_store_dwordx4 v[76:79], v1, s[20:23], s45 offen sc1
    s_add_u32 s45, s47, 555008
    buffer_store_dwordx4 v[80:83], v1, s[20:23], s45 offen sc1
    s_add_u32 s45, s47, 556032
    buffer_store_dwordx4 v[84:87], v1, s[20:23], s45 offen sc1
    s_add_u32 s45, s47, 557056
    buffer_store_dwordx4 v[88:91], v1, s[20:23], s45 offen sc1
    ds_read_b64_tr_b16 v[92:93], v7 offset:3168
    ds_read_b64_tr_b16 v[94:95], v7 offset:3680
    ds_read_b64_tr_b16 v[96:97], v7 offset:4096
    ds_read_b64_tr_b16 v[98:99], v7 offset:4608
    ds_read_b64_tr_b16 v[100:101], v7 offset:4128
    ds_read_b64_tr_b16 v[102:103], v7 offset:4640
    ds_read_b64_tr_b16 v[104:105], v7 offset:4160
    ds_read_b64_tr_b16 v[106:107], v7 offset:4672
    ds_read_b64_tr_b16 v[108:109], v7 offset:4192
    ds_read_b64_tr_b16 v[110:111], v7 offset:4704
    s_waitcnt lgkmcnt(0)
    s_add_u32 s45, s47, 829440
    buffer_store_dwordx4 v[92:95], v1, s[20:23], s45 offen sc1
    s_add_u32 s45, s47, 830464
    buffer_store_dwordx4 v[96:99], v1, s[20:23], s45 offen sc1
    s_add_u32 s45, s47, 831488
    buffer_store_dwordx4 v[100:103], v1, s[20:23], s45 offen sc1
    s_add_u32 s45, s47, 832512
    buffer_store_dwordx4 v[104:107], v1, s[20:23], s45 offen sc1
    s_add_u32 s45, s47, 833536
    buffer_store_dwordx4 v[108:111], v1, s[20:23], s45 offen sc1
P1_SIDE_WO:
    s_lshl_b32 s46, s43, 2
    s_add_u32 s46, s46, 26226688
    s_barrier
    v_mov_b32 v1, 4064
    v_mov_b32 v2, 0
    ds_write_b32 v1, v2
    s_waitcnt lgkmcnt(0)
    s_barrier
P1_DONE:
    v_mov_b32 v1, s61
    s_waitcnt vmcnt(0)
    s_mov_b64 exec, 1
    buffer_store_dword v1, off, s[20:23], s46 sc1
    s_mov_b64 exec, -1
    v_mov_b32 v72, 0x2000000
    v_mov_b32 v73, 0x2000000
    v_mov_b32 v74, 0x2000000
    v_mov_b32 v75, 0x2000000
    v_mov_b32 v6, 0x3f803f80
    v_mov_b32 v172, v6
    v_mov_b32 v173, v6
    v_mov_b32 v174, v6
    v_mov_b32 v175, v6
    v_mov_b32 v176, v6
    v_mov_b32 v177, v6
    v_mov_b32 v178, v6
    v_mov_b32 v179, v6
    v_mov_b32 v180, v6
    v_mov_b32 v181, v6
    v_mov_b32 v182, v6
    v_mov_b32 v183, v6
    v_mov_b32 v120, 0
    v_mov_b32 v121, 0
    v_mov_b32 v122, 0
    v_mov_b32 v123, 0
    v_mov_b32 v184, 0
    v_mov_b32 v116, -1
    v_mov_b32 v185, 0
    v_mov_b32 v117, -1
    v_mov_b32 v186, 0
    v_mov_b32 v118, -1
    v_mov_b32 v187, 0
    v_mov_b32 v119, -1
    v_mfma_f32_32x32x16_bf16 v[124:139], v[120:123], v[120:123], 0
    v_mfma_f32_32x32x16_bf16 v[140:155], v[120:123], v[120:123], 0
    s_cmp_lt_u32 s3, 4
    s_cbranch_scc1 P2_SETUP
    s_barrier
    s_barrier
P2_SETUP:
    s_and_b32 s12, s2, 7
    s_lshr_b32 s13, s2, 3
    s_lshr_b32 s14, s13, 3
    s_and_b32 s15, s13, 7
    s_lshr_b32 s16, s12, 1
    s_and_b32 s12, s12, 1
    s_lshl_b32 s12, s12, 2
    s_add_u32 s12, s12, s16
    s_lshl_b32 s16, s12, 2
    s_add_u32 s16, s16, s14
    s_and_b32 s17, s12, 3
    s_lshl_b32 s17, s17, 3
    s_add_u32 s17, s17, s15
    s_lshr_b32 s18, s12, 2
    s_lshl_b32 s18, s18, 2
    s_add_u32 s18, s18, s14
    s_lshl_b32 s17, s12, 2
    s_add_u32 s17, s17, s14
    s_mov_b32 s18, s15
    s_and_b32 s19, s3, 3
    v_lshlrev_b32 v1, 4, v0
    v_and_b32 v2, 31, v0
    v_lshrrev_b32 v3, 5, v0
    s_mov_b32 s36, 0xffefffff
    s_mov_b32 s37, 0xffefffff
    v_mul_u32_u24 v4, 20, v3
    v_add_u32 v4, v4, v2
    v_lshlrev_b32 v4, 4, v4
    v_cmp_le_u32 vcc, 20, v2
    v_mov_b32 v5, 0x2000000
    s_nop 0
    v_cndmask_b32 v4, v4, v5, vcc
    s_lshl_b32 s4, s16, 16
    s_add_u32 s5, s4, 0x200000
    s_lshr_b32 s6, s16, 1
    s_lshl_b32 s6, s6, 15
    s_add_u32 s7, s6, 0x480000
    s_mul_i32 s8, s16, 81920
    s_add_u32 s8, s8, 0x500000
    s_lshl_b32 s30, s19, 10
    s_add_u32 s40, s5, s30
    s_add_u32 s40, s40, 2048
    s_add_u32 s41, s7, s30
    s_add_u32 s41, s41, 1024
    s_mul_i32 s31, s19, 1280
    s_add_u32 s42, s8, s31
    s_add_u32 s42, s42, 1280
    s_mov_b32 s43, s30
    s_lshr_b32 s44, s19, 1
    s_mul_i32 s44, s44, 14336
    s_and_b32 s31, s19, 1
    s_lshl_b32 s31, s31, 10
    s_add_u32 s44, s44, s31
    s_add_u32 s44, s44, 4096
    s_lshl_b32 s45, s19, 11
    s_add_u32 s45, s45, 6144
    s_lshl_b32 s50, s17, 2
    s_add_u32 s50, s50, s19
    s_mul_i32 s50, s50, 20480
    s_add_u32 s100, s50, 0x1300000
    s_mul_i32 s51, s18, 160
    s_add_u32 s50, s50, s51
    s_lshl_b32 s101, s17, 7
    s_add_u32 s101, s101, 26222592
    s_cmp_ge_u32 s3, 4
    s_cbranch_scc1 P2_GEMM
    s_lshl_b32 s27, s15, 2
    s_add_u32 s27, s27, s3
    s_lshl_b32 s27, s27, 1
    s_lshl_b32 s28, s27, 10
    s_add_u32 s28, s28, s4
    s_lshl_b32 s29, s27, 9
    s_add_u32 s29, s29, s6
    s_add_u32 s29, s29, 0x400000
    s_mul_i32 s38, s27, 40960
    s_add_u32 s38, s38, 0x1300000
    s_lshl_b32 s34, s16, 9
    s_add_u32 s34, s34, s38
    s_lshl_b32 s35, s16, 7
    s_add_u32 s35, s35, s38
    s_add_u32 s35, s35, 16384
    s_add_u32 s38, s34, 40960
    s_add_u32 s39, s35, 40960
    v_and_b32 v196, 15, v0
    v_bfe_u32 v188, v0, 4, 1
    v_mul_u32_u24 v188, 20480, v188
    v_lshl_add_u32 v197, v196, 4, v188
    v_lshl_add_u32 v197, v3, 8, v197
    v_lshrrev_b32 v246, 4, v0
    v_lshlrev_b32 v246, 8, v246
    v_lshl_add_u32 v246, v196, 3, v246
    v_lshl_add_u32 v196, v196, 3, v188
    s_waitcnt vmcnt(0)
    s_barrier
    s_and_b32 s30, s16, 1
    s_lshl_b32 s30, s30, 3
    v_add_u32 v18, s30, v1
    s_load_dwordx2 s[10:11], s[0:1], 0
    s_load_dwordx2 s[52:53], s[0:1], 64
    v_add_u32 v237, 61440, v1
    v_and_b32 v238, 15, v0
    v_mul_u32_u24 v236, 1280, v238
    v_bfe_u32 v238, v0, 4, 1
    v_lshl_add_u32 v245, v238, 5, v236
    v_lshl_add_u32 v245, v3, 4, v245
    v_lshrrev_b32 v238, 4, v0
    v_lshl_add_u32 v236, v238, 3, v236
    s_lshr_b32 s54, s12, 1
    s_add_u32 s54, s54, 1
    s_add_u32 s31, s54, 0
    s_and_b32 s31, s31, 3
    s_lshl_b32 s30, s31, 12
    s_add_u32 s96, s30, s100
    s_mul_i32 s30, s31, 20480
    v_add_u32 v240, s30, v237
    s_add_u32 s31, s54, 1
    s_and_b32 s31, s31, 3
    s_lshl_b32 s30, s31, 12
    s_add_u32 s97, s30, s100
    s_mul_i32 s30, s31, 20480
    v_add_u32 v241, s30, v237
    s_add_u32 s31, s54, 2
    s_and_b32 s31, s31, 3
    s_lshl_b32 s30, s31, 12
    s_add_u32 s98, s30, s100
    s_mul_i32 s30, s31, 20480
    v_add_u32 v242, s30, v237
    s_add_u32 s31, s54, 3
    s_and_b32 s31, s31, 3
    s_lshl_b32 s30, s31, 12
    s_add_u32 s99, s30, s100
    s_mul_i32 s30, s31, 20480
    v_add_u32 v243, s30, v237
    s_add_u32 s100, s100, 16384
    v_add_u32 v244, 81920, v237
    s_waitcnt lgkmcnt(0)
    s_mov_b32 s24, s10
    s_and_b32 s25, s11, 0xffff
    s_mov_b32 s26, 0x280000
    s_mov_b32 s27, 0x00020000
    s_mov_b32 s56, s52
    s_and_b32 s57, s53, 0xffff
    s_mov_b32 s58, 0x280000
    s_mov_b32 s59, 0x00020000
    s_mul_i32 s30, s3, 14336
    v_lshl_add_u32 v190, v0, 9, s30
    s_mov_b64 exec, 0xffff
    ds_write_b128 v190, v[180:183] offset:10560
    s_mov_b64 exec, -1
    s_lshr_b32 s30, s16, 1
    s_mul_i32 s30, s30, 40
    s_add_u32 s31, s30, 39
    s_lshr_b32 s30, s30, 6
    s_lshr_b32 s31, s31, 6
    s_sub_u32 s31, s31, s30
    v_lshrrev_b32 v188, 4, v0
    v_min_u32 v188, 2, v188
    v_mul_u32_u24 v188, 10, v188
    v_bfe_u32 v189, v0, 3, 1
    v_and_b32 v189, s31, v189
    v_add3_u32 v188, v188, v189, s30
    v_and_b32 v189, 7, v0
    v_lshlrev_b32 v189, 4, v189
    v_lshl_add_u32 v188, v188, 7, v189
    s_mov_b32 s30, 26214400
    v_mov_b32 v189, 4064
    s_cmp_lg_u32 s3, 0
    s_cbranch_scc1 P2_LWAIT
    s_mov_b32 s63, 30000
POLL_9:
    buffer_load_dwordx4 v[52:55], v188, s[20:23], s30 offen sc1
    s_waitcnt vmcnt(0)
    v_xor_b32 v52, s61, v52
    v_xor_b32 v53, s61, v53
    v_xor_b32 v54, s61, v54
    v_xor_b32 v55, s61, v55
    v_or3_b32 v52, v52, v53, v54
    v_or_b32 v52, v52, v55
    v_cmp_ne_u32 vcc, 0, v52
    s_cbranch_vccz POLLED_10
    s_sleep 4
    s_sub_u32 s63, s63, 1
    s_cmp_lg_u32 s63, 0
    s_cbranch_scc1 POLL_9
POLLED_10:
    v_mov_b32 v190, s61
    ds_write_b32 v189, v190
    s_branch P2_LDONE
P2_LWAIT:
    s_mov_b32 s63, 240000
P2_LW1:
    ds_read_b32 v190, v189
    s_waitcnt lgkmcnt(0)
    v_cmp_ne_u32 vcc, s61, v190
    s_cbranch_vccz P2_LDONE
    s_sleep 1
    s_sub_u32 s63, s63, 1
    s_cmp_lg_u32 s63, 0
    s_cbranch_scc1 P2_LW1
P2_LDONE:
    buffer_load_dwordx4 v[8:11], v1, s[20:23], s28 offen sc1
    buffer_load_dwordx4 v[12:15], v1, s[20:23], s28 offen offset:1024 sc1
    buffer_load_dwordx4 v[156:159], v1, s[20:23], s5 offen sc1
    buffer_load_dwordx2 v[170:171], v18, s[20:23], s7 offen sc1
    buffer_load_dwordx2 v[16:17], v18, s[20:23], s29 offen sc1
    buffer_load_dwordx4 v[160:163], v1, s[20:23], s5 offen offset:1024 sc1
    s_mov_b64 exec, s[36:37]
    buffer_load_dwordx4 v[172:175], v4, s[20:23], s8 offen sc1
    buffer_load_dwordx4 v[176:179], v4, s[20:23], s8 offen offset:640 sc1
    s_mov_b64 exec, -1
    s_add_u32 m0, s43, 4096
    s_add_u32 s30, s40, 0
    buffer_load_dwordx4 v1, s[20:23], s30 offen sc1 lds
    s_add_u32 m0, s43, 18432
    s_add_u32 s30, s40, 4096
    buffer_load_dwordx4 v1, s[20:23], s30 offen sc1 lds
    s_add_u32 m0, s44, 4096
    s_add_u32 s30, s41, 0
    buffer_load_dwordx4 v1, s[20:23], s30 offen sc1 lds
    s_mov_b64 exec, s[36:37]
    s_add_u32 m0, s45, 4096
    s_add_u32 s30, s42, 0
    buffer_load_dwordx4 v4, s[20:23], s30 offen sc1 lds
    s_add_u32 m0, s45, 5120
    s_add_u32 s30, s42, 640
    buffer_load_dwordx4 v4, s[20:23], s30 offen sc1 lds
    s_add_u32 m0, s45, 18432
    s_add_u32 s30, s42, 5120
    buffer_load_dwordx4 v4, s[20:23], s30 offen sc1 lds
    s_add_u32 m0, s45, 19456
    s_add_u32 s30, s42, 5760
    buffer_load_dwordx4 v4, s[20:23], s30 offen sc1 lds
    s_mov_b64 exec, -1
    s_waitcnt vmcnt(10)
    v_mfma_f32_32x32x4_2b_bf16 v[52:83], v[170:171], v[16:17], 0 cbsz:1 abid:0
    s_nop 15
    s_nop 1
    v_mfma_f32_32x32x16_bf16 v[52:67], v[156:159], v[8:11], v[52:67]
    v_mfma_f32_32x32x16_bf16 v[68:83], v[156:159], v[12:15], v[68:83]
    s_nop 11
    v_max3_f32 v188, v52, v53, v54
    v_max3_f32 v188, v188, v55, v56
    v_max3_f32 v188, v188, v57, v58
    v_max3_f32 v188, v188, v59, v60
    v_max3_f32 v188, v188, v61, v62
    v_max3_f32 v188, v188, v63, v64
    v_max3_f32 v188, v188, v65, v66
    v_max_f32 v188, v188, v67
    v_mov_b32 v189, v188
    v_max3_f32 v190, v68, v69, v70
    v_max3_f32 v190, v190, v71, v72
    v_max3_f32 v190, v190, v73, v74
    v_max3_f32 v190, v190, v75, v76
    v_max3_f32 v190, v190, v77, v78
    v_max3_f32 v190, v190, v79, v80
    v_max3_f32 v190, v190, v81, v82
    v_max_f32 v190, v190, v83
    v_mov_b32 v191, v190
    s_nop 0
    v_permlane32_swap_b32 v188, v189
    v_permlane32_swap_b32 v190, v191
    s_nop 0
    v_max_f32 v188, v188, v189
    v_sub_f32 v188, 0, v188
    v_max_f32 v190, v190, v191
    v_sub_f32 v190, 0, v190
    v_pk_mov_b32 v[20:21], v[188:189], v[188:189] op_sel:[0,0]
    v_pk_add_f32 v[52:53], v[52:53], v[188:189] op_sel_hi:[1,0]
    v_pk_mov_b32 v[22:23], v[188:189], v[188:189] op_sel:[0,0]
    v_pk_add_f32 v[54:55], v[54:55], v[188:189] op_sel_hi:[1,0]
    v_pk_mov_b32 v[24:25], v[188:189], v[188:189] op_sel:[0,0]
    v_pk_add_f32 v[56:57], v[56:57], v[188:189] op_sel_hi:[1,0]
    v_pk_mov_b32 v[26:27], v[188:189], v[188:189] op_sel:[0,0]
    v_pk_add_f32 v[58:59], v[58:59], v[188:189] op_sel_hi:[1,0]
    v_pk_mov_b32 v[28:29], v[188:189], v[188:189] op_sel:[0,0]
    v_pk_add_f32 v[60:61], v[60:61], v[188:189] op_sel_hi:[1,0]
    v_pk_mov_b32 v[30:31], v[188:189], v[188:189] op_sel:[0,0]
    v_pk_add_f32 v[62:63], v[62:63], v[188:189] op_sel_hi:[1,0]
    v_pk_mov_b32 v[32:33], v[188:189], v[188:189] op_sel:[0,0]
    v_pk_add_f32 v[64:65], v[64:65], v[188:189] op_sel_hi:[1,0]
    v_pk_mov_b32 v[34:35], v[188:189], v[188:189] op_sel:[0,0]
    v_pk_add_f32 v[66:67], v[66:67], v[188:189] op_sel_hi:[1,0]
    v_pk_mov_b32 v[36:37], v[190:191], v[190:191] op_sel:[0,0]
    v_pk_add_f32 v[68:69], v[68:69], v[190:191] op_sel_hi:[1,0]
    v_pk_mov_b32 v[38:39], v[190:191], v[190:191] op_sel:[0,0]
    v_pk_add_f32 v[70:71], v[70:71], v[190:191] op_sel_hi:[1,0]
    v_pk_mov_b32 v[40:41], v[190:191], v[190:191] op_sel:[0,0]
    v_pk_add_f32 v[72:73], v[72:73], v[190:191] op_sel_hi:[1,0]
    v_pk_mov_b32 v[42:43], v[190:191], v[190:191] op_sel:[0,0]
    v_pk_add_f32 v[74:75], v[74:75], v[190:191] op_sel_hi:[1,0]
    v_pk_mov_b32 v[44:45], v[190:191], v[190:191] op_sel:[0,0]
    v_pk_add_f32 v[76:77], v[76:77], v[190:191] op_sel_hi:[1,0]
    v_pk_mov_b32 v[46:47], v[190:191], v[190:191] op_sel:[0,0]
    v_pk_add_f32 v[78:79], v[78:79], v[190:191] op_sel_hi:[1,0]
    v_pk_mov_b32 v[48:49], v[190:191], v[190:191] op_sel:[0,0]
    v_pk_add_f32 v[80:81], v[80:81], v[190:191] op_sel_hi:[1,0]
    v_pk_mov_b32 v[50:51], v[190:191], v[190:191] op_sel:[0,0]
    v_pk_add_f32 v[82:83], v[82:83], v[190:191] op_sel_hi:[1,0]
    s_waitcnt vmcnt(0)
    buffer_store_dwordx4 v[116:119], v197, s[20:23], s34 offen sc1
    s_mov_b32 exec_hi, 0
    buffer_store_dwordx2 v[116:117], v196, s[20:23], s35 offen sc1
    s_mov_b32 exec_hi, -1
    buffer_store_dwordx4 v[116:119], v197, s[20:23], s38 offen sc1
    s_mov_b32 exec_hi, 0
    buffer_store_dwordx2 v[116:117], v196, s[20:23], s39 offen sc1
    s_mov_b32 exec_hi, -1
    buffer_load_dwordx2 v[226:227], v236, s[24:27], s50 offen offset:0
    buffer_load_dwordx2 v[228:229], v236, s[24:27], s50 offen offset:32
    buffer_load_dwordx2 v[230:231], v236, s[24:27], s50 offen offset:64
    buffer_load_dwordx2 v[232:233], v236, s[24:27], s50 offen offset:96
    buffer_load_dwordx2 v[234:235], v236, s[24:27], s50 offen offset:128
    s_mov_b32 s33, 4
    .p2align 6
P2_ATT_LOOP:
    v_exp_f32 v52, v52
    v_exp_f32 v53, v53
    v_mfma_f32_32x32x16_bf16 v[140:155], v[184:187], v[120:123], v[140:155]
    s_waitcnt lgkmcnt(0)
    s_barrier
    v_exp_f32 v54, v54
    v_exp_f32 v55, v55
    v_cvt_pk_bf16_f32 v116, v52, v53
    v_cvt_pk_bf16_f32 v117, v54, v55
    v_mfma_f32_32x32x4_2b_bf16 v[84:115], v[170:171], v[16:17], v[20:51] cbsz:1 abid:1
    v_exp_f32 v56, v56
    v_exp_f32 v57, v57
    v_exp_f32 v58, v58
    v_exp_f32 v59, v59
    v_cvt_pk_bf16_f32 v118, v56, v57
    v_cvt_pk_bf16_f32 v119, v58, v59
    v_exp_f32 v60, v60
    v_exp_f32 v61, v61
    v_exp_f32 v62, v62
    v_mfma_f32_32x32x16_bf16 v[124:139], v[172:175], v[116:119], v[124:139]
    ds_read_b128 v[180:183], v1 offset:10240
    v_exp_f32 v63, v63
    v_cvt_pk_bf16_f32 v120, v60, v61
    v_cvt_pk_bf16_f32 v121, v62, v63
    v_exp_f32 v64, v64
    v_exp_f32 v65, v65
    v_exp_f32 v66, v66
    v_exp_f32 v67, v67
    v_cvt_pk_bf16_f32 v122, v64, v65
    v_cvt_pk_bf16_f32 v123, v66, v67
    v_exp_f32 v68, v68
    v_exp_f32 v69, v69
    v_mfma_f32_32x32x16_bf16 v[124:139], v[176:179], v[120:123], v[124:139]
    ds_read_b128 v[184:187], v1 offset:11264
    v_exp_f32 v70, v70
    v_exp_f32 v71, v71
    v_cvt_pk_bf16_f32 v116, v68, v69
    v_cvt_pk_bf16_f32 v117, v70, v71
    v_mfma_f32_32x32x16_bf16 v[84:99], v[160:163], v[8:11], v[84:99]
    ds_read_b128 v[156:159], v1 offset:4096
    v_exp_f32 v72, v72
    v_exp_f32 v73, v73
    v_exp_f32 v74, v74
    v_mfma_f32_32x32x16_bf16 v[100:115], v[160:163], v[12:15], v[100:115]
    ds_read2st64_b64 v[164:167], v18 offset0:16 offset1:18
    v_exp_f32 v75, v75
    v_cvt_pk_bf16_f32 v118, v72, v73
    v_cvt_pk_bf16_f32 v119, v74, v75
    v_exp_f32 v76, v76
    v_exp_f32 v77, v77
    v_mfma_f32_32x32x16_bf16 v[140:155], v[172:175], v[116:119], v[140:155]
    v_exp_f32 v78, v78
    v_exp_f32 v79, v79
    v_cvt_pk_bf16_f32 v120, v76, v77
    v_cvt_pk_bf16_f32 v121, v78, v79
    v_exp_f32 v80, v80
    v_exp_f32 v81, v81
    v_exp_f32 v82, v82
    v_exp_f32 v83, v83
    v_cvt_pk_bf16_f32 v122, v80, v81
    v_cvt_pk_bf16_f32 v123, v82, v83
    v_exp_f32 v84, v84
    v_exp_f32 v85, v85
    v_mfma_f32_32x32x16_bf16 v[140:155], v[176:179], v[120:123], v[140:155]
    s_waitcnt lgkmcnt(0)
    v_exp_f32 v86, v86
    v_exp_f32 v87, v87
    v_cvt_pk_bf16_f32 v116, v84, v85
    v_cvt_pk_bf16_f32 v117, v86, v87
    v_mfma_f32_32x32x4_2b_bf16 v[52:83], v[164:165], v[16:17], v[20:51] cbsz:1 abid:0
    v_exp_f32 v88, v88
    v_exp_f32 v89, v89
    v_exp_f32 v90, v90
    v_exp_f32 v91, v91
    v_cvt_pk_bf16_f32 v118, v88, v89
    v_cvt_pk_bf16_f32 v119, v90, v91
    v_exp_f32 v92, v92
    v_exp_f32 v93, v93
    v_exp_f32 v94, v94
    v_mfma_f32_32x32x16_bf16 v[124:139], v[180:183], v[116:119], v[124:139]
    ds_read_b128 v[172:175], v1 offset:12288
    v_exp_f32 v95, v95
    v_cvt_pk_bf16_f32 v120, v92, v93
    v_cvt_pk_bf16_f32 v121, v94, v95
    v_exp_f32 v96, v96
    v_exp_f32 v97, v97
    v_exp_f32 v98, v98
    v_exp_f32 v99, v99
    v_cvt_pk_bf16_f32 v122, v96, v97
    v_cvt_pk_bf16_f32 v123, v98, v99
    v_exp_f32 v100, v100
    v_exp_f32 v101, v101
    v_mfma_f32_32x32x16_bf16 v[124:139], v[184:187], v[120:123], v[124:139]
    ds_read_b128 v[176:179], v1 offset:13312
    v_exp_f32 v102, v102
    v_exp_f32 v103, v103
    v_cvt_pk_bf16_f32 v116, v100, v101
    v_cvt_pk_bf16_f32 v117, v102, v103
    v_mfma_f32_32x32x16_bf16 v[52:67], v[156:159], v[8:11], v[52:67]
    ds_read_b128 v[160:163], v1 offset:5120
    v_exp_f32 v104, v104
    v_exp_f32 v105, v105
    v_exp_f32 v106, v106
    v_mfma_f32_32x32x16_bf16 v[68:83], v[156:159], v[12:15], v[68:83]
    v_exp_f32 v107, v107
    v_cvt_pk_bf16_f32 v118, v104, v105
    v_cvt_pk_bf16_f32 v119, v106, v107
    v_exp_f32 v108, v108
    v_exp_f32 v109, v109
    v_mfma_f32_32x32x16_bf16 v[140:155], v[180:183], v[116:119], v[140:155]
    v_exp_f32 v110, v110
    v_exp_f32 v111, v111
    v_cvt_pk_bf16_f32 v120, v108, v109
    v_cvt_pk_bf16_f32 v121, v110, v111
    v_exp_f32 v112, v112
    v_exp_f32 v113, v113
    v_exp_f32 v114, v114
    v_exp_f32 v115, v115
    v_cvt_pk_bf16_f32 v122, v112, v113
    v_cvt_pk_bf16_f32 v123, v114, v115
    v_exp_f32 v52, v52
    v_exp_f32 v53, v53
    v_mfma_f32_32x32x16_bf16 v[140:155], v[184:187], v[120:123], v[140:155]
    s_waitcnt lgkmcnt(0)
    v_exp_f32 v54, v54
    v_exp_f32 v55, v55
    v_cvt_pk_bf16_f32 v116, v52, v53
    v_cvt_pk_bf16_f32 v117, v54, v55
    v_mfma_f32_32x32x4_2b_bf16 v[84:115], v[164:165], v[16:17], v[20:51] cbsz:1 abid:1
    v_exp_f32 v56, v56
    v_exp_f32 v57, v57
    v_exp_f32 v58, v58
    v_exp_f32 v59, v59
    v_cvt_pk_bf16_f32 v118, v56, v57
    v_cvt_pk_bf16_f32 v119, v58, v59
    v_exp_f32 v60, v60
    v_exp_f32 v61, v61
    v_exp_f32 v62, v62
    v_mfma_f32_32x32x16_bf16 v[124:139], v[172:175], v[116:119], v[124:139]
    ds_read_b128 v[180:183], v1 offset:14336
    v_exp_f32 v63, v63
    v_cvt_pk_bf16_f32 v120, v60, v61
    v_cvt_pk_bf16_f32 v121, v62, v63
    v_exp_f32 v64, v64
    v_exp_f32 v65, v65
    v_exp_f32 v66, v66
    v_exp_f32 v67, v67
    v_cvt_pk_bf16_f32 v122, v64, v65
    v_cvt_pk_bf16_f32 v123, v66, v67
    v_exp_f32 v68, v68
    v_exp_f32 v69, v69
    v_mfma_f32_32x32x16_bf16 v[124:139], v[176:179], v[120:123], v[124:139]
    ds_read_b128 v[184:187], v1 offset:15360
    v_exp_f32 v70, v70
    v_exp_f32 v71, v71
    v_cvt_pk_bf16_f32 v116, v68, v69
    v_cvt_pk_bf16_f32 v117, v70, v71
    v_mfma_f32_32x32x16_bf16 v[84:99], v[160:163], v[8:11], v[84:99]
    ds_read_b128 v[156:159], v1 offset:6144
    v_exp_f32 v72, v72
    v_exp_f32 v73, v73
    v_exp_f32 v74, v74
    v_mfma_f32_32x32x16_bf16 v[100:115], v[160:163], v[12:15], v[100:115]
    v_exp_f32 v75, v75
    v_cvt_pk_bf16_f32 v118, v72, v73
    v_cvt_pk_bf16_f32 v119, v74, v75
    v_exp_f32 v76, v76
    v_exp_f32 v77, v77
    v_mfma_f32_32x32x16_bf16 v[140:155], v[172:175], v[116:119], v[140:155]
    v_exp_f32 v78, v78
    v_exp_f32 v79, v79
    v_cvt_pk_bf16_f32 v120, v76, v77
    v_cvt_pk_bf16_f32 v121, v78, v79
    v_exp_f32 v80, v80
    v_exp_f32 v81, v81
    v_exp_f32 v82, v82
    v_exp_f32 v83, v83
    v_cvt_pk_bf16_f32 v122, v80, v81
    v_cvt_pk_bf16_f32 v123, v82, v83
    v_exp_f32 v84, v84
    v_exp_f32 v85, v85
    v_mfma_f32_32x32x16_bf16 v[140:155], v[176:179], v[120:123], v[140:155]
    s_waitcnt lgkmcnt(0)
    v_exp_f32 v86, v86
    v_exp_f32 v87, v87
    v_cvt_pk_bf16_f32 v116, v84, v85
    v_cvt_pk_bf16_f32 v117, v86, v87
    v_mfma_f32_32x32x4_2b_bf16 v[52:83], v[166:167], v[16:17], v[20:51] cbsz:1 abid:0
    v_exp_f32 v88, v88
    v_exp_f32 v89, v89
    v_exp_f32 v90, v90
    v_exp_f32 v91, v91
    v_cvt_pk_bf16_f32 v118, v88, v89
    v_cvt_pk_bf16_f32 v119, v90, v91
    v_exp_f32 v92, v92
    v_exp_f32 v93, v93
    v_exp_f32 v94, v94
    v_mfma_f32_32x32x16_bf16 v[124:139], v[180:183], v[116:119], v[124:139]
    ds_read_b128 v[172:175], v1 offset:16384
    v_exp_f32 v95, v95
    v_cvt_pk_bf16_f32 v120, v92, v93
    v_cvt_pk_bf16_f32 v121, v94, v95
    v_exp_f32 v96, v96
    v_exp_f32 v97, v97
    v_exp_f32 v98, v98
    v_exp_f32 v99, v99
    v_cvt_pk_bf16_f32 v122, v96, v97
    v_cvt_pk_bf16_f32 v123, v98, v99
    v_exp_f32 v100, v100
    v_exp_f32 v101, v101
    v_mfma_f32_32x32x16_bf16 v[124:139], v[184:187], v[120:123], v[124:139]
    ds_read_b128 v[176:179], v1 offset:17408
    v_exp_f32 v102, v102
    v_exp_f32 v103, v103
    v_cvt_pk_bf16_f32 v116, v100, v101
    v_cvt_pk_bf16_f32 v117, v102, v103
    v_mfma_f32_32x32x16_bf16 v[52:67], v[156:159], v[8:11], v[52:67]
    ds_read_b128 v[160:163], v1 offset:7168
    v_exp_f32 v104, v104
    v_exp_f32 v105, v105
    v_exp_f32 v106, v106
    v_mfma_f32_32x32x16_bf16 v[68:83], v[156:159], v[12:15], v[68:83]
    v_exp_f32 v107, v107
    v_cvt_pk_bf16_f32 v118, v104, v105
    v_cvt_pk_bf16_f32 v119, v106, v107
    v_exp_f32 v108, v108
    v_exp_f32 v109, v109
    v_mfma_f32_32x32x16_bf16 v[140:155], v[180:183], v[116:119], v[140:155]
    v_exp_f32 v110, v110
    v_exp_f32 v111, v111
    v_cvt_pk_bf16_f32 v120, v108, v109
    v_cvt_pk_bf16_f32 v121, v110, v111
    v_exp_f32 v112, v112
    v_exp_f32 v113, v113
    v_exp_f32 v114, v114
    v_exp_f32 v115, v115
    v_cvt_pk_bf16_f32 v122, v112, v113
    v_cvt_pk_bf16_f32 v123, v114, v115
    v_exp_f32 v52, v52
    v_exp_f32 v53, v53
    v_mfma_f32_32x32x16_bf16 v[140:155], v[184:187], v[120:123], v[140:155]
    s_waitcnt lgkmcnt(0)
    v_exp_f32 v54, v54
    v_exp_f32 v55, v55
    v_cvt_pk_bf16_f32 v116, v52, v53
    v_cvt_pk_bf16_f32 v117, v54, v55
    v_mfma_f32_32x32x4_2b_bf16 v[84:115], v[166:167], v[16:17], v[20:51] cbsz:1 abid:1
    v_exp_f32 v56, v56
    v_exp_f32 v57, v57
    v_exp_f32 v58, v58
    v_exp_f32 v59, v59
    v_cvt_pk_bf16_f32 v118, v56, v57
    v_cvt_pk_bf16_f32 v119, v58, v59
    v_exp_f32 v60, v60
    v_exp_f32 v61, v61
    v_exp_f32 v62, v62
    v_mfma_f32_32x32x16_bf16 v[124:139], v[172:175], v[116:119], v[124:139]
    ds_read_b128 v[180:183], v1 offset:24576
    v_exp_f32 v63, v63
    v_cvt_pk_bf16_f32 v120, v60, v61
    v_cvt_pk_bf16_f32 v121, v62, v63
    v_exp_f32 v64, v64
    v_exp_f32 v65, v65
    v_exp_f32 v66, v66
    v_exp_f32 v67, v67
    v_cvt_pk_bf16_f32 v122, v64, v65
    v_cvt_pk_bf16_f32 v123, v66, v67
    v_exp_f32 v68, v68
    v_exp_f32 v69, v69
    v_mfma_f32_32x32x16_bf16 v[124:139], v[176:179], v[120:123], v[124:139]
    ds_read_b128 v[184:187], v1 offset:25600
    v_exp_f32 v70, v70
    v_exp_f32 v71, v71
    v_cvt_pk_bf16_f32 v116, v68, v69
    v_cvt_pk_bf16_f32 v117, v70, v71
    v_mfma_f32_32x32x16_bf16 v[84:99], v[160:163], v[8:11], v[84:99]
    ds_read_b128 v[156:159], v1 offset:18432
    v_exp_f32 v72, v72
    v_exp_f32 v73, v73
    v_exp_f32 v74, v74
    v_mfma_f32_32x32x16_bf16 v[100:115], v[160:163], v[12:15], v[100:115]
    ds_read2st64_b64 v[168:171], v18 offset0:44 offset1:46
    v_exp_f32 v75, v75
    v_cvt_pk_bf16_f32 v118, v72, v73
    v_cvt_pk_bf16_f32 v119, v74, v75
    v_exp_f32 v76, v76
    v_exp_f32 v77, v77
    v_mfma_f32_32x32x16_bf16 v[140:155], v[172:175], v[116:119], v[140:155]
    v_exp_f32 v78, v78
    v_exp_f32 v79, v79
    v_cvt_pk_bf16_f32 v120, v76, v77
    v_cvt_pk_bf16_f32 v121, v78, v79
    v_exp_f32 v80, v80
    v_exp_f32 v81, v81
    v_exp_f32 v82, v82
    v_exp_f32 v83, v83
    v_cvt_pk_bf16_f32 v122, v80, v81
    v_cvt_pk_bf16_f32 v123, v82, v83
    v_exp_f32 v84, v84
    v_exp_f32 v85, v85
    v_mfma_f32_32x32x16_bf16 v[140:155], v[176:179], v[120:123], v[140:155]
    s_waitcnt lgkmcnt(0)
    v_exp_f32 v86, v86
    v_exp_f32 v87, v87
    v_cvt_pk_bf16_f32 v116, v84, v85
    v_cvt_pk_bf16_f32 v117, v86, v87
    v_mfma_f32_32x32x4_2b_bf16 v[52:83], v[168:169], v[16:17], v[20:51] cbsz:1 abid:0
    v_exp_f32 v88, v88
    v_exp_f32 v89, v89
    v_exp_f32 v90, v90
    v_exp_f32 v91, v91
    v_cvt_pk_bf16_f32 v118, v88, v89
    v_cvt_pk_bf16_f32 v119, v90, v91
    v_exp_f32 v92, v92
    v_exp_f32 v93, v93
    v_exp_f32 v94, v94
    v_mfma_f32_32x32x16_bf16 v[124:139], v[180:183], v[116:119], v[124:139]
    ds_read_b128 v[172:175], v1 offset:26624
    v_exp_f32 v95, v95
    v_cvt_pk_bf16_f32 v120, v92, v93
    v_cvt_pk_bf16_f32 v121, v94, v95
    v_exp_f32 v96, v96
    v_exp_f32 v97, v97
    v_exp_f32 v98, v98
    v_exp_f32 v99, v99
    v_cvt_pk_bf16_f32 v122, v96, v97
    v_cvt_pk_bf16_f32 v123, v98, v99
    v_exp_f32 v100, v100
    v_exp_f32 v101, v101
    v_mfma_f32_32x32x16_bf16 v[124:139], v[184:187], v[120:123], v[124:139]
    ds_read_b128 v[176:179], v1 offset:27648
    v_exp_f32 v102, v102
    v_exp_f32 v103, v103
    v_cvt_pk_bf16_f32 v116, v100, v101
    v_cvt_pk_bf16_f32 v117, v102, v103
    v_mfma_f32_32x32x16_bf16 v[52:67], v[156:159], v[8:11], v[52:67]
    ds_read_b128 v[160:163], v1 offset:19456
    v_exp_f32 v104, v104
    v_exp_f32 v105, v105
    v_exp_f32 v106, v106
    v_mfma_f32_32x32x16_bf16 v[68:83], v[156:159], v[12:15], v[68:83]
    v_exp_f32 v107, v107
    v_cvt_pk_bf16_f32 v118, v104, v105
    v_cvt_pk_bf16_f32 v119, v106, v107
    v_exp_f32 v108, v108
    v_exp_f32 v109, v109
    v_mfma_f32_32x32x16_bf16 v[140:155], v[180:183], v[116:119], v[140:155]
    v_exp_f32 v110, v110
    v_exp_f32 v111, v111
    v_cvt_pk_bf16_f32 v120, v108, v109
    v_cvt_pk_bf16_f32 v121, v110, v111
    v_exp_f32 v112, v112
    v_exp_f32 v113, v113
    v_exp_f32 v114, v114
    v_exp_f32 v115, v115
    v_cvt_pk_bf16_f32 v122, v112, v113
    v_cvt_pk_bf16_f32 v123, v114, v115
    v_exp_f32 v52, v52
    v_exp_f32 v53, v53
    v_mfma_f32_32x32x16_bf16 v[140:155], v[184:187], v[120:123], v[140:155]
    s_waitcnt lgkmcnt(0)
    v_exp_f32 v54, v54
    v_exp_f32 v55, v55
    v_cvt_pk_bf16_f32 v116, v52, v53
    v_cvt_pk_bf16_f32 v117, v54, v55
    v_mfma_f32_32x32x4_2b_bf16 v[84:115], v[168:169], v[16:17], v[20:51] cbsz:1 abid:1
    v_exp_f32 v56, v56
    v_exp_f32 v57, v57
    v_exp_f32 v58, v58
    v_exp_f32 v59, v59
    v_cvt_pk_bf16_f32 v118, v56, v57
    v_cvt_pk_bf16_f32 v119, v58, v59
    v_exp_f32 v60, v60
    v_exp_f32 v61, v61
    v_exp_f32 v62, v62
    v_mfma_f32_32x32x16_bf16 v[124:139], v[172:175], v[116:119], v[124:139]
    ds_read_b128 v[180:183], v1 offset:28672
    v_exp_f32 v63, v63
    v_cvt_pk_bf16_f32 v120, v60, v61
    v_cvt_pk_bf16_f32 v121, v62, v63
    v_exp_f32 v64, v64
    v_exp_f32 v65, v65
    v_exp_f32 v66, v66
    v_exp_f32 v67, v67
    v_cvt_pk_bf16_f32 v122, v64, v65
    v_cvt_pk_bf16_f32 v123, v66, v67
    v_exp_f32 v68, v68
    v_exp_f32 v69, v69
    v_mfma_f32_32x32x16_bf16 v[124:139], v[176:179], v[120:123], v[124:139]
    ds_read_b128 v[184:187], v1 offset:29696
    v_exp_f32 v70, v70
    v_exp_f32 v71, v71
    v_cvt_pk_bf16_f32 v116, v68, v69
    v_cvt_pk_bf16_f32 v117, v70, v71
    v_mfma_f32_32x32x16_bf16 v[84:99], v[160:163], v[8:11], v[84:99]
    ds_read_b128 v[156:159], v1 offset:20480
    v_exp_f32 v72, v72
    v_exp_f32 v73, v73
    v_exp_f32 v74, v74
    v_mfma_f32_32x32x16_bf16 v[100:115], v[160:163], v[12:15], v[100:115]
    v_exp_f32 v75, v75
    v_cvt_pk_bf16_f32 v118, v72, v73
    v_cvt_pk_bf16_f32 v119, v74, v75
    v_exp_f32 v76, v76
    v_exp_f32 v77, v77
    v_mfma_f32_32x32x16_bf16 v[140:155], v[172:175], v[116:119], v[140:155]
    v_exp_f32 v78, v78
    v_exp_f32 v79, v79
    v_cvt_pk_bf16_f32 v120, v76, v77
    v_cvt_pk_bf16_f32 v121, v78, v79
    v_exp_f32 v80, v80
    v_exp_f32 v81, v81
    v_exp_f32 v82, v82
    v_exp_f32 v83, v83
    v_cvt_pk_bf16_f32 v122, v80, v81
    v_cvt_pk_bf16_f32 v123, v82, v83
    v_exp_f32 v84, v84
    v_exp_f32 v85, v85
    v_mfma_f32_32x32x16_bf16 v[140:155], v[176:179], v[120:123], v[140:155]
    s_waitcnt lgkmcnt(0)
    v_exp_f32 v86, v86
    v_exp_f32 v87, v87
    v_cvt_pk_bf16_f32 v116, v84, v85
    v_cvt_pk_bf16_f32 v117, v86, v87
    v_mfma_f32_32x32x4_2b_bf16 v[52:83], v[170:171], v[16:17], v[20:51] cbsz:1 abid:0
    v_exp_f32 v88, v88
    v_exp_f32 v89, v89
    v_exp_f32 v90, v90
    v_exp_f32 v91, v91
    v_cvt_pk_bf16_f32 v118, v88, v89
    v_cvt_pk_bf16_f32 v119, v90, v91
    v_exp_f32 v92, v92
    v_exp_f32 v93, v93
    v_exp_f32 v94, v94
    v_mfma_f32_32x32x16_bf16 v[124:139], v[180:183], v[116:119], v[124:139]
    ds_read_b128 v[172:175], v1 offset:30720
    v_exp_f32 v95, v95
    v_cvt_pk_bf16_f32 v120, v92, v93
    v_cvt_pk_bf16_f32 v121, v94, v95
    v_exp_f32 v96, v96
    v_exp_f32 v97, v97
    v_exp_f32 v98, v98
    v_exp_f32 v99, v99
    v_cvt_pk_bf16_f32 v122, v96, v97
    v_cvt_pk_bf16_f32 v123, v98, v99
    v_exp_f32 v100, v100
    v_exp_f32 v101, v101
    v_mfma_f32_32x32x16_bf16 v[124:139], v[184:187], v[120:123], v[124:139]
    ds_read_b128 v[176:179], v1 offset:31744
    v_exp_f32 v102, v102
    v_exp_f32 v103, v103
    v_cvt_pk_bf16_f32 v116, v100, v101
    v_cvt_pk_bf16_f32 v117, v102, v103
    v_mfma_f32_32x32x16_bf16 v[52:67], v[156:159], v[8:11], v[52:67]
    ds_read_b128 v[160:163], v1 offset:21504
    v_exp_f32 v104, v104
    v_exp_f32 v105, v105
    v_exp_f32 v106, v106
    v_mfma_f32_32x32x16_bf16 v[68:83], v[156:159], v[12:15], v[68:83]
    v_exp_f32 v107, v107
    v_cvt_pk_bf16_f32 v118, v104, v105
    v_cvt_pk_bf16_f32 v119, v106, v107
    v_exp_f32 v108, v108
    v_exp_f32 v109, v109
    v_mfma_f32_32x32x16_bf16 v[140:155], v[180:183], v[116:119], v[140:155]
    v_exp_f32 v110, v110
    v_exp_f32 v111, v111
    v_cvt_pk_bf16_f32 v120, v108, v109
    v_cvt_pk_bf16_f32 v121, v110, v111
    v_exp_f32 v112, v112
    v_exp_f32 v113, v113
    v_exp_f32 v114, v114
    v_exp_f32 v115, v115
    v_cvt_pk_bf16_f32 v122, v112, v113
    v_cvt_pk_bf16_f32 v123, v114, v115
    v_exp_f32 v52, v52
    v_exp_f32 v53, v53
    v_mfma_f32_32x32x16_bf16 v[140:155], v[184:187], v[120:123], v[140:155]
    s_waitcnt lgkmcnt(0)
    s_barrier
    v_exp_f32 v54, v54
    v_exp_f32 v55, v55
    v_cvt_pk_bf16_f32 v116, v52, v53
    v_cvt_pk_bf16_f32 v117, v54, v55
    v_mfma_f32_32x32x4_2b_bf16 v[84:115], v[170:171], v[16:17], v[20:51] cbsz:1 abid:1
    v_exp_f32 v56, v56
    v_exp_f32 v57, v57
    v_exp_f32 v58, v58
    v_exp_f32 v59, v59
    v_cvt_pk_bf16_f32 v118, v56, v57
    v_cvt_pk_bf16_f32 v119, v58, v59
    v_exp_f32 v60, v60
    v_exp_f32 v61, v61
    v_exp_f32 v62, v62
    v_mfma_f32_32x32x16_bf16 v[124:139], v[172:175], v[116:119], v[124:139]
    ds_read_b128 v[180:183], v1 offset:38912
    v_exp_f32 v63, v63
    v_cvt_pk_bf16_f32 v120, v60, v61
    v_cvt_pk_bf16_f32 v121, v62, v63
    v_exp_f32 v64, v64
    v_exp_f32 v65, v65
    v_exp_f32 v66, v66
    v_exp_f32 v67, v67
    v_cvt_pk_bf16_f32 v122, v64, v65
    v_cvt_pk_bf16_f32 v123, v66, v67
    v_exp_f32 v68, v68
    v_exp_f32 v69, v69
    v_mfma_f32_32x32x16_bf16 v[124:139], v[176:179], v[120:123], v[124:139]
    ds_read_b128 v[184:187], v1 offset:39936
    v_exp_f32 v70, v70
    v_exp_f32 v71, v71
    v_cvt_pk_bf16_f32 v116, v68, v69
    v_cvt_pk_bf16_f32 v117, v70, v71
    v_mfma_f32_32x32x16_bf16 v[84:99], v[160:163], v[8:11], v[84:99]
    ds_read_b128 v[156:159], v1 offset:32768
    v_exp_f32 v72, v72
    v_exp_f32 v73, v73
    v_exp_f32 v74, v74
    v_mfma_f32_32x32x16_bf16 v[100:115], v[160:163], v[12:15], v[100:115]
    ds_read2st64_b64 v[164:167], v18 offset0:72 offset1:74
    v_exp_f32 v75, v75
    v_cvt_pk_bf16_f32 v118, v72, v73
    v_cvt_pk_bf16_f32 v119, v74, v75
    v_exp_f32 v76, v76
    v_exp_f32 v77, v77
    v_mfma_f32_32x32x16_bf16 v[140:155], v[172:175], v[116:119], v[140:155]
    v_exp_f32 v78, v78
    v_exp_f32 v79, v79
    v_cvt_pk_bf16_f32 v120, v76, v77
    v_cvt_pk_bf16_f32 v121, v78, v79
    v_exp_f32 v80, v80
    v_exp_f32 v81, v81
    v_exp_f32 v82, v82
    v_exp_f32 v83, v83
    v_cvt_pk_bf16_f32 v122, v80, v81
    v_cvt_pk_bf16_f32 v123, v82, v83
    v_exp_f32 v84, v84
    v_exp_f32 v85, v85
    v_mfma_f32_32x32x16_bf16 v[140:155], v[176:179], v[120:123], v[140:155]
    s_waitcnt lgkmcnt(0)
    v_exp_f32 v86, v86
    v_exp_f32 v87, v87
    v_cvt_pk_bf16_f32 v116, v84, v85
    v_cvt_pk_bf16_f32 v117, v86, v87
    v_mfma_f32_32x32x4_2b_bf16 v[52:83], v[164:165], v[16:17], v[20:51] cbsz:1 abid:0
    v_exp_f32 v88, v88
    v_exp_f32 v89, v89
    v_exp_f32 v90, v90
    v_exp_f32 v91, v91
    v_cvt_pk_bf16_f32 v118, v88, v89
    v_cvt_pk_bf16_f32 v119, v90, v91
    v_exp_f32 v92, v92
    v_exp_f32 v93, v93
    v_exp_f32 v94, v94
    v_mfma_f32_32x32x16_bf16 v[124:139], v[180:183], v[116:119], v[124:139]
    ds_read_b128 v[172:175], v1 offset:40960
    v_exp_f32 v95, v95
    v_cvt_pk_bf16_f32 v120, v92, v93
    v_cvt_pk_bf16_f32 v121, v94, v95
    v_exp_f32 v96, v96
    v_exp_f32 v97, v97
    v_exp_f32 v98, v98
    v_exp_f32 v99, v99
    v_cvt_pk_bf16_f32 v122, v96, v97
    v_cvt_pk_bf16_f32 v123, v98, v99
    v_exp_f32 v100, v100
    v_exp_f32 v101, v101
    v_mfma_f32_32x32x16_bf16 v[124:139], v[184:187], v[120:123], v[124:139]
    ds_read_b128 v[176:179], v1 offset:41984
    v_exp_f32 v102, v102
    v_exp_f32 v103, v103
    v_cvt_pk_bf16_f32 v116, v100, v101
    v_cvt_pk_bf16_f32 v117, v102, v103
    v_mfma_f32_32x32x16_bf16 v[52:67], v[156:159], v[8:11], v[52:67]
    ds_read_b128 v[160:163], v1 offset:33792
    v_exp_f32 v104, v104
    v_exp_f32 v105, v105
    v_exp_f32 v106, v106
    v_mfma_f32_32x32x16_bf16 v[68:83], v[156:159], v[12:15], v[68:83]
    v_exp_f32 v107, v107
    v_cvt_pk_bf16_f32 v118, v104, v105
    v_cvt_pk_bf16_f32 v119, v106, v107
    v_exp_f32 v108, v108
    v_exp_f32 v109, v109
    v_mfma_f32_32x32x16_bf16 v[140:155], v[180:183], v[116:119], v[140:155]
    v_exp_f32 v110, v110
    v_exp_f32 v111, v111
    v_cvt_pk_bf16_f32 v120, v108, v109
    v_cvt_pk_bf16_f32 v121, v110, v111
    v_exp_f32 v112, v112
    v_exp_f32 v113, v113
    v_exp_f32 v114, v114
    v_exp_f32 v115, v115
    v_cvt_pk_bf16_f32 v122, v112, v113
    v_cvt_pk_bf16_f32 v123, v114, v115
    v_exp_f32 v52, v52
    v_exp_f32 v53, v53
    v_mfma_f32_32x32x16_bf16 v[140:155], v[184:187], v[120:123], v[140:155]
    s_waitcnt lgkmcnt(0)
    v_exp_f32 v54, v54
    v_exp_f32 v55, v55
    v_cvt_pk_bf16_f32 v116, v52, v53
    v_cvt_pk_bf16_f32 v117, v54, v55
    v_mfma_f32_32x32x4_2b_bf16 v[84:115], v[164:165], v[16:17], v[20:51] cbsz:1 abid:1
    v_exp_f32 v56, v56
    v_exp_f32 v57, v57
    v_exp_f32 v58, v58
    v_exp_f32 v59, v59
    v_cvt_pk_bf16_f32 v118, v56, v57
    v_cvt_pk_bf16_f32 v119, v58, v59
    v_exp_f32 v60, v60
    v_exp_f32 v61, v61
    v_exp_f32 v62, v62
    v_mfma_f32_32x32x16_bf16 v[124:139], v[172:175], v[116:119], v[124:139]
    ds_read_b128 v[180:183], v1 offset:43008
    v_exp_f32 v63, v63
    v_cvt_pk_bf16_f32 v120, v60, v61
    v_cvt_pk_bf16_f32 v121, v62, v63
    v_exp_f32 v64, v64
    v_exp_f32 v65, v65
    v_exp_f32 v66, v66
    v_exp_f32 v67, v67
    v_cvt_pk_bf16_f32 v122, v64, v65
    v_cvt_pk_bf16_f32 v123, v66, v67
    v_exp_f32 v68, v68
    v_exp_f32 v69, v69
    v_mfma_f32_32x32x16_bf16 v[124:139], v[176:179], v[120:123], v[124:139]
    ds_read_b128 v[184:187], v1 offset:44032
    v_exp_f32 v70, v70
    v_exp_f32 v71, v71
    v_cvt_pk_bf16_f32 v116, v68, v69
    v_cvt_pk_bf16_f32 v117, v70, v71
    v_mfma_f32_32x32x16_bf16 v[84:99], v[160:163], v[8:11], v[84:99]
    ds_read_b128 v[156:159], v1 offset:34816
    v_exp_f32 v72, v72
    v_exp_f32 v73, v73
    v_exp_f32 v74, v74
    v_mfma_f32_32x32x16_bf16 v[100:115], v[160:163], v[12:15], v[100:115]
    v_exp_f32 v75, v75
    v_cvt_pk_bf16_f32 v118, v72, v73
    v_cvt_pk_bf16_f32 v119, v74, v75
    v_exp_f32 v76, v76
    v_exp_f32 v77, v77
    v_mfma_f32_32x32x16_bf16 v[140:155], v[172:175], v[116:119], v[140:155]
    v_exp_f32 v78, v78
    v_exp_f32 v79, v79
    v_cvt_pk_bf16_f32 v120, v76, v77
    v_cvt_pk_bf16_f32 v121, v78, v79
    v_exp_f32 v80, v80
    v_exp_f32 v81, v81
    v_exp_f32 v82, v82
    v_exp_f32 v83, v83
    v_cvt_pk_bf16_f32 v122, v80, v81
    v_cvt_pk_bf16_f32 v123, v82, v83
    v_exp_f32 v84, v84
    v_exp_f32 v85, v85
    v_mfma_f32_32x32x16_bf16 v[140:155], v[176:179], v[120:123], v[140:155]
    s_waitcnt lgkmcnt(0)
    v_exp_f32 v86, v86
    v_exp_f32 v87, v87
    v_cvt_pk_bf16_f32 v116, v84, v85
    v_cvt_pk_bf16_f32 v117, v86, v87
    v_mfma_f32_32x32x4_2b_bf16 v[52:83], v[166:167], v[16:17], v[20:51] cbsz:1 abid:0
    v_exp_f32 v88, v88
    v_exp_f32 v89, v89
    v_exp_f32 v90, v90
    v_exp_f32 v91, v91
    v_cvt_pk_bf16_f32 v118, v88, v89
    v_cvt_pk_bf16_f32 v119, v90, v91
    v_exp_f32 v92, v92
    v_exp_f32 v93, v93
    v_exp_f32 v94, v94
    v_mfma_f32_32x32x16_bf16 v[124:139], v[180:183], v[116:119], v[124:139]
    ds_read_b128 v[172:175], v1 offset:45056
    v_exp_f32 v95, v95
    v_cvt_pk_bf16_f32 v120, v92, v93
    v_cvt_pk_bf16_f32 v121, v94, v95
    v_exp_f32 v96, v96
    v_exp_f32 v97, v97
    v_exp_f32 v98, v98
    v_exp_f32 v99, v99
    v_cvt_pk_bf16_f32 v122, v96, v97
    v_cvt_pk_bf16_f32 v123, v98, v99
    v_exp_f32 v100, v100
    v_exp_f32 v101, v101
    v_mfma_f32_32x32x16_bf16 v[124:139], v[184:187], v[120:123], v[124:139]
    ds_read_b128 v[176:179], v1 offset:46080
    v_exp_f32 v102, v102
    v_exp_f32 v103, v103
    v_cvt_pk_bf16_f32 v116, v100, v101
    v_cvt_pk_bf16_f32 v117, v102, v103
    v_mfma_f32_32x32x16_bf16 v[52:67], v[156:159], v[8:11], v[52:67]
    ds_read_b128 v[160:163], v1 offset:35840
    v_exp_f32 v104, v104
    v_exp_f32 v105, v105
    v_exp_f32 v106, v106
    v_mfma_f32_32x32x16_bf16 v[68:83], v[156:159], v[12:15], v[68:83]
    v_exp_f32 v107, v107
    v_cvt_pk_bf16_f32 v118, v104, v105
    v_cvt_pk_bf16_f32 v119, v106, v107
    v_exp_f32 v108, v108
    v_exp_f32 v109, v109
    v_mfma_f32_32x32x16_bf16 v[140:155], v[180:183], v[116:119], v[140:155]
    v_exp_f32 v110, v110
    v_exp_f32 v111, v111
    v_cvt_pk_bf16_f32 v120, v108, v109
    v_cvt_pk_bf16_f32 v121, v110, v111
    v_exp_f32 v112, v112
    v_exp_f32 v113, v113
    v_exp_f32 v114, v114
    v_exp_f32 v115, v115
    v_cvt_pk_bf16_f32 v122, v112, v113
    v_cvt_pk_bf16_f32 v123, v114, v115
    v_exp_f32 v52, v52
    v_exp_f32 v53, v53
    v_mfma_f32_32x32x16_bf16 v[140:155], v[184:187], v[120:123], v[140:155]
    s_waitcnt lgkmcnt(0)
    v_exp_f32 v54, v54
    v_exp_f32 v55, v55
    v_cvt_pk_bf16_f32 v116, v52, v53
    v_cvt_pk_bf16_f32 v117, v54, v55
    v_mfma_f32_32x32x4_2b_bf16 v[84:115], v[166:167], v[16:17], v[20:51] cbsz:1 abid:1
    v_exp_f32 v56, v56
    v_exp_f32 v57, v57
    v_exp_f32 v58, v58
    v_exp_f32 v59, v59
    v_cvt_pk_bf16_f32 v118, v56, v57
    v_cvt_pk_bf16_f32 v119, v58, v59
    v_exp_f32 v60, v60
    v_exp_f32 v61, v61
    v_exp_f32 v62, v62
    v_mfma_f32_32x32x16_bf16 v[124:139], v[172:175], v[116:119], v[124:139]
    ds_read_b128 v[180:183], v1 offset:53248
    v_exp_f32 v63, v63
    v_cvt_pk_bf16_f32 v120, v60, v61
    v_cvt_pk_bf16_f32 v121, v62, v63
    v_exp_f32 v64, v64
    v_exp_f32 v65, v65
    v_exp_f32 v66, v66
    v_exp_f32 v67, v67
    v_cvt_pk_bf16_f32 v122, v64, v65
    v_cvt_pk_bf16_f32 v123, v66, v67
    v_exp_f32 v68, v68
    v_exp_f32 v69, v69
    v_mfma_f32_32x32x16_bf16 v[124:139], v[176:179], v[120:123], v[124:139]
    ds_read_b128 v[184:187], v1 offset:54272
    v_exp_f32 v70, v70
    v_exp_f32 v71, v71
    v_cvt_pk_bf16_f32 v116, v68, v69
    v_cvt_pk_bf16_f32 v117, v70, v71
    v_mfma_f32_32x32x16_bf16 v[84:99], v[160:163], v[8:11], v[84:99]
    ds_read_b128 v[156:159], v1 offset:47104
    v_exp_f32 v72, v72
    v_exp_f32 v73, v73
    v_exp_f32 v74, v74
    v_mfma_f32_32x32x16_bf16 v[100:115], v[160:163], v[12:15], v[100:115]
    ds_read2st64_b64 v[168:171], v18 offset0:100 offset1:102
    v_exp_f32 v75, v75
    v_cvt_pk_bf16_f32 v118, v72, v73
    v_cvt_pk_bf16_f32 v119, v74, v75
    v_exp_f32 v76, v76
    v_exp_f32 v77, v77
    v_mfma_f32_32x32x16_bf16 v[140:155], v[172:175], v[116:119], v[140:155]
    v_exp_f32 v78, v78
    v_exp_f32 v79, v79
    v_cvt_pk_bf16_f32 v120, v76, v77
    v_cvt_pk_bf16_f32 v121, v78, v79
    v_exp_f32 v80, v80
    v_exp_f32 v81, v81
    v_exp_f32 v82, v82
    v_exp_f32 v83, v83
    v_cvt_pk_bf16_f32 v122, v80, v81
    v_cvt_pk_bf16_f32 v123, v82, v83
    v_exp_f32 v84, v84
    v_exp_f32 v85, v85
    v_mfma_f32_32x32x16_bf16 v[140:155], v[176:179], v[120:123], v[140:155]
    s_waitcnt lgkmcnt(0)
    v_exp_f32 v86, v86
    v_exp_f32 v87, v87
    v_cvt_pk_bf16_f32 v116, v84, v85
    v_cvt_pk_bf16_f32 v117, v86, v87
    v_mfma_f32_32x32x4_2b_bf16 v[52:83], v[168:169], v[16:17], v[20:51] cbsz:1 abid:0
    v_exp_f32 v88, v88
    v_exp_f32 v89, v89
    v_exp_f32 v90, v90
    v_exp_f32 v91, v91
    v_cvt_pk_bf16_f32 v118, v88, v89
    v_cvt_pk_bf16_f32 v119, v90, v91
    v_exp_f32 v92, v92
    v_exp_f32 v93, v93
    v_exp_f32 v94, v94
    v_mfma_f32_32x32x16_bf16 v[124:139], v[180:183], v[116:119], v[124:139]
    ds_read_b128 v[172:175], v1 offset:55296
    v_exp_f32 v95, v95
    v_cvt_pk_bf16_f32 v120, v92, v93
    v_cvt_pk_bf16_f32 v121, v94, v95
    v_exp_f32 v96, v96
    v_exp_f32 v97, v97
    v_exp_f32 v98, v98
    v_exp_f32 v99, v99
    v_cvt_pk_bf16_f32 v122, v96, v97
    v_cvt_pk_bf16_f32 v123, v98, v99
    v_exp_f32 v100, v100
    v_exp_f32 v101, v101
    v_mfma_f32_32x32x16_bf16 v[124:139], v[184:187], v[120:123], v[124:139]
    ds_read_b128 v[176:179], v1 offset:56320
    v_exp_f32 v102, v102
    v_exp_f32 v103, v103
    v_cvt_pk_bf16_f32 v116, v100, v101
    v_cvt_pk_bf16_f32 v117, v102, v103
    v_mfma_f32_32x32x16_bf16 v[52:67], v[156:159], v[8:11], v[52:67]
    ds_read_b128 v[160:163], v1 offset:48128
    v_exp_f32 v104, v104
    v_exp_f32 v105, v105
    v_exp_f32 v106, v106
    v_mfma_f32_32x32x16_bf16 v[68:83], v[156:159], v[12:15], v[68:83]
    v_exp_f32 v107, v107
    v_cvt_pk_bf16_f32 v118, v104, v105
    v_cvt_pk_bf16_f32 v119, v106, v107
    v_exp_f32 v108, v108
    v_exp_f32 v109, v109
    v_mfma_f32_32x32x16_bf16 v[140:155], v[180:183], v[116:119], v[140:155]
    v_exp_f32 v110, v110
    v_exp_f32 v111, v111
    v_cvt_pk_bf16_f32 v120, v108, v109
    v_cvt_pk_bf16_f32 v121, v110, v111
    v_exp_f32 v112, v112
    v_exp_f32 v113, v113
    v_exp_f32 v114, v114
    v_exp_f32 v115, v115
    v_cvt_pk_bf16_f32 v122, v112, v113
    v_cvt_pk_bf16_f32 v123, v114, v115
    v_exp_f32 v52, v52
    v_exp_f32 v53, v53
    v_mfma_f32_32x32x16_bf16 v[140:155], v[184:187], v[120:123], v[140:155]
    s_waitcnt lgkmcnt(0)
    v_exp_f32 v54, v54
    v_exp_f32 v55, v55
    v_cvt_pk_bf16_f32 v116, v52, v53
    v_cvt_pk_bf16_f32 v117, v54, v55
    v_mfma_f32_32x32x4_2b_bf16 v[84:115], v[168:169], v[16:17], v[20:51] cbsz:1 abid:1
    v_exp_f32 v56, v56
    v_exp_f32 v57, v57
    v_exp_f32 v58, v58
    v_exp_f32 v59, v59
    v_cvt_pk_bf16_f32 v118, v56, v57
    v_cvt_pk_bf16_f32 v119, v58, v59
    v_exp_f32 v60, v60
    v_exp_f32 v61, v61
    v_exp_f32 v62, v62
    v_mfma_f32_32x32x16_bf16 v[124:139], v[172:175], v[116:119], v[124:139]
    ds_read_b128 v[180:183], v1 offset:57344
    v_exp_f32 v63, v63
    v_cvt_pk_bf16_f32 v120, v60, v61
    v_cvt_pk_bf16_f32 v121, v62, v63
    v_exp_f32 v64, v64
    v_exp_f32 v65, v65
    v_exp_f32 v66, v66
    v_exp_f32 v67, v67
    v_cvt_pk_bf16_f32 v122, v64, v65
    v_cvt_pk_bf16_f32 v123, v66, v67
    v_exp_f32 v68, v68
    v_exp_f32 v69, v69
    v_mfma_f32_32x32x16_bf16 v[124:139], v[176:179], v[120:123], v[124:139]
    ds_read_b128 v[184:187], v1 offset:58368
    v_exp_f32 v70, v70
    v_exp_f32 v71, v71
    v_cvt_pk_bf16_f32 v116, v68, v69
    v_cvt_pk_bf16_f32 v117, v70, v71
    v_mfma_f32_32x32x16_bf16 v[84:99], v[160:163], v[8:11], v[84:99]
    ds_read_b128 v[156:159], v1 offset:49152
    v_exp_f32 v72, v72
    v_exp_f32 v73, v73
    v_exp_f32 v74, v74
    v_mfma_f32_32x32x16_bf16 v[100:115], v[160:163], v[12:15], v[100:115]
    s_waitcnt vmcnt(0)
    v_exp_f32 v75, v75
    v_cvt_pk_bf16_f32 v118, v72, v73
    v_cvt_pk_bf16_f32 v119, v74, v75
    v_exp_f32 v76, v76
    v_exp_f32 v77, v77
    v_mfma_f32_32x32x16_bf16 v[140:155], v[172:175], v[116:119], v[140:155]
    v_exp_f32 v78, v78
    v_exp_f32 v79, v79
    v_cvt_pk_bf16_f32 v120, v76, v77
    v_cvt_pk_bf16_f32 v121, v78, v79
    v_exp_f32 v80, v80
    v_exp_f32 v81, v81
    v_exp_f32 v82, v82
    v_exp_f32 v83, v83
    v_cvt_pk_bf16_f32 v122, v80, v81
    v_cvt_pk_bf16_f32 v123, v82, v83
    v_exp_f32 v84, v84
    v_exp_f32 v85, v85
    v_mfma_f32_32x32x16_bf16 v[140:155], v[176:179], v[120:123], v[140:155]
    s_waitcnt lgkmcnt(0)
    v_exp_f32 v86, v86
    v_exp_f32 v87, v87
    v_cvt_pk_bf16_f32 v116, v84, v85
    v_cvt_pk_bf16_f32 v117, v86, v87
    v_mfma_f32_32x32x4_2b_bf16 v[52:83], v[170:171], v[16:17], v[20:51] cbsz:1 abid:0
    v_exp_f32 v88, v88
    v_exp_f32 v89, v89
    v_exp_f32 v90, v90
    v_exp_f32 v91, v91
    v_cvt_pk_bf16_f32 v118, v88, v89
    v_cvt_pk_bf16_f32 v119, v90, v91
    v_exp_f32 v92, v92
    v_exp_f32 v93, v93
    v_exp_f32 v94, v94
    v_mfma_f32_32x32x16_bf16 v[124:139], v[180:183], v[116:119], v[124:139]
    ds_read_b128 v[172:175], v1 offset:59392
    v_exp_f32 v95, v95
    v_cvt_pk_bf16_f32 v120, v92, v93
    v_cvt_pk_bf16_f32 v121, v94, v95
    v_exp_f32 v96, v96
    v_exp_f32 v97, v97
    v_exp_f32 v98, v98
    v_exp_f32 v99, v99
    v_cvt_pk_bf16_f32 v122, v96, v97
    v_cvt_pk_bf16_f32 v123, v98, v99
    v_exp_f32 v100, v100
    v_exp_f32 v101, v101
    v_mfma_f32_32x32x16_bf16 v[124:139], v[184:187], v[120:123], v[124:139]
    ds_read_b128 v[176:179], v1 offset:60416
    v_exp_f32 v102, v102
    v_exp_f32 v103, v103
    v_cvt_pk_bf16_f32 v116, v100, v101
    v_cvt_pk_bf16_f32 v117, v102, v103
    v_mfma_f32_32x32x16_bf16 v[52:67], v[156:159], v[8:11], v[52:67]
    ds_read_b128 v[160:163], v1 offset:50176
    v_exp_f32 v104, v104
    v_exp_f32 v105, v105
    v_exp_f32 v106, v106
    v_mfma_f32_32x32x16_bf16 v[68:83], v[156:159], v[12:15], v[68:83]
    s_sub_u32 s33, s33, 1
    v_exp_f32 v107, v107
    v_cvt_pk_bf16_f32 v118, v104, v105
    v_cvt_pk_bf16_f32 v119, v106, v107
    v_exp_f32 v108, v108
    v_exp_f32 v109, v109
    v_mfma_f32_32x32x16_bf16 v[140:155], v[180:183], v[116:119], v[140:155]
    s_cmp_lg_u32 s33, 0
    v_exp_f32 v110, v110
    v_exp_f32 v111, v111
    v_cvt_pk_bf16_f32 v120, v108, v109
    v_cvt_pk_bf16_f32 v121, v110, v111
    v_exp_f32 v112, v112
    v_exp_f32 v113, v113
    v_exp_f32 v114, v114
    v_exp_f32 v115, v115
    v_cvt_pk_bf16_f32 v122, v112, v113
    v_cvt_pk_bf16_f32 v123, v114, v115
    s_cbranch_scc1 P2_ATT_LOOP
    s_nop 0
    v_mfma_f32_32x32x16_bf16 v[140:155], v[184:187], v[120:123], v[140:155]
    s_waitcnt lgkmcnt(0)
    s_nop 4
P2_ATT_STORE:
    s_mov_b32 s30, 0x53800000
    v_mov_b32 v137, v132
    v_mov_b32 v136, v132
    s_nop 1
    v_permlane32_swap_b32 v137, v136
    v_rcp_f32 v188, v136
    s_nop 0
    v_pk_mul_f32 v[124:125], v[124:125], v[188:189] op_sel:[0,0] op_sel_hi:[1,0]
    v_pk_mul_f32 v[126:127], v[126:127], v[188:189] op_sel:[0,0] op_sel_hi:[1,0]
    v_pk_mul_f32 v[128:129], v[128:129], v[188:189] op_sel:[0,0] op_sel_hi:[1,0]
    v_pk_mul_f32 v[130:131], v[130:131], v[188:189] op_sel:[0,0] op_sel_hi:[1,0]
    v_pk_mul_f32 v[132:133], v[132:133], v[188:189] op_sel:[0,0] op_sel_hi:[1,0]
    v_pk_mul_f32 v[134:135], v[134:135], v[188:189] op_sel:[0,0] op_sel_hi:[1,0]
    v_cvt_pk_bf16_f32 v52, v124, v125
    v_cvt_pk_bf16_f32 v53, v126, v127
    v_cvt_pk_bf16_f32 v54, v128, v129
    v_cvt_pk_bf16_f32 v55, v130, v131
    v_cvt_pk_bf16_f32 v56, v132, v133
    v_cvt_pk_bf16_f32 v57, v134, v135
    v_mov_b32 v153, v148
    v_mov_b32 v152, v148
    s_nop 1
    v_permlane32_swap_b32 v153, v152
    v_rcp_f32 v189, v152
    s_nop 0
    v_pk_mul_f32 v[140:141], v[140:141], v[188:189] op_sel:[0,1] op_sel_hi:[1,1]
    v_pk_mul_f32 v[142:143], v[142:143], v[188:189] op_sel:[0,1] op_sel_hi:[1,1]
    v_pk_mul_f32 v[144:145], v[144:145], v[188:189] op_sel:[0,1] op_sel_hi:[1,1]
    v_pk_mul_f32 v[146:147], v[146:147], v[188:189] op_sel:[0,1] op_sel_hi:[1,1]
    v_pk_mul_f32 v[148:149], v[148:149], v[188:189] op_sel:[0,1] op_sel_hi:[1,1]
    v_pk_mul_f32 v[150:151], v[150:151], v[188:189] op_sel:[0,1] op_sel_hi:[1,1]
    v_cvt_pk_bf16_f32 v68, v140, v141
    v_cvt_pk_bf16_f32 v69, v142, v143
    v_cvt_pk_bf16_f32 v70, v144, v145
    v_cvt_pk_bf16_f32 v71, v146, v147
    v_cvt_pk_bf16_f32 v72, v148, v149
    v_cvt_pk_bf16_f32 v73, v150, v151
    s_cmp_lg_u32 s33, 0
    s_cbranch_scc1 P2_ATT_PUB
    v_add_f32 v188, v136, v152
    v_mov_b32 v189, 0
    v_pk_fma_f32 v[188:189], v[124:125], 0, v[188:189] op_sel_hi:[1,0,1]
    v_pk_fma_f32 v[188:189], v[126:127], 0, v[188:189] op_sel_hi:[1,0,1]
    v_pk_fma_f32 v[188:189], v[128:129], 0, v[188:189] op_sel_hi:[1,0,1]
    v_pk_fma_f32 v[188:189], v[130:131], 0, v[188:189] op_sel_hi:[1,0,1]
    v_pk_fma_f32 v[188:189], v[132:133], 0, v[188:189] op_sel_hi:[1,0,1]
    v_pk_fma_f32 v[188:189], v[134:135], 0, v[188:189] op_sel_hi:[1,0,1]
    v_pk_fma_f32 v[188:189], v[140:141], 0, v[188:189] op_sel_hi:[1,0,1]
    v_pk_fma_f32 v[188:189], v[142:143], 0, v[188:189] op_sel_hi:[1,0,1]
    v_pk_fma_f32 v[188:189], v[144:145], 0, v[188:189] op_sel_hi:[1,0,1]
    v_pk_fma_f32 v[188:189], v[146:147], 0, v[188:189] op_sel_hi:[1,0,1]
    v_pk_fma_f32 v[188:189], v[148:149], 0, v[188:189] op_sel_hi:[1,0,1]
    v_pk_fma_f32 v[188:189], v[150:151], 0, v[188:189] op_sel_hi:[1,0,1]
    v_add_f32 v188, v188, v189
    v_cmp_nle_f32 vcc, v188, s30
    s_cbranch_vccnz P2_ATT_SLOW
P2_ATT_PUB:
    buffer_store_dwordx4 v[52:55], v197, s[20:23], s34 offen sc1
    buffer_store_dwordx4 v[68:71], v197, s[20:23], s38 offen sc1
    s_mov_b32 exec_hi, 0
    buffer_store_dwordx2 v[56:57], v196, s[20:23], s35 offen sc1
    buffer_store_dwordx2 v[72:73], v196, s[20:23], s39 offen sc1
    s_mov_b32 exec_hi, -1
    s_barrier
    buffer_load_dwordx4 v[6:9], v1, s[20:23], s96 offen offset:0 sc1
    buffer_load_dwordx4 v[10:13], v1, s[20:23], s96 offen offset:1024 sc1
    buffer_load_dwordx4 v[14:17], v1, s[20:23], s96 offen offset:2048 sc1
    buffer_load_dwordx4 v[18:21], v1, s[20:23], s96 offen offset:3072 sc1
    buffer_load_dwordx4 v[22:25], v1, s[20:23], s97 offen offset:0 sc1
    buffer_load_dwordx4 v[26:29], v1, s[20:23], s97 offen offset:1024 sc1
    buffer_load_dwordx4 v[30:33], v1, s[20:23], s97 offen offset:2048 sc1
    buffer_load_dwordx4 v[34:37], v1, s[20:23], s97 offen offset:3072 sc1
    buffer_load_dwordx4 v[38:41], v1, s[20:23], s98 offen offset:0 sc1
    buffer_load_dwordx4 v[42:45], v1, s[20:23], s98 offen offset:1024 sc1
    buffer_load_dwordx4 v[46:49], v1, s[20:23], s98 offen offset:2048 sc1
    buffer_load_dwordx4 v[50:53], v1, s[20:23], s98 offen offset:3072 sc1
    ds_read_b128 v[106:109], v240 offset:0
    ds_read_b128 v[110:113], v240 offset:1024
    ds_read_b128 v[114:117], v240 offset:2048
    ds_read_b128 v[118:121], v240 offset:3072
    ds_read_b128 v[122:125], v240 offset:4096
    ds_read_b128 v[126:129], v240 offset:5120
    ds_read_b128 v[130:133], v240 offset:6144
    ds_read_b128 v[134:137], v240 offset:7168
    ds_read_b128 v[138:141], v240 offset:8192
    ds_read_b128 v[142:145], v240 offset:9216
    ds_read_b128 v[146:149], v240 offset:10240
    ds_read_b128 v[150:153], v240 offset:11264
    ds_read_b128 v[154:157], v240 offset:12288
    ds_read_b128 v[158:161], v240 offset:13312
    ds_read_b128 v[162:165], v240 offset:14336
    ds_read_b128 v[166:169], v240 offset:15360
    ds_read_b128 v[170:173], v240 offset:16384
    ds_read_b128 v[174:177], v240 offset:17408
    ds_read_b128 v[178:181], v240 offset:18432
    ds_read_b128 v[182:185], v240 offset:19456
    v_mov_b32 v86, 0
    v_mov_b32 v87, 0
    v_mov_b32 v88, 0
    v_mov_b32 v89, 0
    v_mov_b32 v90, 0
    v_mov_b32 v91, 0
    v_mov_b32 v92, 0
    v_mov_b32 v93, 0
    v_mov_b32 v94, 0
    v_mov_b32 v95, 0
    v_mov_b32 v96, 0
    v_mov_b32 v97, 0
    v_mov_b32 v98, 0
    v_mov_b32 v99, 0
    v_mov_b32 v100, 0
    v_mov_b32 v101, 0
    v_mov_b32 v102, 0
    v_mov_b32 v103, 0
    v_mov_b32 v104, 0
    v_mov_b32 v105, 0
    v_lshlrev_b32 v206, 16, v226
    v_and_b32 v207, 0xffff0000, v226
    v_lshlrev_b32 v208, 16, v227
    v_and_b32 v209, 0xffff0000, v227
    v_lshlrev_b32 v210, 16, v228
    v_and_b32 v211, 0xffff0000, v228
    v_lshlrev_b32 v212, 16, v229
    v_and_b32 v213, 0xffff0000, v229
    v_lshlrev_b32 v214, 16, v230
    v_and_b32 v215, 0xffff0000, v230
    v_lshlrev_b32 v216, 16, v231
    v_and_b32 v217, 0xffff0000, v231
    v_lshlrev_b32 v218, 16, v232
    v_and_b32 v219, 0xffff0000, v232
    v_lshlrev_b32 v220, 16, v233
    v_and_b32 v221, 0xffff0000, v233
    v_lshlrev_b32 v222, 16, v234
    v_and_b32 v223, 0xffff0000, v234
    v_lshlrev_b32 v224, 16, v235
    v_and_b32 v225, 0xffff0000, v235
    s_mov_b32 s34, 31
    s_mov_b32 s63, 30000
    s_mov_b32 s35, -1
    s_mov_b32 s36, 0
    s_barrier
    buffer_load_dwordx4 v[54:57], v1, s[20:23], s99 offen offset:0 sc1
    buffer_load_dwordx4 v[58:61], v1, s[20:23], s99 offen offset:1024 sc1
    buffer_load_dwordx4 v[62:65], v1, s[20:23], s99 offen offset:2048 sc1
    buffer_load_dwordx4 v[66:69], v1, s[20:23], s99 offen offset:3072 sc1
    buffer_load_dwordx2 v[70:71], v246, s[20:23], s100 offen offset:0 sc1
    buffer_load_dwordx2 v[72:73], v246, s[20:23], s100 offen offset:128 sc1
    buffer_load_dwordx2 v[74:75], v246, s[20:23], s100 offen offset:1024 sc1
    buffer_load_dwordx2 v[76:77], v246, s[20:23], s100 offen offset:1152 sc1
    buffer_load_dwordx2 v[78:79], v246, s[20:23], s100 offen offset:2048 sc1
    buffer_load_dwordx2 v[80:81], v246, s[20:23], s100 offen offset:2176 sc1
    buffer_load_dwordx2 v[82:83], v246, s[20:23], s100 offen offset:3072 sc1
    buffer_load_dwordx2 v[84:85], v246, s[20:23], s100 offen offset:3200 sc1
P3_PASS:
    s_bitcmp1_b32 s34, 0
    s_cbranch_scc0 P3_S_11
    s_waitcnt vmcnt(20)
    v_max3_u32 v238, v6, v7, 1
    v_max3_u32 v239, v8, v9, 1
    v_max3_u32 v238, v238, v10, v11
    v_max3_u32 v239, v239, v12, v13
    v_max3_u32 v238, v238, v14, v15
    v_max3_u32 v239, v239, v16, v17
    v_max3_u32 v238, v238, v18, v19
    v_max3_u32 v239, v239, v20, v21
    v_max_u32 v238, v238, v239
    v_cmp_eq_u32 vcc, s35, v238
    s_cmp_eq_u32 s36, 0
    s_cbranch_vccnz P3_A_13
    s_cbranch_scc0 P3_N_14
P3_H_12:
    s_waitcnt lgkmcnt(8)
    v_mfma_f32_16x16x32_bf16 v[86:89], v[106:109], v[6:9], v[86:89]
    ds_read_b128 v[106:109], v241 offset:0
    v_mfma_f32_16x16x32_bf16 v[90:93], v[110:113], v[6:9], v[90:93]
    ds_read_b128 v[110:113], v241 offset:1024
    v_mfma_f32_16x16x32_bf16 v[94:97], v[114:117], v[6:9], v[94:97]
    ds_read_b128 v[114:117], v241 offset:2048
    v_mfma_f32_16x16x32_bf16 v[98:101], v[118:121], v[6:9], v[98:101]
    ds_read_b128 v[118:121], v241 offset:3072
    v_mfma_f32_16x16x32_bf16 v[102:105], v[122:125], v[6:9], v[102:105]
    ds_read_b128 v[122:125], v241 offset:4096
    v_mfma_f32_16x16x32_bf16 v[86:89], v[126:129], v[10:13], v[86:89]
    ds_read_b128 v[126:129], v241 offset:5120
    v_mfma_f32_16x16x32_bf16 v[90:93], v[130:133], v[10:13], v[90:93]
    ds_read_b128 v[130:133], v241 offset:6144
    v_mfma_f32_16x16x32_bf16 v[94:97], v[134:137], v[10:13], v[94:97]
    ds_read_b128 v[134:137], v241 offset:7168
    s_waitcnt lgkmcnt(8)
    v_mfma_f32_16x16x32_bf16 v[98:101], v[138:141], v[10:13], v[98:101]
    ds_read_b128 v[138:141], v241 offset:8192
    v_mfma_f32_16x16x32_bf16 v[102:105], v[142:145], v[10:13], v[102:105]
    ds_read_b128 v[142:145], v241 offset:9216
    v_mfma_f32_16x16x32_bf16 v[86:89], v[146:149], v[14:17], v[86:89]
    ds_read_b128 v[146:149], v241 offset:10240
    v_mfma_f32_16x16x32_bf16 v[90:93], v[150:153], v[14:17], v[90:93]
    ds_read_b128 v[150:153], v241 offset:11264
    v_mfma_f32_16x16x32_bf16 v[94:97], v[154:157], v[14:17], v[94:97]
    ds_read_b128 v[154:157], v241 offset:12288
    v_mfma_f32_16x16x32_bf16 v[98:101], v[158:161], v[14:17], v[98:101]
    ds_read_b128 v[158:161], v241 offset:13312
    v_mfma_f32_16x16x32_bf16 v[102:105], v[162:165], v[14:17], v[102:105]
    ds_read_b128 v[162:165], v241 offset:14336
    v_mfma_f32_16x16x32_bf16 v[86:89], v[166:169], v[18:21], v[86:89]
    ds_read_b128 v[166:169], v241 offset:15360
    v_mfma_f32_16x16x32_bf16 v[90:93], v[170:173], v[18:21], v[90:93]
    ds_read_b128 v[170:173], v241 offset:16384
    v_mfma_f32_16x16x32_bf16 v[94:97], v[174:177], v[18:21], v[94:97]
    ds_read_b128 v[174:177], v241 offset:17408
    v_mfma_f32_16x16x32_bf16 v[98:101], v[178:181], v[18:21], v[98:101]
    ds_read_b128 v[178:181], v241 offset:18432
    v_mfma_f32_16x16x32_bf16 v[102:105], v[182:185], v[18:21], v[102:105]
    ds_read_b128 v[182:185], v241 offset:19456
    s_bitset0_b32 s34, 0
    s_mov_b32 s36, 1
P3_S_11:
    s_bitcmp1_b32 s34, 1
    s_cbranch_scc0 P3_S_15
    s_waitcnt vmcnt(16)
    v_max3_u32 v238, v22, v23, 1
    v_max3_u32 v239, v24, v25, 1
    v_max3_u32 v238, v238, v26, v27
    v_max3_u32 v239, v239, v28, v29
    v_max3_u32 v238, v238, v30, v31
    v_max3_u32 v239, v239, v32, v33
    v_max3_u32 v238, v238, v34, v35
    v_max3_u32 v239, v239, v36, v37
    v_max_u32 v238, v238, v239
    v_cmp_eq_u32 vcc, s35, v238
    s_cmp_eq_u32 s36, 1
    s_cbranch_vccnz P3_A_17
    s_cbranch_scc0 P3_N_18
P3_H_16:
    s_waitcnt lgkmcnt(8)
    v_mfma_f32_16x16x32_bf16 v[86:89], v[106:109], v[22:25], v[86:89]
    ds_read_b128 v[106:109], v242 offset:0
    v_mfma_f32_16x16x32_bf16 v[90:93], v[110:113], v[22:25], v[90:93]
    ds_read_b128 v[110:113], v242 offset:1024
    v_mfma_f32_16x16x32_bf16 v[94:97], v[114:117], v[22:25], v[94:97]
    ds_read_b128 v[114:117], v242 offset:2048
    v_mfma_f32_16x16x32_bf16 v[98:101], v[118:121], v[22:25], v[98:101]
    ds_read_b128 v[118:121], v242 offset:3072
    v_mfma_f32_16x16x32_bf16 v[102:105], v[122:125], v[22:25], v[102:105]
    ds_read_b128 v[122:125], v242 offset:4096
    v_mfma_f32_16x16x32_bf16 v[86:89], v[126:129], v[26:29], v[86:89]
    ds_read_b128 v[126:129], v242 offset:5120
    v_mfma_f32_16x16x32_bf16 v[90:93], v[130:133], v[26:29], v[90:93]
    ds_read_b128 v[130:133], v242 offset:6144
    v_mfma_f32_16x16x32_bf16 v[94:97], v[134:137], v[26:29], v[94:97]
    ds_read_b128 v[134:137], v242 offset:7168
    s_waitcnt lgkmcnt(8)
    v_mfma_f32_16x16x32_bf16 v[98:101], v[138:141], v[26:29], v[98:101]
    ds_read_b128 v[138:141], v242 offset:8192
    v_mfma_f32_16x16x32_bf16 v[102:105], v[142:145], v[26:29], v[102:105]
    ds_read_b128 v[142:145], v242 offset:9216
    v_mfma_f32_16x16x32_bf16 v[86:89], v[146:149], v[30:33], v[86:89]
    ds_read_b128 v[146:149], v242 offset:10240
    v_mfma_f32_16x16x32_bf16 v[90:93], v[150:153], v[30:33], v[90:93]
    ds_read_b128 v[150:153], v242 offset:11264
    v_mfma_f32_16x16x32_bf16 v[94:97], v[154:157], v[30:33], v[94:97]
    ds_read_b128 v[154:157], v242 offset:12288
    v_mfma_f32_16x16x32_bf16 v[98:101], v[158:161], v[30:33], v[98:101]
    ds_read_b128 v[158:161], v242 offset:13312
    v_mfma_f32_16x16x32_bf16 v[102:105], v[162:165], v[30:33], v[102:105]
    ds_read_b128 v[162:165], v242 offset:14336
    v_mfma_f32_16x16x32_bf16 v[86:89], v[166:169], v[34:37], v[86:89]
    ds_read_b128 v[166:169], v242 offset:15360
    v_mfma_f32_16x16x32_bf16 v[90:93], v[170:173], v[34:37], v[90:93]
    ds_read_b128 v[170:173], v242 offset:16384
    v_mfma_f32_16x16x32_bf16 v[94:97], v[174:177], v[34:37], v[94:97]
    ds_read_b128 v[174:177], v242 offset:17408
    v_mfma_f32_16x16x32_bf16 v[98:101], v[178:181], v[34:37], v[98:101]
    ds_read_b128 v[178:181], v242 offset:18432
    v_mfma_f32_16x16x32_bf16 v[102:105], v[182:185], v[34:37], v[102:105]
    ds_read_b128 v[182:185], v242 offset:19456
    s_bitset0_b32 s34, 1
    s_mov_b32 s36, 2
P3_S_15:
    s_bitcmp1_b32 s34, 2
    s_cbranch_scc0 P3_S_19
    s_waitcnt vmcnt(12)
    v_max3_u32 v238, v38, v39, 1
    v_max3_u32 v239, v40, v41, 1
    v_max3_u32 v238, v238, v42, v43
    v_max3_u32 v239, v239, v44, v45
    v_max3_u32 v238, v238, v46, v47
    v_max3_u32 v239, v239, v48, v49
    v_max3_u32 v238, v238, v50, v51
    v_max3_u32 v239, v239, v52, v53
    v_max_u32 v238, v238, v239
    v_cmp_eq_u32 vcc, s35, v238
    s_cmp_eq_u32 s36, 2
    s_cbranch_vccnz P3_A_21
    s_cbranch_scc0 P3_N_22
P3_H_20:
    s_waitcnt lgkmcnt(8)
    v_mfma_f32_16x16x32_bf16 v[86:89], v[106:109], v[38:41], v[86:89]
    ds_read_b128 v[106:109], v243 offset:0
    v_mfma_f32_16x16x32_bf16 v[90:93], v[110:113], v[38:41], v[90:93]
    ds_read_b128 v[110:113], v243 offset:1024
    v_mfma_f32_16x16x32_bf16 v[94:97], v[114:117], v[38:41], v[94:97]
    ds_read_b128 v[114:117], v243 offset:2048
    v_mfma_f32_16x16x32_bf16 v[98:101], v[118:121], v[38:41], v[98:101]
    ds_read_b128 v[118:121], v243 offset:3072
    v_mfma_f32_16x16x32_bf16 v[102:105], v[122:125], v[38:41], v[102:105]
    ds_read_b128 v[122:125], v243 offset:4096
    v_mfma_f32_16x16x32_bf16 v[86:89], v[126:129], v[42:45], v[86:89]
    ds_read_b128 v[126:129], v243 offset:5120
    v_mfma_f32_16x16x32_bf16 v[90:93], v[130:133], v[42:45], v[90:93]
    ds_read_b128 v[130:133], v243 offset:6144
    v_mfma_f32_16x16x32_bf16 v[94:97], v[134:137], v[42:45], v[94:97]
    ds_read_b128 v[134:137], v243 offset:7168
    s_waitcnt lgkmcnt(8)
    v_mfma_f32_16x16x32_bf16 v[98:101], v[138:141], v[42:45], v[98:101]
    ds_read_b128 v[138:141], v243 offset:8192
    v_mfma_f32_16x16x32_bf16 v[102:105], v[142:145], v[42:45], v[102:105]
    ds_read_b128 v[142:145], v243 offset:9216
    v_mfma_f32_16x16x32_bf16 v[86:89], v[146:149], v[46:49], v[86:89]
    ds_read_b128 v[146:149], v243 offset:10240
    v_mfma_f32_16x16x32_bf16 v[90:93], v[150:153], v[46:49], v[90:93]
    ds_read_b128 v[150:153], v243 offset:11264
    v_mfma_f32_16x16x32_bf16 v[94:97], v[154:157], v[46:49], v[94:97]
    ds_read_b128 v[154:157], v243 offset:12288
    v_mfma_f32_16x16x32_bf16 v[98:101], v[158:161], v[46:49], v[98:101]
    ds_read_b128 v[158:161], v243 offset:13312
    v_mfma_f32_16x16x32_bf16 v[102:105], v[162:165], v[46:49], v[102:105]
    ds_read_b128 v[162:165], v243 offset:14336
    v_mfma_f32_16x16x32_bf16 v[86:89], v[166:169], v[50:53], v[86:89]
    ds_read_b128 v[166:169], v243 offset:15360
    v_mfma_f32_16x16x32_bf16 v[90:93], v[170:173], v[50:53], v[90:93]
    ds_read_b128 v[170:173], v243 offset:16384
    v_mfma_f32_16x16x32_bf16 v[94:97], v[174:177], v[50:53], v[94:97]
    ds_read_b128 v[174:177], v243 offset:17408
    v_mfma_f32_16x16x32_bf16 v[98:101], v[178:181], v[50:53], v[98:101]
    ds_read_b128 v[178:181], v243 offset:18432
    v_mfma_f32_16x16x32_bf16 v[102:105], v[182:185], v[50:53], v[102:105]
    ds_read_b128 v[182:185], v243 offset:19456
    s_bitset0_b32 s34, 2
    s_mov_b32 s36, 3
P3_S_19:
    s_bitcmp1_b32 s34, 3
    s_cbranch_scc0 P3_S_23
    s_waitcnt vmcnt(8)
    v_max3_u32 v238, v54, v55, 1
    v_max3_u32 v239, v56, v57, 1
    v_max3_u32 v238, v238, v58, v59
    v_max3_u32 v239, v239, v60, v61
    v_max3_u32 v238, v238, v62, v63
    v_max3_u32 v239, v239, v64, v65
    v_max3_u32 v238, v238, v66, v67
    v_max3_u32 v239, v239, v68, v69
    v_max_u32 v238, v238, v239
    v_cmp_eq_u32 vcc, s35, v238
    s_cmp_eq_u32 s36, 3
    s_cbranch_vccnz P3_A_25
    s_cbranch_scc0 P3_N_26
P3_H_24:
    s_waitcnt lgkmcnt(8)
    v_mfma_f32_16x16x32_bf16 v[86:89], v[106:109], v[54:57], v[86:89]
    ds_read_b128 v[106:109], v244 offset:0
    v_mfma_f32_16x16x32_bf16 v[90:93], v[110:113], v[54:57], v[90:93]
    ds_read_b128 v[110:113], v244 offset:1024
    v_mfma_f32_16x16x32_bf16 v[94:97], v[114:117], v[54:57], v[94:97]
    ds_read_b128 v[114:117], v244 offset:2048
    v_mfma_f32_16x16x32_bf16 v[98:101], v[118:121], v[54:57], v[98:101]
    ds_read_b128 v[118:121], v244 offset:3072
    v_mfma_f32_16x16x32_bf16 v[102:105], v[122:125], v[54:57], v[102:105]
    ds_read_b128 v[122:125], v244 offset:4096
    v_mfma_f32_16x16x32_bf16 v[86:89], v[126:129], v[58:61], v[86:89]
    ds_read_b128 v[126:129], v244 offset:5120
    v_mfma_f32_16x16x32_bf16 v[90:93], v[130:133], v[58:61], v[90:93]
    ds_read_b128 v[130:133], v244 offset:6144
    v_mfma_f32_16x16x32_bf16 v[94:97], v[134:137], v[58:61], v[94:97]
    ds_read_b128 v[134:137], v244 offset:7168
    s_waitcnt lgkmcnt(8)
    v_mfma_f32_16x16x32_bf16 v[98:101], v[138:141], v[58:61], v[98:101]
    ds_read_b128 v[138:141], v244 offset:8192
    v_mfma_f32_16x16x32_bf16 v[102:105], v[142:145], v[58:61], v[102:105]
    ds_read_b128 v[142:145], v244 offset:9216
    v_mfma_f32_16x16x32_bf16 v[86:89], v[146:149], v[62:65], v[86:89]
    ds_read_b128 v[146:149], v244 offset:10240
    v_mfma_f32_16x16x32_bf16 v[90:93], v[150:153], v[62:65], v[90:93]
    ds_read_b128 v[150:153], v244 offset:11264
    v_mfma_f32_16x16x32_bf16 v[94:97], v[154:157], v[62:65], v[94:97]
    ds_read_b128 v[154:157], v244 offset:12288
    v_mfma_f32_16x16x32_bf16 v[98:101], v[158:161], v[62:65], v[98:101]
    ds_read_b128 v[158:161], v244 offset:13312
    v_mfma_f32_16x16x32_bf16 v[102:105], v[162:165], v[62:65], v[102:105]
    ds_read_b128 v[162:165], v244 offset:14336
    v_mfma_f32_16x16x32_bf16 v[86:89], v[166:169], v[66:69], v[86:89]
    ds_read_b128 v[166:169], v244 offset:15360
    v_mfma_f32_16x16x32_bf16 v[90:93], v[170:173], v[66:69], v[90:93]
    ds_read_b128 v[170:173], v244 offset:16384
    v_mfma_f32_16x16x32_bf16 v[94:97], v[174:177], v[66:69], v[94:97]
    ds_read_b128 v[174:177], v244 offset:17408
    v_mfma_f32_16x16x32_bf16 v[98:101], v[178:181], v[66:69], v[98:101]
    ds_read_b128 v[178:181], v244 offset:18432
    v_mfma_f32_16x16x32_bf16 v[102:105], v[182:185], v[66:69], v[102:105]
    ds_read_b128 v[182:185], v244 offset:19456
    s_bitset0_b32 s34, 3
    s_mov_b32 s36, 4
P3_S_23:
    s_bitcmp1_b32 s34, 4
    s_cbranch_scc0 P3_S_27
    s_waitcnt vmcnt(0)
    v_max3_u32 v238, v70, v71, 1
    v_max3_u32 v239, v72, v73, 1
    v_max3_u32 v238, v238, v74, v75
    v_max3_u32 v239, v239, v76, v77
    v_max3_u32 v238, v238, v78, v79
    v_max3_u32 v239, v239, v80, v81
    v_max3_u32 v238, v238, v82, v83
    v_max3_u32 v239, v239, v84, v85
    v_max_u32 v238, v238, v239
    v_cmp_eq_u32 vcc, s35, v238
    s_cmp_eq_u32 s36, 4
    s_cbranch_vccnz P3_A_29
    s_cbranch_scc0 P3_N_30
P3_H_28:
    s_waitcnt lgkmcnt(8)
    v_mfma_f32_16x16x32_bf16 v[86:89], v[106:109], v[70:73], v[86:89]
    v_mfma_f32_16x16x32_bf16 v[90:93], v[110:113], v[70:73], v[90:93]
    v_mfma_f32_16x16x32_bf16 v[94:97], v[114:117], v[70:73], v[94:97]
    v_mfma_f32_16x16x32_bf16 v[98:101], v[118:121], v[70:73], v[98:101]
    v_mfma_f32_16x16x32_bf16 v[102:105], v[122:125], v[70:73], v[102:105]
    v_mfma_f32_16x16x32_bf16 v[86:89], v[126:129], v[74:77], v[86:89]
    v_mfma_f32_16x16x32_bf16 v[90:93], v[130:133], v[74:77], v[90:93]
    v_mfma_f32_16x16x32_bf16 v[94:97], v[134:137], v[74:77], v[94:97]
    s_waitcnt lgkmcnt(0)
    v_mfma_f32_16x16x32_bf16 v[98:101], v[138:141], v[74:77], v[98:101]
    v_mfma_f32_16x16x32_bf16 v[102:105], v[142:145], v[74:77], v[102:105]
    v_mfma_f32_16x16x32_bf16 v[86:89], v[146:149], v[78:81], v[86:89]
    v_mfma_f32_16x16x32_bf16 v[90:93], v[150:153], v[78:81], v[90:93]
    v_mfma_f32_16x16x32_bf16 v[94:97], v[154:157], v[78:81], v[94:97]
    v_mfma_f32_16x16x32_bf16 v[98:101], v[158:161], v[78:81], v[98:101]
    v_mfma_f32_16x16x32_bf16 v[102:105], v[162:165], v[78:81], v[102:105]
    v_mfma_f32_16x16x32_bf16 v[86:89], v[166:169], v[82:85], v[86:89]
    v_mfma_f32_16x16x32_bf16 v[90:93], v[170:173], v[82:85], v[90:93]
    v_mfma_f32_16x16x32_bf16 v[94:97], v[174:177], v[82:85], v[94:97]
    v_mfma_f32_16x16x32_bf16 v[98:101], v[178:181], v[82:85], v[98:101]
    v_mfma_f32_16x16x32_bf16 v[102:105], v[182:185], v[82:85], v[102:105]
    s_bitset0_b32 s34, 4
    s_mov_b32 s36, 5
P3_S_27:
    s_cmp_lg_u32 s34, 0
    s_cbranch_scc1 P3_MORE
P3_DONE:
    s_mul_i32 s30, s19, 15360
    v_add_u32 v237, s30, v1
    s_waitcnt lgkmcnt(0)
    s_barrier
    ds_read_b128 v[186:189], v237 offset:0
    ds_read_b128 v[190:193], v237 offset:1024
    ds_read_b128 v[194:197], v237 offset:2048
    ds_read_b128 v[198:201], v237 offset:3072
    ds_read_b128 v[202:205], v237 offset:4096
    s_nop 2
    s_waitcnt lgkmcnt(4)
    v_pk_fma_f32 v[86:87], v[86:87], v[186:187], v[206:207]
    v_pk_fma_f32 v[88:89], v[88:89], v[188:189], v[208:209]
    v_cvt_pk_bf16_f32 v226, v86, v87
    v_cvt_pk_bf16_f32 v227, v88, v89
    s_waitcnt lgkmcnt(3)
    v_pk_fma_f32 v[90:91], v[90:91], v[190:191], v[210:211]
    v_pk_fma_f32 v[92:93], v[92:93], v[192:193], v[212:213]
    v_cvt_pk_bf16_f32 v228, v90, v91
    v_cvt_pk_bf16_f32 v229, v92, v93
    s_nop 1
    v_permlane16_swap_b32 v226, v228
    v_permlane16_swap_b32 v227, v229
    buffer_store_dwordx4 v[226:229], v245, s[56:59], s50 offen offset:0
    s_waitcnt lgkmcnt(2)
    v_pk_fma_f32 v[94:95], v[94:95], v[194:195], v[214:215]
    v_pk_fma_f32 v[96:97], v[96:97], v[196:197], v[216:217]
    v_cvt_pk_bf16_f32 v230, v94, v95
    v_cvt_pk_bf16_f32 v231, v96, v97
    s_waitcnt lgkmcnt(1)
    v_pk_fma_f32 v[98:99], v[98:99], v[198:199], v[218:219]
    v_pk_fma_f32 v[100:101], v[100:101], v[200:201], v[220:221]
    v_cvt_pk_bf16_f32 v232, v98, v99
    v_cvt_pk_bf16_f32 v233, v100, v101
    s_nop 1
    v_permlane16_swap_b32 v230, v232
    v_permlane16_swap_b32 v231, v233
    buffer_store_dwordx4 v[230:233], v245, s[56:59], s50 offen offset:64
    s_waitcnt lgkmcnt(0)
    v_pk_fma_f32 v[102:103], v[102:103], v[202:203], v[222:223]
    v_pk_fma_f32 v[104:105], v[104:105], v[204:205], v[224:225]
    v_cvt_pk_bf16_f32 v234, v102, v103
    v_cvt_pk_bf16_f32 v235, v104, v105
    buffer_store_dwordx2 v[234:235], v236, s[56:59], s50 offen offset:128
    s_endpgm
P3_MORE:
    s_sub_u32 s63, s63, 1
    s_cselect_b32 s35, 0, s35
    s_ff1_i32_b32 s30, s34
    s_cmp_eq_u32 s30, s36
    s_cbranch_scc1 P3_AGAIN
    s_mov_b32 s36, s30
    s_add_u32 s31, s30, s54
    s_and_b32 s31, s31, 3
    s_cmp_eq_u32 s30, 4
    s_cselect_b32 s30, 4, s31
    s_mul_i32 s30, s30, 20480
    v_add_u32 v238, s30, v237
    ds_read_b128 v[106:109], v238 offset:0
    ds_read_b128 v[110:113], v238 offset:1024
    ds_read_b128 v[114:117], v238 offset:2048
    ds_read_b128 v[118:121], v238 offset:3072
    ds_read_b128 v[122:125], v238 offset:4096
    ds_read_b128 v[126:129], v238 offset:5120
    ds_read_b128 v[130:133], v238 offset:6144
    ds_read_b128 v[134:137], v238 offset:7168
    ds_read_b128 v[138:141], v238 offset:8192
    ds_read_b128 v[142:145], v238 offset:9216
    ds_read_b128 v[146:149], v238 offset:10240
    ds_read_b128 v[150:153], v238 offset:11264
    ds_read_b128 v[154:157], v238 offset:12288
    ds_read_b128 v[158:161], v238 offset:13312
    ds_read_b128 v[162:165], v238 offset:14336
    ds_read_b128 v[166:169], v238 offset:15360
    ds_read_b128 v[170:173], v238 offset:16384
    ds_read_b128 v[174:177], v238 offset:17408
    ds_read_b128 v[178:181], v238 offset:18432
    ds_read_b128 v[182:185], v238 offset:19456
P3_AGAIN:
    s_waitcnt vmcnt(0)
    s_branch P3_PASS
P3_A_13:
    buffer_load_dwordx4 v[6:9], v1, s[20:23], s96 offen offset:0 sc1
    buffer_load_dwordx4 v[10:13], v1, s[20:23], s96 offen offset:1024 sc1
    buffer_load_dwordx4 v[14:17], v1, s[20:23], s96 offen offset:2048 sc1
    buffer_load_dwordx4 v[18:21], v1, s[20:23], s96 offen offset:3072 sc1
    s_branch P3_S_11
P3_A_17:
    buffer_load_dwordx4 v[22:25], v1, s[20:23], s97 offen offset:0 sc1
    buffer_load_dwordx4 v[26:29], v1, s[20:23], s97 offen offset:1024 sc1
    buffer_load_dwordx4 v[30:33], v1, s[20:23], s97 offen offset:2048 sc1
    buffer_load_dwordx4 v[34:37], v1, s[20:23], s97 offen offset:3072 sc1
    s_branch P3_S_15
P3_A_21:
    buffer_load_dwordx4 v[38:41], v1, s[20:23], s98 offen offset:0 sc1
    buffer_load_dwordx4 v[42:45], v1, s[20:23], s98 offen offset:1024 sc1
    buffer_load_dwordx4 v[46:49], v1, s[20:23], s98 offen offset:2048 sc1
    buffer_load_dwordx4 v[50:53], v1, s[20:23], s98 offen offset:3072 sc1
    s_branch P3_S_19
P3_A_25:
    buffer_load_dwordx4 v[54:57], v1, s[20:23], s99 offen offset:0 sc1
    buffer_load_dwordx4 v[58:61], v1, s[20:23], s99 offen offset:1024 sc1
    buffer_load_dwordx4 v[62:65], v1, s[20:23], s99 offen offset:2048 sc1
    buffer_load_dwordx4 v[66:69], v1, s[20:23], s99 offen offset:3072 sc1
    s_branch P3_S_23
P3_A_29:
    buffer_load_dwordx2 v[70:71], v246, s[20:23], s100 offen offset:0 sc1
    buffer_load_dwordx2 v[72:73], v246, s[20:23], s100 offen offset:128 sc1
    buffer_load_dwordx2 v[74:75], v246, s[20:23], s100 offen offset:1024 sc1
    buffer_load_dwordx2 v[76:77], v246, s[20:23], s100 offen offset:1152 sc1
    buffer_load_dwordx2 v[78:79], v246, s[20:23], s100 offen offset:2048 sc1
    buffer_load_dwordx2 v[80:81], v246, s[20:23], s100 offen offset:2176 sc1
    buffer_load_dwordx2 v[82:83], v246, s[20:23], s100 offen offset:3072 sc1
    buffer_load_dwordx2 v[84:85], v246, s[20:23], s100 offen offset:3200 sc1
    s_branch P3_S_27
P3_N_14:
    ds_read_b128 v[106:109], v240 offset:0
    ds_read_b128 v[110:113], v240 offset:1024
    ds_read_b128 v[114:117], v240 offset:2048
    ds_read_b128 v[118:121], v240 offset:3072
    ds_read_b128 v[122:125], v240 offset:4096
    ds_read_b128 v[126:129], v240 offset:5120
    ds_read_b128 v[130:133], v240 offset:6144
    ds_read_b128 v[134:137], v240 offset:7168
    ds_read_b128 v[138:141], v240 offset:8192
    ds_read_b128 v[142:145], v240 offset:9216
    ds_read_b128 v[146:149], v240 offset:10240
    ds_read_b128 v[150:153], v240 offset:11264
    ds_read_b128 v[154:157], v240 offset:12288
    ds_read_b128 v[158:161], v240 offset:13312
    ds_read_b128 v[162:165], v240 offset:14336
    ds_read_b128 v[166:169], v240 offset:15360
    ds_read_b128 v[170:173], v240 offset:16384
    ds_read_b128 v[174:177], v240 offset:17408
    ds_read_b128 v[178:181], v240 offset:18432
    ds_read_b128 v[182:185], v240 offset:19456
    s_branch P3_H_12
P3_N_18:
    ds_read_b128 v[106:109], v241 offset:0
    ds_read_b128 v[110:113], v241 offset:1024
    ds_read_b128 v[114:117], v241 offset:2048
    ds_read_b128 v[118:121], v241 offset:3072
    ds_read_b128 v[122:125], v241 offset:4096
    ds_read_b128 v[126:129], v241 offset:5120
    ds_read_b128 v[130:133], v241 offset:6144
    ds_read_b128 v[134:137], v241 offset:7168
    ds_read_b128 v[138:141], v241 offset:8192
    ds_read_b128 v[142:145], v241 offset:9216
    ds_read_b128 v[146:149], v241 offset:10240
    ds_read_b128 v[150:153], v241 offset:11264
    ds_read_b128 v[154:157], v241 offset:12288
    ds_read_b128 v[158:161], v241 offset:13312
    ds_read_b128 v[162:165], v241 offset:14336
    ds_read_b128 v[166:169], v241 offset:15360
    ds_read_b128 v[170:173], v241 offset:16384
    ds_read_b128 v[174:177], v241 offset:17408
    ds_read_b128 v[178:181], v241 offset:18432
    ds_read_b128 v[182:185], v241 offset:19456
    s_branch P3_H_16
P3_N_22:
    ds_read_b128 v[106:109], v242 offset:0
    ds_read_b128 v[110:113], v242 offset:1024
    ds_read_b128 v[114:117], v242 offset:2048
    ds_read_b128 v[118:121], v242 offset:3072
    ds_read_b128 v[122:125], v242 offset:4096
    ds_read_b128 v[126:129], v242 offset:5120
    ds_read_b128 v[130:133], v242 offset:6144
    ds_read_b128 v[134:137], v242 offset:7168
    ds_read_b128 v[138:141], v242 offset:8192
    ds_read_b128 v[142:145], v242 offset:9216
    ds_read_b128 v[146:149], v242 offset:10240
    ds_read_b128 v[150:153], v242 offset:11264
    ds_read_b128 v[154:157], v242 offset:12288
    ds_read_b128 v[158:161], v242 offset:13312
    ds_read_b128 v[162:165], v242 offset:14336
    ds_read_b128 v[166:169], v242 offset:15360
    ds_read_b128 v[170:173], v242 offset:16384
    ds_read_b128 v[174:177], v242 offset:17408
    ds_read_b128 v[178:181], v242 offset:18432
    ds_read_b128 v[182:185], v242 offset:19456
    s_branch P3_H_20
P3_N_26:
    ds_read_b128 v[106:109], v243 offset:0
    ds_read_b128 v[110:113], v243 offset:1024
    ds_read_b128 v[114:117], v243 offset:2048
    ds_read_b128 v[118:121], v243 offset:3072
    ds_read_b128 v[122:125], v243 offset:4096
    ds_read_b128 v[126:129], v243 offset:5120
    ds_read_b128 v[130:133], v243 offset:6144
    ds_read_b128 v[134:137], v243 offset:7168
    ds_read_b128 v[138:141], v243 offset:8192
    ds_read_b128 v[142:145], v243 offset:9216
    ds_read_b128 v[146:149], v243 offset:10240
    ds_read_b128 v[150:153], v243 offset:11264
    ds_read_b128 v[154:157], v243 offset:12288
    ds_read_b128 v[158:161], v243 offset:13312
    ds_read_b128 v[162:165], v243 offset:14336
    ds_read_b128 v[166:169], v243 offset:15360
    ds_read_b128 v[170:173], v243 offset:16384
    ds_read_b128 v[174:177], v243 offset:17408
    ds_read_b128 v[178:181], v243 offset:18432
    ds_read_b128 v[182:185], v243 offset:19456
    s_branch P3_H_24
P3_N_30:
    ds_read_b128 v[106:109], v244 offset:0
    ds_read_b128 v[110:113], v244 offset:1024
    ds_read_b128 v[114:117], v244 offset:2048
    ds_read_b128 v[118:121], v244 offset:3072
    ds_read_b128 v[122:125], v244 offset:4096
    ds_read_b128 v[126:129], v244 offset:5120
    ds_read_b128 v[130:133], v244 offset:6144
    ds_read_b128 v[134:137], v244 offset:7168
    ds_read_b128 v[138:141], v244 offset:8192
    ds_read_b128 v[142:145], v244 offset:9216
    ds_read_b128 v[146:149], v244 offset:10240
    ds_read_b128 v[150:153], v244 offset:11264
    ds_read_b128 v[154:157], v244 offset:12288
    ds_read_b128 v[158:161], v244 offset:13312
    ds_read_b128 v[162:165], v244 offset:14336
    ds_read_b128 v[166:169], v244 offset:15360
    ds_read_b128 v[170:173], v244 offset:16384
    ds_read_b128 v[174:177], v244 offset:17408
    ds_read_b128 v[178:181], v244 offset:18432
    ds_read_b128 v[182:185], v244 offset:19456
    s_branch P3_H_28
P2_ATT_SLOW:
    v_mov_b32 v188, 0xff800000
    v_mov_b32 v190, 0xff800000
    s_mov_b32 s33, 0
P2_SLOW1:
    s_lshl_b32 s30, s33, 11
    s_add_u32 s30, s30, s5
    s_lshl_b32 s31, s33, 10
    s_add_u32 s31, s31, s7
    buffer_load_dwordx4 v[156:159], v1, s[20:23], s30 offen sc1
    buffer_load_dwordx4 v[160:163], v1, s[20:23], s30 offen offset:1024 sc1
    buffer_load_dwordx2 v[164:165], v18, s[20:23], s31 offen sc1
    s_waitcnt vmcnt(0)
    v_mfma_f32_32x32x4_2b_bf16 v[52:83], v[164:165], v[16:17], 0 cbsz:1 abid:0
    s_nop 15
    s_nop 1
    v_mfma_f32_32x32x16_bf16 v[52:67], v[156:159], v[8:11], v[52:67]
    v_mfma_f32_32x32x16_bf16 v[68:83], v[156:159], v[12:15], v[68:83]
    s_nop 11
    v_mfma_f32_32x32x4_2b_bf16 v[84:115], v[164:165], v[16:17], 0 cbsz:1 abid:1
    s_nop 15
    s_nop 1
    v_mfma_f32_32x32x16_bf16 v[84:99], v[160:163], v[8:11], v[84:99]
    v_mfma_f32_32x32x16_bf16 v[100:115], v[160:163], v[12:15], v[100:115]
    s_nop 11
    v_max3_f32 v188, v188, v52, v84
    v_max3_f32 v188, v188, v53, v85
    v_max3_f32 v188, v188, v54, v86
    v_max3_f32 v188, v188, v55, v87
    v_max3_f32 v188, v188, v56, v88
    v_max3_f32 v188, v188, v57, v89
    v_max3_f32 v188, v188, v58, v90
    v_max3_f32 v188, v188, v59, v91
    v_max3_f32 v188, v188, v60, v92
    v_max3_f32 v188, v188, v61, v93
    v_max3_f32 v188, v188, v62, v94
    v_max3_f32 v188, v188, v63, v95
    v_max3_f32 v188, v188, v64, v96
    v_max3_f32 v188, v188, v65, v97
    v_max3_f32 v188, v188, v66, v98
    v_max3_f32 v188, v188, v67, v99
    v_max3_f32 v190, v190, v68, v100
    v_max3_f32 v190, v190, v69, v101
    v_max3_f32 v190, v190, v70, v102
    v_max3_f32 v190, v190, v71, v103
    v_max3_f32 v190, v190, v72, v104
    v_max3_f32 v190, v190, v73, v105
    v_max3_f32 v190, v190, v74, v106
    v_max3_f32 v190, v190, v75, v107
    v_max3_f32 v190, v190, v76, v108
    v_max3_f32 v190, v190, v77, v109
    v_max3_f32 v190, v190, v78, v110
    v_max3_f32 v190, v190, v79, v111
    v_max3_f32 v190, v190, v80, v112
    v_max3_f32 v190, v190, v81, v113
    v_max3_f32 v190, v190, v82, v114
    v_max3_f32 v190, v190, v83, v115
    s_add_u32 s33, s33, 1
    s_cmp_lt_u32 s33, 32
    s_cbranch_scc1 P2_SLOW1
    v_mov_b32 v189, v188
    s_nop 1
    v_permlane32_swap_b32 v188, v189
    s_nop 1
    v_max_f32 v188, v188, v189
    v_sub_f32 v20, 0, v188
    v_mov_b32 v124, 0
    v_sub_f32 v21, 0, v188
    v_mov_b32 v125, 0
    v_sub_f32 v22, 0, v188
    v_mov_b32 v126, 0
    v_sub_f32 v23, 0, v188
    v_mov_b32 v127, 0
    v_sub_f32 v24, 0, v188
    v_mov_b32 v128, 0
    v_sub_f32 v25, 0, v188
    v_mov_b32 v129, 0
    v_sub_f32 v26, 0, v188
    v_mov_b32 v130, 0
    v_sub_f32 v27, 0, v188
    v_mov_b32 v131, 0
    v_sub_f32 v28, 0, v188
    v_mov_b32 v132, 0
    v_sub_f32 v29, 0, v188
    v_mov_b32 v133, 0
    v_sub_f32 v30, 0, v188
    v_mov_b32 v134, 0
    v_sub_f32 v31, 0, v188
    v_mov_b32 v135, 0
    v_sub_f32 v32, 0, v188
    v_mov_b32 v136, 0
    v_sub_f32 v33, 0, v188
    v_mov_b32 v137, 0
    v_sub_f32 v34, 0, v188
    v_mov_b32 v138, 0
    v_sub_f32 v35, 0, v188
    v_mov_b32 v139, 0
    v_mov_b32 v191, v190
    s_nop 1
    v_permlane32_swap_b32 v190, v191
    s_nop 1
    v_max_f32 v190, v190, v191
    v_sub_f32 v36, 0, v190
    v_mov_b32 v140, 0
    v_sub_f32 v37, 0, v190
    v_mov_b32 v141, 0
    v_sub_f32 v38, 0, v190
    v_mov_b32 v142, 0
    v_sub_f32 v39, 0, v190
    v_mov_b32 v143, 0
    v_sub_f32 v40, 0, v190
    v_mov_b32 v144, 0
    v_sub_f32 v41, 0, v190
    v_mov_b32 v145, 0
    v_sub_f32 v42, 0, v190
    v_mov_b32 v146, 0
    v_sub_f32 v43, 0, v190
    v_mov_b32 v147, 0
    v_sub_f32 v44, 0, v190
    v_mov_b32 v148, 0
    v_sub_f32 v45, 0, v190
    v_mov_b32 v149, 0
    v_sub_f32 v46, 0, v190
    v_mov_b32 v150, 0
    v_sub_f32 v47, 0, v190
    v_mov_b32 v151, 0
    v_sub_f32 v48, 0, v190
    v_mov_b32 v152, 0
    v_sub_f32 v49, 0, v190
    v_mov_b32 v153, 0
    v_sub_f32 v50, 0, v190
    v_mov_b32 v154, 0
    v_sub_f32 v51, 0, v190
    v_mov_b32 v155, 0
    v_mov_b32 v172, v6
    v_mov_b32 v173, v6
    v_mov_b32 v174, v6
    v_mov_b32 v175, v6
    v_mov_b32 v176, v6
    v_mov_b32 v177, v6
    v_mov_b32 v178, v6
    v_mov_b32 v179, v6
    v_mov_b32 v180, v6
    v_mov_b32 v181, v6
    v_mov_b32 v182, v6
    v_mov_b32 v183, v6
    v_mov_b32 v184, v6
    v_mov_b32 v185, v6
    v_mov_b32 v186, v6
    v_mov_b32 v187, v6
    s_mov_b32 s33, 0
P2_SLOW2:
    s_lshl_b32 s30, s33, 11
    s_add_u32 s30, s30, s5
    s_lshl_b32 s31, s33, 10
    s_add_u32 s31, s31, s7
    buffer_load_dwordx4 v[156:159], v1, s[20:23], s30 offen sc1
    buffer_load_dwordx4 v[160:163], v1, s[20:23], s30 offen offset:1024 sc1
    buffer_load_dwordx2 v[164:165], v18, s[20:23], s31 offen sc1
    s_mul_i32 s32, s33, 2560
    s_add_u32 s32, s32, s8
    s_mov_b64 exec, s[36:37]
    buffer_load_dwordx4 v[172:175], v4, s[20:23], s32 offen offset:0 sc1
    buffer_load_dwordx4 v[176:179], v4, s[20:23], s32 offen offset:640 sc1
    buffer_load_dwordx4 v[180:183], v4, s[20:23], s32 offen offset:1280 sc1
    buffer_load_dwordx4 v[184:187], v4, s[20:23], s32 offen offset:1920 sc1
    s_mov_b64 exec, -1
    s_waitcnt vmcnt(0)
    v_mfma_f32_32x32x4_2b_bf16 v[52:83], v[164:165], v[16:17], v[20:51] cbsz:1 abid:0
    s_nop 15
    s_nop 1
    v_mfma_f32_32x32x16_bf16 v[52:67], v[156:159], v[8:11], v[52:67]
    v_mfma_f32_32x32x16_bf16 v[68:83], v[156:159], v[12:15], v[68:83]
    s_nop 11
    v_exp_f32 v52, v52
    v_exp_f32 v53, v53
    v_exp_f32 v54, v54
    v_exp_f32 v55, v55
    v_exp_f32 v56, v56
    v_exp_f32 v57, v57
    v_exp_f32 v58, v58
    v_exp_f32 v59, v59
    v_exp_f32 v60, v60
    v_exp_f32 v61, v61
    v_exp_f32 v62, v62
    v_exp_f32 v63, v63
    v_exp_f32 v64, v64
    v_exp_f32 v65, v65
    v_exp_f32 v66, v66
    v_exp_f32 v67, v67
    s_nop 0
    v_cvt_pk_bf16_f32 v116, v52, v53
    v_cvt_pk_bf16_f32 v117, v54, v55
    v_cvt_pk_bf16_f32 v118, v56, v57
    v_cvt_pk_bf16_f32 v119, v58, v59
    v_cvt_pk_bf16_f32 v120, v60, v61
    v_cvt_pk_bf16_f32 v121, v62, v63
    v_cvt_pk_bf16_f32 v122, v64, v65
    v_cvt_pk_bf16_f32 v123, v66, v67
    s_nop 1
    v_mfma_f32_32x32x16_bf16 v[124:139], v[172:175], v[116:119], v[124:139]
    v_mfma_f32_32x32x16_bf16 v[124:139], v[176:179], v[120:123], v[124:139]
    s_nop 7
    v_exp_f32 v68, v68
    v_exp_f32 v69, v69
    v_exp_f32 v70, v70
    v_exp_f32 v71, v71
    v_exp_f32 v72, v72
    v_exp_f32 v73, v73
    v_exp_f32 v74, v74
    v_exp_f32 v75, v75
    v_exp_f32 v76, v76
    v_exp_f32 v77, v77
    v_exp_f32 v78, v78
    v_exp_f32 v79, v79
    v_exp_f32 v80, v80
    v_exp_f32 v81, v81
    v_exp_f32 v82, v82
    v_exp_f32 v83, v83
    s_nop 0
    v_cvt_pk_bf16_f32 v116, v68, v69
    v_cvt_pk_bf16_f32 v117, v70, v71
    v_cvt_pk_bf16_f32 v118, v72, v73
    v_cvt_pk_bf16_f32 v119, v74, v75
    v_cvt_pk_bf16_f32 v120, v76, v77
    v_cvt_pk_bf16_f32 v121, v78, v79
    v_cvt_pk_bf16_f32 v122, v80, v81
    v_cvt_pk_bf16_f32 v123, v82, v83
    s_nop 1
    v_mfma_f32_32x32x16_bf16 v[140:155], v[172:175], v[116:119], v[140:155]
    v_mfma_f32_32x32x16_bf16 v[140:155], v[176:179], v[120:123], v[140:155]
    s_nop 7
    v_mfma_f32_32x32x4_2b_bf16 v[52:83], v[164:165], v[16:17], v[20:51] cbsz:1 abid:1
    s_nop 15
    s_nop 1
    v_mfma_f32_32x32x16_bf16 v[52:67], v[160:163], v[8:11], v[52:67]
    v_mfma_f32_32x32x16_bf16 v[68:83], v[160:163], v[12:15], v[68:83]
    s_nop 11
    v_exp_f32 v52, v52
    v_exp_f32 v53, v53
    v_exp_f32 v54, v54
    v_exp_f32 v55, v55
    v_exp_f32 v56, v56
    v_exp_f32 v57, v57
    v_exp_f32 v58, v58
    v_exp_f32 v59, v59
    v_exp_f32 v60, v60
    v_exp_f32 v61, v61
    v_exp_f32 v62, v62
    v_exp_f32 v63, v63
    v_exp_f32 v64, v64
    v_exp_f32 v65, v65
    v_exp_f32 v66, v66
    v_exp_f32 v67, v67
    s_nop 0
    v_cvt_pk_bf16_f32 v116, v52, v53
    v_cvt_pk_bf16_f32 v117, v54, v55
    v_cvt_pk_bf16_f32 v118, v56, v57
    v_cvt_pk_bf16_f32 v119, v58, v59
    v_cvt_pk_bf16_f32 v120, v60, v61
    v_cvt_pk_bf16_f32 v121, v62, v63
    v_cvt_pk_bf16_f32 v122, v64, v65
    v_cvt_pk_bf16_f32 v123, v66, v67
    s_nop 1
    v_mfma_f32_32x32x16_bf16 v[124:139], v[180:183], v[116:119], v[124:139]
    v_mfma_f32_32x32x16_bf16 v[124:139], v[184:187], v[120:123], v[124:139]
    s_nop 7
    v_exp_f32 v68, v68
    v_exp_f32 v69, v69
    v_exp_f32 v70, v70
    v_exp_f32 v71, v71
    v_exp_f32 v72, v72
    v_exp_f32 v73, v73
    v_exp_f32 v74, v74
    v_exp_f32 v75, v75
    v_exp_f32 v76, v76
    v_exp_f32 v77, v77
    v_exp_f32 v78, v78
    v_exp_f32 v79, v79
    v_exp_f32 v80, v80
    v_exp_f32 v81, v81
    v_exp_f32 v82, v82
    v_exp_f32 v83, v83
    s_nop 0
    v_cvt_pk_bf16_f32 v116, v68, v69
    v_cvt_pk_bf16_f32 v117, v70, v71
    v_cvt_pk_bf16_f32 v118, v72, v73
    v_cvt_pk_bf16_f32 v119, v74, v75
    v_cvt_pk_bf16_f32 v120, v76, v77
    v_cvt_pk_bf16_f32 v121, v78, v79
    v_cvt_pk_bf16_f32 v122, v80, v81
    v_cvt_pk_bf16_f32 v123, v82, v83
    s_nop 1
    v_mfma_f32_32x32x16_bf16 v[140:155], v[180:183], v[116:119], v[140:155]
    v_mfma_f32_32x32x16_bf16 v[140:155], v[184:187], v[120:123], v[140:155]
    s_nop 7
    s_add_u32 s33, s33, 1
    s_cmp_lt_u32 s33, 32
    s_cbranch_scc1 P2_SLOW2
    s_nop 15
    s_branch P2_ATT_STORE
P2_GEMM:
    s_setprio 2
    s_load_dwordx2 s[10:11], s[0:1], 56
    s_load_dwordx2 s[28:29], s[0:1], 16
    s_add_u32 m0, s43, 32768
    s_add_u32 s30, s40, 8192
    buffer_load_dwordx4 v1, s[20:23], s30 offen sc1 lds
    s_add_u32 m0, s43, 47104
    s_add_u32 s30, s40, 12288
    buffer_load_dwordx4 v1, s[20:23], s30 offen sc1 lds
    s_add_u32 m0, s44, 32768
    s_add_u32 s30, s41, 4096
    buffer_load_dwordx4 v1, s[20:23], s30 offen sc1 lds
    s_mov_b64 exec, s[36:37]
    s_add_u32 m0, s45, 32768
    s_add_u32 s30, s42, 10240
    buffer_load_dwordx4 v4, s[20:23], s30 offen sc1 lds
    s_add_u32 m0, s45, 33792
    s_add_u32 s30, s42, 10880
    buffer_load_dwordx4 v4, s[20:23], s30 offen sc1 lds
    s_add_u32 m0, s45, 47104
    s_add_u32 s30, s42, 15360
    buffer_load_dwordx4 v4, s[20:23], s30 offen sc1 lds
    s_add_u32 m0, s45, 48128
    s_add_u32 s30, s42, 16000
    buffer_load_dwordx4 v4, s[20:23], s30 offen sc1 lds
    s_mov_b64 exec, -1
    s_and_b32 s52, s3, 2
    s_lshl_b32 s52, s52, 9
    s_xor_b32 s53, s52, 1024
    buffer_store_dwordx4 v[214:217], v72, s[20:23], s52 offen sc1
    buffer_store_dwordx4 v[218:221], v73, s[20:23], s52 offen sc1
    buffer_store_dwordx4 v[222:225], v74, s[20:23], s52 offen sc1
    buffer_store_dwordx4 v[226:229], v75, s[20:23], s52 offen sc1
    buffer_store_dwordx4 v[230:233], v72, s[20:23], s53 offen sc1
    buffer_store_dwordx4 v[234:237], v73, s[20:23], s53 offen sc1
    buffer_store_dwordx4 v[238:241], v74, s[20:23], s53 offen sc1
    buffer_store_dwordx4 v[242:245], v75, s[20:23], s53 offen sc1
    s_mul_i32 s54, s19, 14
    s_cmp_eq_u32 s19, 3
    s_cselect_b32 s31, 1, 0
    s_sub_u32 s54, s54, s31
    s_mul_i32 s47, s17, 221184
    s_lshl_b32 s31, s54, 10
    s_add_u32 s47, s47, s31
    s_add_u32 s47, s47, 0x800000
    s_mul_i32 s48, s18, 54
    s_add_u32 s48, s48, s54
    s_mul_i32 s48, s48, 5120
    s_add_u32 s48, s48, 0xf00000
    v_add_u32 v30, 4096, v1
    v_mov_b32 v31, s61
    s_xor_b32 s31, s19, 0
    s_mul_i32 s31, s31, 55296
    v_add_u32 v26, s31, v1
    s_xor_b32 s31, s19, 1
    s_mul_i32 s31, s31, 55296
    v_add_u32 v27, s31, v1
    s_xor_b32 s31, s19, 2
    s_mul_i32 s31, s31, 55296
    v_add_u32 v28, s31, v1
    s_xor_b32 s31, s19, 3
    s_mul_i32 s31, s31, 55296
    v_add_u32 v29, s31, v1
    s_mul_i32 s49, s18, 102400
    s_add_u32 s49, s49, 0x1200000
    v_lshrrev_b32 v33, 4, v0
    v_lshlrev_b32 v33, 3, v33
    v_subrev_u32 v34, 32, v0
    v_min_u32 v34, 6, v34
    v_lshlrev_b32 v34, 4, v34
    s_lshl_b32 s31, s17, 7
    s_add_u32 s31, s31, 26218496
    v_add_u32 v34, s31, v34
    v_add_u32 v35, 26226688, v1
    v_cmp_gt_u32 vcc, 32, v0
    s_waitcnt lgkmcnt(0)
    s_mov_b32 s24, s10
    s_and_b32 s25, s11, 0xffff
    s_mov_b32 s26, 0x500
    s_mov_b32 s27, 0x00020000
    s_mov_b32 s56, s28
    s_and_b32 s57, s29, 0xffff
    s_mov_b32 s58, 0xc8000
    s_mov_b32 s59, 0x00020000
    v_cndmask_b32 v34, v34, v35, vcc
    s_waitcnt vmcnt(8)
    s_barrier
    s_add_u32 m0, s43, 4096
    s_add_u32 s30, s40, 16384
    buffer_load_dwordx4 v1, s[20:23], s30 offen sc1 lds
    s_add_u32 m0, s43, 18432
    s_add_u32 s30, s40, 20480
    buffer_load_dwordx4 v1, s[20:23], s30 offen sc1 lds
    s_add_u32 m0, s44, 4096
    s_add_u32 s30, s41, 8192
    buffer_load_dwordx4 v1, s[20:23], s30 offen sc1 lds
    s_mov_b64 exec, s[36:37]
    s_add_u32 m0, s45, 4096
    s_add_u32 s30, s42, 20480
    buffer_load_dwordx4 v4, s[20:23], s30 offen sc1 lds
    s_add_u32 m0, s45, 5120
    s_add_u32 s30, s42, 21120
    buffer_load_dwordx4 v4, s[20:23], s30 offen sc1 lds
    s_add_u32 m0, s45, 18432
    s_add_u32 s30, s42, 25600
    buffer_load_dwordx4 v4, s[20:23], s30 offen sc1 lds
    s_add_u32 m0, s45, 19456
    s_add_u32 s30, s42, 26240
    buffer_load_dwordx4 v4, s[20:23], s30 offen sc1 lds
    s_mov_b64 exec, -1
    s_waitcnt vmcnt(7)
    s_mov_b64 exec, 1
    buffer_store_dword v31, off, s[20:23], s46 sc1
    s_mov_b64 exec, -1
    buffer_load_dwordx2 v[40:41], v33, s[24:27], s51 offen offset:0
    buffer_load_dwordx2 v[42:43], v33, s[24:27], s51 offen offset:32
    buffer_load_dwordx2 v[44:45], v33, s[24:27], s51 offen offset:64
    buffer_load_dwordx2 v[46:47], v33, s[24:27], s51 offen offset:96
    buffer_load_dwordx2 v[48:49], v33, s[24:27], s51 offen offset:128
    s_xor_b32 s9, s2, 255
    s_mul_i32 s34, s9, 6554
    s_lshr_b32 s34, s34, 16
    s_mul_i32 s35, s34, 10
    s_sub_u32 s35, s9, s35
    s_lshl_b32 s30, s34, 2
    s_add_u32 s30, s30, s19
    s_lshr_b32 s31, s30, 1
    s_mul_i32 s31, s31, 20
    s_and_b32 s32, s30, 1
    s_lshl_b32 s32, s32, 2
    s_add_u32 s31, s31, s32
    s_mul_i32 s33, s30, 40
    s_sub_u32 s33, s33, 2544
    s_cmp_ge_u32 s30, 64
    s_cselect_b32 s31, s33, s31
    s_cselect_b32 s32, 20, 8
    s_mul_i32 s31, s31, 1280
    s_lshl_b32 s33, s35, 7
    s_add_u32 s31, s31, s33
    v_lshrrev_b32 v50, 5, v0
    v_mul_lo_u32 v50, s32, v50
    v_bfe_u32 v51, v0, 3, 2
    v_add_u32 v50, v50, v51
    v_mul_u32_u24 v50, 1280, v50
    v_and_b32 v51, 7, v0
    v_lshl_add_u32 v50, v51, 4, v50
    s_add_u32 m0, s43, 61440
    s_nop 0
    buffer_load_dwordx4 v50, s[56:59], s31 offen lds
    s_waitcnt vmcnt(0)
    s_barrier
    s_add_u32 m0, s43, 32768
    s_add_u32 s30, s40, 24576
    buffer_load_dwordx4 v1, s[20:23], s30 offen sc1 lds
    s_add_u32 m0, s43, 47104
    s_add_u32 s30, s40, 28672
    buffer_load_dwordx4 v1, s[20:23], s30 offen sc1 lds
    s_add_u32 m0, s44, 32768
    s_add_u32 s30, s41, 12288
    buffer_load_dwordx4 v1, s[20:23], s30 offen sc1 lds
    s_mov_b64 exec, s[36:37]
    s_add_u32 m0, s45, 32768
    s_add_u32 s30, s42, 30720
    buffer_load_dwordx4 v4, s[20:23], s30 offen sc1 lds
    s_add_u32 m0, s45, 33792
    s_add_u32 s30, s42, 31360
    buffer_load_dwordx4 v4, s[20:23], s30 offen sc1 lds
    s_add_u32 m0, s45, 47104
    s_add_u32 s30, s42, 35840
    buffer_load_dwordx4 v4, s[20:23], s30 offen sc1 lds
    s_add_u32 m0, s45, 48128
    s_add_u32 s30, s42, 36480
    buffer_load_dwordx4 v4, s[20:23], s30 offen sc1 lds
    s_mov_b64 exec, -1
    s_mov_b32 s63, 30000
POLL_31:
    buffer_load_dwordx4 v[36:39], v34, s[20:23], 0 offen sc1
    s_waitcnt vmcnt(0)
    v_xor_b32 v36, s61, v36
    v_xor_b32 v37, s61, v37
    v_xor_b32 v38, s61, v38
    v_xor_b32 v39, s61, v39
    v_or3_b32 v36, v36, v37, v38
    v_or_b32 v36, v36, v39
    v_cmp_ne_u32 vcc, 0, v36
    s_cbranch_vccz POLLED_32
    s_sleep 8
    s_sub_u32 s63, s63, 1
    s_cmp_lg_u32 s63, 0
    s_cbranch_scc1 POLL_31
POLLED_32:
    s_add_u32 s30, s47, 0
    s_add_u32 s31, s48, 0
    buffer_load_dwordx4 v[130:133], v26, s[20:23], s30 offen sc1
    buffer_load_dwordx4 v[134:137], v27, s[20:23], s30 offen sc1
    buffer_load_dwordx4 v[138:141], v28, s[20:23], s30 offen sc1
    buffer_load_dwordx4 v[142:145], v29, s[20:23], s30 offen sc1
    buffer_load_dwordx4 v[146:149], v1, s[20:23], s31 offen offset:0 sc1
    buffer_load_dwordx4 v[150:153], v1, s[20:23], s31 offen offset:1024 sc1
    buffer_load_dwordx4 v[154:157], v1, s[20:23], s31 offen offset:2048 sc1
    buffer_load_dwordx4 v[158:161], v1, s[20:23], s31 offen offset:3072 sc1
    buffer_load_dwordx4 v[162:165], v30, s[20:23], s31 offen sc1
    s_add_u32 s30, s47, 1024
    s_add_u32 s31, s48, 5120
    buffer_load_dwordx4 v[166:169], v26, s[20:23], s30 offen sc1
    buffer_load_dwordx4 v[170:173], v27, s[20:23], s30 offen sc1
    buffer_load_dwordx4 v[174:177], v28, s[20:23], s30 offen sc1
    buffer_load_dwordx4 v[178:181], v29, s[20:23], s30 offen sc1
    buffer_load_dwordx4 v[182:185], v1, s[20:23], s31 offen offset:0 sc1
    buffer_load_dwordx4 v[186:189], v1, s[20:23], s31 offen offset:1024 sc1
    buffer_load_dwordx4 v[190:193], v1, s[20:23], s31 offen offset:2048 sc1
    buffer_load_dwordx4 v[194:197], v1, s[20:23], s31 offen offset:3072 sc1
    buffer_load_dwordx4 v[198:201], v30, s[20:23], s31 offen sc1
    v_lshrrev_b32 v50, 4, v0
    v_lshlrev_b32 v50, 10, v50
    v_bfe_u32 v51, v0, 2, 2
    v_lshl_add_u32 v50, v51, 7, v50
    v_and_b32 v51, 3, v0
    v_lshl_add_u32 v50, v51, 3, v50
    s_lshl_b32 s30, s19, 5
    v_add_u32 v50, s30, v50
    ds_read_b64_tr_b16 v[54:55], v50 offset:61440
    ds_read_b64_tr_b16 v[56:57], v50 offset:61952
    s_lshl_b32 s30, s35, 2
    s_add_u32 s30, s30, s19
    s_mul_i32 s30, s30, 20
    s_add_u32 s30, s30, s34
    s_lshl_b32 s30, s30, 10
    s_add_u32 s30, s30, 18874368
    s_cmp_ge_u32 s9, 200
    s_cselect_b32 s30, 0x2000000, s30
    s_waitcnt lgkmcnt(0)
    buffer_store_dwordx4 v[54:57], v1, s[20:23], s30 offen sc1
    s_lshl_b32 s30, s15, 2
    s_add_u32 s30, s30, s19
    s_lshl_b32 s30, s30, 7
    s_lshl_b32 s31, s16, 2
    s_add_u32 s30, s30, s31
    s_add_u32 s30, s30, 26222592
    s_mov_b64 exec, 1
    buffer_store_dword v31, off, s[20:23], s30 sc1
    s_mov_b64 exec, -1
    s_barrier
    s_add_u32 m0, s43, 4096
    s_add_u32 s30, s40, 32768
    buffer_load_dwordx4 v1, s[20:23], s30 offen sc1 lds
    s_add_u32 m0, s43, 18432
    s_add_u32 s30, s40, 36864
    buffer_load_dwordx4 v1, s[20:23], s30 offen sc1 lds
    s_add_u32 m0, s44, 4096
    s_add_u32 s30, s41, 16384
    buffer_load_dwordx4 v1, s[20:23], s30 offen sc1 lds
    s_mov_b64 exec, s[36:37]
    s_add_u32 m0, s45, 4096
    s_add_u32 s30, s42, 40960
    buffer_load_dwordx4 v4, s[20:23], s30 offen sc1 lds
    s_add_u32 m0, s45, 5120
    s_add_u32 s30, s42, 41600
    buffer_load_dwordx4 v4, s[20:23], s30 offen sc1 lds
    s_add_u32 m0, s45, 18432
    s_add_u32 s30, s42, 46080
    buffer_load_dwordx4 v4, s[20:23], s30 offen sc1 lds
    s_add_u32 m0, s45, 19456
    s_add_u32 s30, s42, 46720
    buffer_load_dwordx4 v4, s[20:23], s30 offen sc1 lds
    s_mov_b64 exec, -1
    s_add_u32 s30, s47, 2048
    s_add_u32 s31, s48, 10240
    buffer_load_dwordx4 v[202:205], v26, s[20:23], s30 offen sc1
    buffer_load_dwordx4 v[206:209], v27, s[20:23], s30 offen sc1
    buffer_load_dwordx4 v[210:213], v28, s[20:23], s30 offen sc1
    buffer_load_dwordx4 v[214:217], v29, s[20:23], s30 offen sc1
    buffer_load_dwordx4 v[218:221], v1, s[20:23], s31 offen offset:0 sc1
    buffer_load_dwordx4 v[222:225], v1, s[20:23], s31 offen offset:1024 sc1
    buffer_load_dwordx4 v[226:229], v1, s[20:23], s31 offen offset:2048 sc1
    buffer_load_dwordx4 v[230:233], v1, s[20:23], s31 offen offset:3072 sc1
    buffer_load_dwordx4 v[234:237], v30, s[20:23], s31 offen sc1
    s_setprio 0
    s_waitcnt vmcnt(31)
    v_mfma_f32_16x16x32_bf16 v[50:53], v[146:149], v[130:133], 0
    v_mfma_f32_16x16x32_bf16 v[70:73], v[146:149], v[134:137], 0
    v_mfma_f32_16x16x32_bf16 v[90:93], v[146:149], v[138:141], 0
    v_mfma_f32_16x16x32_bf16 v[110:113], v[146:149], v[142:145], 0
    s_waitcnt vmcnt(30)
    v_mfma_f32_16x16x32_bf16 v[114:117], v[150:153], v[142:145], 0
    v_mfma_f32_16x16x32_bf16 v[94:97], v[150:153], v[138:141], 0
    v_mfma_f32_16x16x32_bf16 v[74:77], v[150:153], v[134:137], 0
    v_mfma_f32_16x16x32_bf16 v[54:57], v[150:153], v[130:133], 0
    s_waitcnt vmcnt(29)
    v_mfma_f32_16x16x32_bf16 v[58:61], v[154:157], v[130:133], 0
    v_mfma_f32_16x16x32_bf16 v[78:81], v[154:157], v[134:137], 0
    v_mfma_f32_16x16x32_bf16 v[98:101], v[154:157], v[138:141], 0
    v_mfma_f32_16x16x32_bf16 v[118:121], v[154:157], v[142:145], 0
    s_waitcnt vmcnt(28)
    v_mfma_f32_16x16x32_bf16 v[122:125], v[158:161], v[142:145], 0
    v_mfma_f32_16x16x32_bf16 v[102:105], v[158:161], v[138:141], 0
    v_mfma_f32_16x16x32_bf16 v[82:85], v[158:161], v[134:137], 0
    v_mfma_f32_16x16x32_bf16 v[62:65], v[158:161], v[130:133], 0
    s_waitcnt vmcnt(27)
    v_mfma_f32_16x16x32_bf16 v[66:69], v[162:165], v[130:133], 0
    v_mfma_f32_16x16x32_bf16 v[86:89], v[162:165], v[134:137], 0
    v_mfma_f32_16x16x32_bf16 v[106:109], v[162:165], v[138:141], 0
    v_mfma_f32_16x16x32_bf16 v[126:129], v[162:165], v[142:145], 0
    s_add_u32 s30, s47, 3072
    s_add_u32 s31, s48, 15360
    buffer_load_dwordx4 v[130:133], v26, s[20:23], s30 offen sc1
    buffer_load_dwordx4 v[134:137], v27, s[20:23], s30 offen sc1
    buffer_load_dwordx4 v[138:141], v28, s[20:23], s30 offen sc1
    buffer_load_dwordx4 v[142:145], v29, s[20:23], s30 offen sc1
    buffer_load_dwordx4 v[146:149], v1, s[20:23], s31 offen offset:0 sc1
    buffer_load_dwordx4 v[150:153], v1, s[20:23], s31 offen offset:1024 sc1
    buffer_load_dwordx4 v[154:157], v1, s[20:23], s31 offen offset:2048 sc1
    buffer_load_dwordx4 v[158:161], v1, s[20:23], s31 offen offset:3072 sc1
    buffer_load_dwordx4 v[162:165], v30, s[20:23], s31 offen sc1
    s_waitcnt vmcnt(31)
    v_mfma_f32_16x16x32_bf16 v[50:53], v[182:185], v[166:169], v[50:53]
    v_mfma_f32_16x16x32_bf16 v[70:73], v[182:185], v[170:173], v[70:73]
    v_mfma_f32_16x16x32_bf16 v[90:93], v[182:185], v[174:177], v[90:93]
    v_mfma_f32_16x16x32_bf16 v[110:113], v[182:185], v[178:181], v[110:113]
    s_waitcnt vmcnt(30)
    v_mfma_f32_16x16x32_bf16 v[114:117], v[186:189], v[178:181], v[114:117]
    v_mfma_f32_16x16x32_bf16 v[94:97], v[186:189], v[174:177], v[94:97]
    v_mfma_f32_16x16x32_bf16 v[74:77], v[186:189], v[170:173], v[74:77]
    v_mfma_f32_16x16x32_bf16 v[54:57], v[186:189], v[166:169], v[54:57]
    s_waitcnt vmcnt(29)
    v_mfma_f32_16x16x32_bf16 v[58:61], v[190:193], v[166:169], v[58:61]
    v_mfma_f32_16x16x32_bf16 v[78:81], v[190:193], v[170:173], v[78:81]
    v_mfma_f32_16x16x32_bf16 v[98:101], v[190:193], v[174:177], v[98:101]
    v_mfma_f32_16x16x32_bf16 v[118:121], v[190:193], v[178:181], v[118:121]
    s_waitcnt vmcnt(28)
    v_mfma_f32_16x16x32_bf16 v[122:125], v[194:197], v[178:181], v[122:125]
    v_mfma_f32_16x16x32_bf16 v[102:105], v[194:197], v[174:177], v[102:105]
    v_mfma_f32_16x16x32_bf16 v[82:85], v[194:197], v[170:173], v[82:85]
    v_mfma_f32_16x16x32_bf16 v[62:65], v[194:197], v[166:169], v[62:65]
    s_waitcnt vmcnt(27)
    v_mfma_f32_16x16x32_bf16 v[66:69], v[198:201], v[166:169], v[66:69]
    v_mfma_f32_16x16x32_bf16 v[86:89], v[198:201], v[170:173], v[86:89]
    v_mfma_f32_16x16x32_bf16 v[106:109], v[198:201], v[174:177], v[106:109]
    v_mfma_f32_16x16x32_bf16 v[126:129], v[198:201], v[178:181], v[126:129]
    s_add_u32 s30, s47, 4096
    s_add_u32 s31, s48, 20480
    buffer_load_dwordx4 v[166:169], v26, s[20:23], s30 offen sc1
    buffer_load_dwordx4 v[170:173], v27, s[20:23], s30 offen sc1
    buffer_load_dwordx4 v[174:177], v28, s[20:23], s30 offen sc1
    buffer_load_dwordx4 v[178:181], v29, s[20:23], s30 offen sc1
    buffer_load_dwordx4 v[182:185], v1, s[20:23], s31 offen offset:0 sc1
    buffer_load_dwordx4 v[186:189], v1, s[20:23], s31 offen offset:1024 sc1
    buffer_load_dwordx4 v[190:193], v1, s[20:23], s31 offen offset:2048 sc1
    buffer_load_dwordx4 v[194:197], v1, s[20:23], s31 offen offset:3072 sc1
    buffer_load_dwordx4 v[198:201], v30, s[20:23], s31 offen sc1
    s_setprio 2
    s_waitcnt vmcnt(27)
    s_barrier
    s_add_u32 m0, s43, 32768
    s_add_u32 s30, s40, 40960
    buffer_load_dwordx4 v1, s[20:23], s30 offen sc1 lds
    s_add_u32 m0, s43, 47104
    s_add_u32 s30, s40, 45056
    buffer_load_dwordx4 v1, s[20:23], s30 offen sc1 lds
    s_add_u32 m0, s44, 32768
    s_add_u32 s30, s41, 20480
    buffer_load_dwordx4 v1, s[20:23], s30 offen sc1 lds
    s_mov_b64 exec, s[36:37]
    s_add_u32 m0, s45, 32768
    s_add_u32 s30, s42, 51200
    buffer_load_dwordx4 v4, s[20:23], s30 offen sc1 lds
    s_add_u32 m0, s45, 33792
    s_add_u32 s30, s42, 51840
    buffer_load_dwordx4 v4, s[20:23], s30 offen sc1 lds
    s_add_u32 m0, s45, 47104
    s_add_u32 s30, s42, 56320
    buffer_load_dwordx4 v4, s[20:23], s30 offen sc1 lds
    s_add_u32 m0, s45, 48128
    s_add_u32 s30, s42, 56960
    buffer_load_dwordx4 v4, s[20:23], s30 offen sc1 lds
    s_mov_b64 exec, -1
    s_lshl_b32 s30, s9, 2
    s_add_u32 s30, s30, 26227712
    s_cmp_eq_u32 s3, 4
    s_cselect_b32 s30, s30, 0x2000000
    s_mov_b64 exec, 1
    buffer_store_dword v31, off, s[20:23], s30 sc1
    s_mov_b64 exec, -1
    s_setprio 0
    s_waitcnt vmcnt(30)
    v_mfma_f32_16x16x32_bf16 v[50:53], v[218:221], v[202:205], v[50:53]
    v_mfma_f32_16x16x32_bf16 v[70:73], v[218:221], v[206:209], v[70:73]
    v_mfma_f32_16x16x32_bf16 v[90:93], v[218:221], v[210:213], v[90:93]
    v_mfma_f32_16x16x32_bf16 v[110:113], v[218:221], v[214:217], v[110:113]
    s_waitcnt vmcnt(29)
    v_mfma_f32_16x16x32_bf16 v[114:117], v[222:225], v[214:217], v[114:117]
    v_mfma_f32_16x16x32_bf16 v[94:97], v[222:225], v[210:213], v[94:97]
    v_mfma_f32_16x16x32_bf16 v[74:77], v[222:225], v[206:209], v[74:77]
    v_mfma_f32_16x16x32_bf16 v[54:57], v[222:225], v[202:205], v[54:57]
    s_waitcnt vmcnt(28)
    v_mfma_f32_16x16x32_bf16 v[58:61], v[226:229], v[202:205], v[58:61]
    v_mfma_f32_16x16x32_bf16 v[78:81], v[226:229], v[206:209], v[78:81]
    v_mfma_f32_16x16x32_bf16 v[98:101], v[226:229], v[210:213], v[98:101]
    v_mfma_f32_16x16x32_bf16 v[118:121], v[226:229], v[214:217], v[118:121]
    s_waitcnt vmcnt(27)
    v_mfma_f32_16x16x32_bf16 v[122:125], v[230:233], v[214:217], v[122:125]
    v_mfma_f32_16x16x32_bf16 v[102:105], v[230:233], v[210:213], v[102:105]
    v_mfma_f32_16x16x32_bf16 v[82:85], v[230:233], v[206:209], v[82:85]
    v_mfma_f32_16x16x32_bf16 v[62:65], v[230:233], v[202:205], v[62:65]
    s_waitcnt vmcnt(26)
    v_mfma_f32_16x16x32_bf16 v[66:69], v[234:237], v[202:205], v[66:69]
    v_mfma_f32_16x16x32_bf16 v[86:89], v[234:237], v[206:209], v[86:89]
    v_mfma_f32_16x16x32_bf16 v[106:109], v[234:237], v[210:213], v[106:109]
    v_mfma_f32_16x16x32_bf16 v[126:129], v[234:237], v[214:217], v[126:129]
    s_add_u32 s30, s47, 5120
    s_add_u32 s31, s48, 25600
    buffer_load_dwordx4 v[202:205], v26, s[20:23], s30 offen sc1
    buffer_load_dwordx4 v[206:209], v27, s[20:23], s30 offen sc1
    buffer_load_dwordx4 v[210:213], v28, s[20:23], s30 offen sc1
    buffer_load_dwordx4 v[214:217], v29, s[20:23], s30 offen sc1
    buffer_load_dwordx4 v[218:221], v1, s[20:23], s31 offen offset:0 sc1
    buffer_load_dwordx4 v[222:225], v1, s[20:23], s31 offen offset:1024 sc1
    buffer_load_dwordx4 v[226:229], v1, s[20:23], s31 offen offset:2048 sc1
    buffer_load_dwordx4 v[230:233], v1, s[20:23], s31 offen offset:3072 sc1
    buffer_load_dwordx4 v[234:237], v30, s[20:23], s31 offen sc1
    s_waitcnt vmcnt(30)
    v_mfma_f32_16x16x32_bf16 v[50:53], v[146:149], v[130:133], v[50:53]
    v_mfma_f32_16x16x32_bf16 v[70:73], v[146:149], v[134:137], v[70:73]
    v_mfma_f32_16x16x32_bf16 v[90:93], v[146:149], v[138:141], v[90:93]
    v_mfma_f32_16x16x32_bf16 v[110:113], v[146:149], v[142:145], v[110:113]
    s_waitcnt vmcnt(29)
    v_mfma_f32_16x16x32_bf16 v[114:117], v[150:153], v[142:145], v[114:117]
    v_mfma_f32_16x16x32_bf16 v[94:97], v[150:153], v[138:141], v[94:97]
    v_mfma_f32_16x16x32_bf16 v[74:77], v[150:153], v[134:137], v[74:77]
    v_mfma_f32_16x16x32_bf16 v[54:57], v[150:153], v[130:133], v[54:57]
    s_waitcnt vmcnt(28)
    v_mfma_f32_16x16x32_bf16 v[58:61], v[154:157], v[130:133], v[58:61]
    v_mfma_f32_16x16x32_bf16 v[78:81], v[154:157], v[134:137], v[78:81]
    v_mfma_f32_16x16x32_bf16 v[98:101], v[154:157], v[138:141], v[98:101]
    v_mfma_f32_16x16x32_bf16 v[118:121], v[154:157], v[142:145], v[118:121]
    s_waitcnt vmcnt(27)
    v_mfma_f32_16x16x32_bf16 v[122:125], v[158:161], v[142:145], v[122:125]
    v_mfma_f32_16x16x32_bf16 v[102:105], v[158:161], v[138:141], v[102:105]
    v_mfma_f32_16x16x32_bf16 v[82:85], v[158:161], v[134:137], v[82:85]
    v_mfma_f32_16x16x32_bf16 v[62:65], v[158:161], v[130:133], v[62:65]
    s_waitcnt vmcnt(26)
    v_mfma_f32_16x16x32_bf16 v[66:69], v[162:165], v[130:133], v[66:69]
    v_mfma_f32_16x16x32_bf16 v[86:89], v[162:165], v[134:137], v[86:89]
    v_mfma_f32_16x16x32_bf16 v[106:109], v[162:165], v[138:141], v[106:109]
    v_mfma_f32_16x16x32_bf16 v[126:129], v[162:165], v[142:145], v[126:129]
    s_add_u32 s30, s47, 6144
    s_add_u32 s31, s48, 30720
    buffer_load_dwordx4 v[130:133], v26, s[20:23], s30 offen sc1
    buffer_load_dwordx4 v[134:137], v27, s[20:23], s30 offen sc1
    buffer_load_dwordx4 v[138:141], v28, s[20:23], s30 offen sc1
    buffer_load_dwordx4 v[142:145], v29, s[20:23], s30 offen sc1
    buffer_load_dwordx4 v[146:149], v1, s[20:23], s31 offen offset:0 sc1
    buffer_load_dwordx4 v[150:153], v1, s[20:23], s31 offen offset:1024 sc1
    buffer_load_dwordx4 v[154:157], v1, s[20:23], s31 offen offset:2048 sc1
    buffer_load_dwordx4 v[158:161], v1, s[20:23], s31 offen offset:3072 sc1
    buffer_load_dwordx4 v[162:165], v30, s[20:23], s31 offen sc1
    s_waitcnt vmcnt(30)
    v_mfma_f32_16x16x32_bf16 v[50:53], v[182:185], v[166:169], v[50:53]
    v_mfma_f32_16x16x32_bf16 v[70:73], v[182:185], v[170:173], v[70:73]
    v_mfma_f32_16x16x32_bf16 v[90:93], v[182:185], v[174:177], v[90:93]
    v_mfma_f32_16x16x32_bf16 v[110:113], v[182:185], v[178:181], v[110:113]
    s_waitcnt vmcnt(29)
    v_mfma_f32_16x16x32_bf16 v[114:117], v[186:189], v[178:181], v[114:117]
    v_mfma_f32_16x16x32_bf16 v[94:97], v[186:189], v[174:177], v[94:97]
    v_mfma_f32_16x16x32_bf16 v[74:77], v[186:189], v[170:173], v[74:77]
    v_mfma_f32_16x16x32_bf16 v[54:57], v[186:189], v[166:169], v[54:57]
    s_waitcnt vmcnt(28)
    v_mfma_f32_16x16x32_bf16 v[58:61], v[190:193], v[166:169], v[58:61]
    v_mfma_f32_16x16x32_bf16 v[78:81], v[190:193], v[170:173], v[78:81]
    v_mfma_f32_16x16x32_bf16 v[98:101], v[190:193], v[174:177], v[98:101]
    v_mfma_f32_16x16x32_bf16 v[118:121], v[190:193], v[178:181], v[118:121]
    s_waitcnt vmcnt(27)
    v_mfma_f32_16x16x32_bf16 v[122:125], v[194:197], v[178:181], v[122:125]
    v_mfma_f32_16x16x32_bf16 v[102:105], v[194:197], v[174:177], v[102:105]
    v_mfma_f32_16x16x32_bf16 v[82:85], v[194:197], v[170:173], v[82:85]
    v_mfma_f32_16x16x32_bf16 v[62:65], v[194:197], v[166:169], v[62:65]
    s_waitcnt vmcnt(26)
    v_mfma_f32_16x16x32_bf16 v[66:69], v[198:201], v[166:169], v[66:69]
    v_mfma_f32_16x16x32_bf16 v[86:89], v[198:201], v[170:173], v[86:89]
    v_mfma_f32_16x16x32_bf16 v[106:109], v[198:201], v[174:177], v[106:109]
    v_mfma_f32_16x16x32_bf16 v[126:129], v[198:201], v[178:181], v[126:129]
    s_add_u32 s30, s47, 7168
    s_add_u32 s31, s48, 35840
    buffer_load_dwordx4 v[166:169], v26, s[20:23], s30 offen sc1
    buffer_load_dwordx4 v[170:173], v27, s[20:23], s30 offen sc1
    buffer_load_dwordx4 v[174:177], v28, s[20:23], s30 offen sc1
    buffer_load_dwordx4 v[178:181], v29, s[20:23], s30 offen sc1
    buffer_load_dwordx4 v[182:185], v1, s[20:23], s31 offen offset:0 sc1
    buffer_load_dwordx4 v[186:189], v1, s[20:23], s31 offen offset:1024 sc1
    buffer_load_dwordx4 v[190:193], v1, s[20:23], s31 offen offset:2048 sc1
    buffer_load_dwordx4 v[194:197], v1, s[20:23], s31 offen offset:3072 sc1
    buffer_load_dwordx4 v[198:201], v30, s[20:23], s31 offen sc1
    s_setprio 2
    s_waitcnt vmcnt(28)
    s_barrier
    s_add_u32 m0, s43, 4096
    s_add_u32 s30, s40, 49152
    buffer_load_dwordx4 v1, s[20:23], s30 offen sc1 lds
    s_add_u32 m0, s43, 18432
    s_add_u32 s30, s40, 53248
    buffer_load_dwordx4 v1, s[20:23], s30 offen sc1 lds
    s_add_u32 m0, s44, 4096
    s_add_u32 s30, s41, 24576
    buffer_load_dwordx4 v1, s[20:23], s30 offen sc1 lds
    s_mov_b64 exec, s[36:37]
    s_add_u32 m0, s45, 4096
    s_add_u32 s30, s42, 61440
    buffer_load_dwordx4 v4, s[20:23], s30 offen sc1 lds
    s_add_u32 m0, s45, 5120
    s_add_u32 s30, s42, 62080
    buffer_load_dwordx4 v4, s[20:23], s30 offen sc1 lds
    s_add_u32 m0, s45, 18432
    s_add_u32 s30, s42, 66560
    buffer_load_dwordx4 v4, s[20:23], s30 offen sc1 lds
    s_add_u32 m0, s45, 19456
    s_add_u32 s30, s42, 67200
    buffer_load_dwordx4 v4, s[20:23], s30 offen sc1 lds
    s_mov_b64 exec, -1
    v_add_u32 v32, s101, v1
    v_min_u32 v33, 912, v1
    v_add_u32 v33, 26227584, v33
    v_cmp_gt_u32 vcc, 8, v0
    s_nop 1
    v_cndmask_b32 v32, v33, v32, vcc
    buffer_load_dwordx4 v[36:39], v32, s[20:23], 0 offen sc1
    s_setprio 0
    s_waitcnt vmcnt(30)
    v_mfma_f32_16x16x32_bf16 v[50:53], v[218:221], v[202:205], v[50:53]
    v_mfma_f32_16x16x32_bf16 v[70:73], v[218:221], v[206:209], v[70:73]
    v_mfma_f32_16x16x32_bf16 v[90:93], v[218:221], v[210:213], v[90:93]
    v_mfma_f32_16x16x32_bf16 v[110:113], v[218:221], v[214:217], v[110:113]
    s_waitcnt vmcnt(29)
    v_mfma_f32_16x16x32_bf16 v[114:117], v[222:225], v[214:217], v[114:117]
    v_mfma_f32_16x16x32_bf16 v[94:97], v[222:225], v[210:213], v[94:97]
    v_mfma_f32_16x16x32_bf16 v[74:77], v[222:225], v[206:209], v[74:77]
    v_mfma_f32_16x16x32_bf16 v[54:57], v[222:225], v[202:205], v[54:57]
    s_waitcnt vmcnt(28)
    v_mfma_f32_16x16x32_bf16 v[58:61], v[226:229], v[202:205], v[58:61]
    v_mfma_f32_16x16x32_bf16 v[78:81], v[226:229], v[206:209], v[78:81]
    v_mfma_f32_16x16x32_bf16 v[98:101], v[226:229], v[210:213], v[98:101]
    v_mfma_f32_16x16x32_bf16 v[118:121], v[226:229], v[214:217], v[118:121]
    s_waitcnt vmcnt(27)
    v_mfma_f32_16x16x32_bf16 v[122:125], v[230:233], v[214:217], v[122:125]
    v_mfma_f32_16x16x32_bf16 v[102:105], v[230:233], v[210:213], v[102:105]
    v_mfma_f32_16x16x32_bf16 v[82:85], v[230:233], v[206:209], v[82:85]
    v_mfma_f32_16x16x32_bf16 v[62:65], v[230:233], v[202:205], v[62:65]
    s_waitcnt vmcnt(26)
    v_mfma_f32_16x16x32_bf16 v[66:69], v[234:237], v[202:205], v[66:69]
    v_mfma_f32_16x16x32_bf16 v[86:89], v[234:237], v[206:209], v[86:89]
    v_mfma_f32_16x16x32_bf16 v[106:109], v[234:237], v[210:213], v[106:109]
    v_mfma_f32_16x16x32_bf16 v[126:129], v[234:237], v[214:217], v[126:129]
    s_add_u32 s30, s47, 8192
    s_add_u32 s31, s48, 40960
    buffer_load_dwordx4 v[202:205], v26, s[20:23], s30 offen sc1
    buffer_load_dwordx4 v[206:209], v27, s[20:23], s30 offen sc1
    buffer_load_dwordx4 v[210:213], v28, s[20:23], s30 offen sc1
    buffer_load_dwordx4 v[214:217], v29, s[20:23], s30 offen sc1
    buffer_load_dwordx4 v[218:221], v1, s[20:23], s31 offen offset:0 sc1
    buffer_load_dwordx4 v[222:225], v1, s[20:23], s31 offen offset:1024 sc1
    buffer_load_dwordx4 v[226:229], v1, s[20:23], s31 offen offset:2048 sc1
    buffer_load_dwordx4 v[230:233], v1, s[20:23], s31 offen offset:3072 sc1
    buffer_load_dwordx4 v[234:237], v30, s[20:23], s31 offen sc1
    s_waitcnt vmcnt(30)
    v_mfma_f32_16x16x32_bf16 v[50:53], v[146:149], v[130:133], v[50:53]
    v_mfma_f32_16x16x32_bf16 v[70:73], v[146:149], v[134:137], v[70:73]
    v_mfma_f32_16x16x32_bf16 v[90:93], v[146:149], v[138:141], v[90:93]
    v_mfma_f32_16x16x32_bf16 v[110:113], v[146:149], v[142:145], v[110:113]
    s_waitcnt vmcnt(29)
    v_mfma_f32_16x16x32_bf16 v[114:117], v[150:153], v[142:145], v[114:117]
    v_mfma_f32_16x16x32_bf16 v[94:97], v[150:153], v[138:141], v[94:97]
    v_mfma_f32_16x16x32_bf16 v[74:77], v[150:153], v[134:137], v[74:77]
    v_mfma_f32_16x16x32_bf16 v[54:57], v[150:153], v[130:133], v[54:57]
    s_waitcnt vmcnt(28)
    v_mfma_f32_16x16x32_bf16 v[58:61], v[154:157], v[130:133], v[58:61]
    v_mfma_f32_16x16x32_bf16 v[78:81], v[154:157], v[134:137], v[78:81]
    v_mfma_f32_16x16x32_bf16 v[98:101], v[154:157], v[138:141], v[98:101]
    v_mfma_f32_16x16x32_bf16 v[118:121], v[154:157], v[142:145], v[118:121]
    s_waitcnt vmcnt(27)
    v_mfma_f32_16x16x32_bf16 v[122:125], v[158:161], v[142:145], v[122:125]
    v_mfma_f32_16x16x32_bf16 v[102:105], v[158:161], v[138:141], v[102:105]
    v_mfma_f32_16x16x32_bf16 v[82:85], v[158:161], v[134:137], v[82:85]
    v_mfma_f32_16x16x32_bf16 v[62:65], v[158:161], v[130:133], v[62:65]
    s_waitcnt vmcnt(26)
    v_mfma_f32_16x16x32_bf16 v[66:69], v[162:165], v[130:133], v[66:69]
    v_mfma_f32_16x16x32_bf16 v[86:89], v[162:165], v[134:137], v[86:89]
    v_mfma_f32_16x16x32_bf16 v[106:109], v[162:165], v[138:141], v[106:109]
    v_mfma_f32_16x16x32_bf16 v[126:129], v[162:165], v[142:145], v[126:129]
    s_add_u32 s30, s47, 9216
    s_add_u32 s31, s48, 46080
    buffer_load_dwordx4 v[130:133], v26, s[20:23], s30 offen sc1
    buffer_load_dwordx4 v[134:137], v27, s[20:23], s30 offen sc1
    buffer_load_dwordx4 v[138:141], v28, s[20:23], s30 offen sc1
    buffer_load_dwordx4 v[142:145], v29, s[20:23], s30 offen sc1
    buffer_load_dwordx4 v[146:149], v1, s[20:23], s31 offen offset:0 sc1
    buffer_load_dwordx4 v[150:153], v1, s[20:23], s31 offen offset:1024 sc1
    buffer_load_dwordx4 v[154:157], v1, s[20:23], s31 offen offset:2048 sc1
    buffer_load_dwordx4 v[158:161], v1, s[20:23], s31 offen offset:3072 sc1
    buffer_load_dwordx4 v[162:165], v30, s[20:23], s31 offen sc1
    s_setprio 2
    s_waitcnt vmcnt(18)
    v_xor_b32 v36, s61, v36
    v_xor_b32 v37, s61, v37
    v_xor_b32 v38, s61, v38
    v_xor_b32 v39, s61, v39
    v_or3_b32 v36, v36, v37, v38
    v_or_b32 v36, v36, v39
    v_cmp_ne_u32 vcc, 0, v36
    s_cbranch_vccz P2_ARM_33
    s_mov_b32 s63, 30000
POLL_34:
    buffer_load_dwordx4 v[36:39], v32, s[20:23], 0 offen sc1
    s_waitcnt vmcnt(0)
    v_xor_b32 v36, s61, v36
    v_xor_b32 v37, s61, v37
    v_xor_b32 v38, s61, v38
    v_xor_b32 v39, s61, v39
    v_or3_b32 v36, v36, v37, v38
    v_or_b32 v36, v36, v39
    v_cmp_ne_u32 vcc, 0, v36
    s_cbranch_vccz POLLED_35
    s_sleep 8
    s_sub_u32 s63, s63, 1
    s_cmp_lg_u32 s63, 0
    s_cbranch_scc1 POLL_34
POLLED_35:
P2_ARM_33:
    s_mul_i32 s32, s19, 5120
    s_mul_i32 s33, s19, 1024
    s_add_u32 s33, s33, s49
    s_add_u32 m0, s32, 61440
    s_add_u32 s30, s33, 0
    buffer_load_dwordx4 v1, s[20:23], s30 offen sc1 lds
    s_add_u32 m0, s32, 62464
    s_add_u32 s30, s33, 20480
    buffer_load_dwordx4 v1, s[20:23], s30 offen sc1 lds
    s_add_u32 m0, s32, 63488
    s_add_u32 s30, s33, 40960
    buffer_load_dwordx4 v1, s[20:23], s30 offen sc1 lds
    s_add_u32 m0, s32, 64512
    s_add_u32 s30, s33, 61440
    buffer_load_dwordx4 v1, s[20:23], s30 offen sc1 lds
    s_add_u32 m0, s32, 65536
    s_add_u32 s30, s33, 81920
    buffer_load_dwordx4 v1, s[20:23], s30 offen sc1 lds
    s_barrier
    s_add_u32 m0, s43, 32768
    s_add_u32 s30, s40, 57344
    buffer_load_dwordx4 v1, s[20:23], s30 offen sc1 lds
    s_add_u32 m0, s43, 47104
    s_add_u32 s30, s40, 61440
    buffer_load_dwordx4 v1, s[20:23], s30 offen sc1 lds
    s_add_u32 m0, s44, 32768
    s_add_u32 s30, s41, 28672
    buffer_load_dwordx4 v1, s[20:23], s30 offen sc1 lds
    s_mov_b64 exec, s[36:37]
    s_add_u32 m0, s45, 32768
    s_add_u32 s30, s42, 71680
    buffer_load_dwordx4 v4, s[20:23], s30 offen sc1 lds
    s_add_u32 m0, s45, 33792
    s_add_u32 s30, s42, 72320
    buffer_load_dwordx4 v4, s[20:23], s30 offen sc1 lds
    s_add_u32 m0, s45, 47104
    s_add_u32 s30, s42, 76800
    buffer_load_dwordx4 v4, s[20:23], s30 offen sc1 lds
    s_add_u32 m0, s45, 48128
    s_add_u32 s30, s42, 77440
    buffer_load_dwordx4 v4, s[20:23], s30 offen sc1 lds
    s_mov_b64 exec, -1
    s_setprio 0
    v_mfma_f32_16x16x32_bf16 v[50:53], v[182:185], v[166:169], v[50:53]
    v_mfma_f32_16x16x32_bf16 v[70:73], v[182:185], v[170:173], v[70:73]
    v_mfma_f32_16x16x32_bf16 v[90:93], v[182:185], v[174:177], v[90:93]
    v_mfma_f32_16x16x32_bf16 v[110:113], v[182:185], v[178:181], v[110:113]
    v_mfma_f32_16x16x32_bf16 v[114:117], v[186:189], v[178:181], v[114:117]
    v_mfma_f32_16x16x32_bf16 v[94:97], v[186:189], v[174:177], v[94:97]
    v_mfma_f32_16x16x32_bf16 v[74:77], v[186:189], v[170:173], v[74:77]
    v_mfma_f32_16x16x32_bf16 v[54:57], v[186:189], v[166:169], v[54:57]
    v_mfma_f32_16x16x32_bf16 v[58:61], v[190:193], v[166:169], v[58:61]
    v_mfma_f32_16x16x32_bf16 v[78:81], v[190:193], v[170:173], v[78:81]
    v_mfma_f32_16x16x32_bf16 v[98:101], v[190:193], v[174:177], v[98:101]
    v_mfma_f32_16x16x32_bf16 v[118:121], v[190:193], v[178:181], v[118:121]
    v_mfma_f32_16x16x32_bf16 v[122:125], v[194:197], v[178:181], v[122:125]
    v_mfma_f32_16x16x32_bf16 v[102:105], v[194:197], v[174:177], v[102:105]
    v_mfma_f32_16x16x32_bf16 v[82:85], v[194:197], v[170:173], v[82:85]
    v_mfma_f32_16x16x32_bf16 v[62:65], v[194:197], v[166:169], v[62:65]
    v_mfma_f32_16x16x32_bf16 v[66:69], v[198:201], v[166:169], v[66:69]
    v_mfma_f32_16x16x32_bf16 v[86:89], v[198:201], v[170:173], v[86:89]
    v_mfma_f32_16x16x32_bf16 v[106:109], v[198:201], v[174:177], v[106:109]
    v_mfma_f32_16x16x32_bf16 v[126:129], v[198:201], v[178:181], v[126:129]
    s_add_u32 s30, s47, 10240
    s_add_u32 s31, s48, 51200
    buffer_load_dwordx4 v[166:169], v26, s[20:23], s30 offen sc1
    buffer_load_dwordx4 v[170:173], v27, s[20:23], s30 offen sc1
    buffer_load_dwordx4 v[174:177], v28, s[20:23], s30 offen sc1
    buffer_load_dwordx4 v[178:181], v29, s[20:23], s30 offen sc1
    buffer_load_dwordx4 v[182:185], v1, s[20:23], s31 offen offset:0 sc1
    buffer_load_dwordx4 v[186:189], v1, s[20:23], s31 offen offset:1024 sc1
    buffer_load_dwordx4 v[190:193], v1, s[20:23], s31 offen offset:2048 sc1
    buffer_load_dwordx4 v[194:197], v1, s[20:23], s31 offen offset:3072 sc1
    buffer_load_dwordx4 v[198:201], v30, s[20:23], s31 offen sc1
    s_waitcnt vmcnt(34)
    v_mfma_f32_16x16x32_bf16 v[50:53], v[218:221], v[202:205], v[50:53]
    v_mfma_f32_16x16x32_bf16 v[70:73], v[218:221], v[206:209], v[70:73]
    v_mfma_f32_16x16x32_bf16 v[90:93], v[218:221], v[210:213], v[90:93]
    v_mfma_f32_16x16x32_bf16 v[110:113], v[218:221], v[214:217], v[110:113]
    s_waitcnt vmcnt(33)
    v_mfma_f32_16x16x32_bf16 v[114:117], v[222:225], v[214:217], v[114:117]
    v_mfma_f32_16x16x32_bf16 v[94:97], v[222:225], v[210:213], v[94:97]
    v_mfma_f32_16x16x32_bf16 v[74:77], v[222:225], v[206:209], v[74:77]
    v_mfma_f32_16x16x32_bf16 v[54:57], v[222:225], v[202:205], v[54:57]
    s_waitcnt vmcnt(32)
    v_mfma_f32_16x16x32_bf16 v[58:61], v[226:229], v[202:205], v[58:61]
    v_mfma_f32_16x16x32_bf16 v[78:81], v[226:229], v[206:209], v[78:81]
    v_mfma_f32_16x16x32_bf16 v[98:101], v[226:229], v[210:213], v[98:101]
    v_mfma_f32_16x16x32_bf16 v[118:121], v[226:229], v[214:217], v[118:121]
    s_waitcnt vmcnt(31)
    v_mfma_f32_16x16x32_bf16 v[122:125], v[230:233], v[214:217], v[122:125]
    v_mfma_f32_16x16x32_bf16 v[102:105], v[230:233], v[210:213], v[102:105]
    v_mfma_f32_16x16x32_bf16 v[82:85], v[230:233], v[206:209], v[82:85]
    v_mfma_f32_16x16x32_bf16 v[62:65], v[230:233], v[202:205], v[62:65]
    s_waitcnt vmcnt(30)
    v_mfma_f32_16x16x32_bf16 v[66:69], v[234:237], v[202:205], v[66:69]
    v_mfma_f32_16x16x32_bf16 v[86:89], v[234:237], v[206:209], v[86:89]
    v_mfma_f32_16x16x32_bf16 v[106:109], v[234:237], v[210:213], v[106:109]
    v_mfma_f32_16x16x32_bf16 v[126:129], v[234:237], v[214:217], v[126:129]
    s_add_u32 s30, s47, 11264
    s_add_u32 s31, s48, 56320
    buffer_load_dwordx4 v[202:205], v26, s[20:23], s30 offen sc1
    buffer_load_dwordx4 v[206:209], v27, s[20:23], s30 offen sc1
    buffer_load_dwordx4 v[210:213], v28, s[20:23], s30 offen sc1
    buffer_load_dwordx4 v[214:217], v29, s[20:23], s30 offen sc1
    buffer_load_dwordx4 v[218:221], v1, s[20:23], s31 offen offset:0 sc1
    buffer_load_dwordx4 v[222:225], v1, s[20:23], s31 offen offset:1024 sc1
    buffer_load_dwordx4 v[226:229], v1, s[20:23], s31 offen offset:2048 sc1
    buffer_load_dwordx4 v[230:233], v1, s[20:23], s31 offen offset:3072 sc1
    buffer_load_dwordx4 v[234:237], v30, s[20:23], s31 offen sc1
    s_setprio 2
    s_mul_i32 s32, s19, 5120
    s_mul_i32 s33, s19, 1024
    s_add_u32 s33, s33, s49
    s_add_u32 m0, s32, 81920
    s_add_u32 s30, s33, 4096
    buffer_load_dwordx4 v1, s[20:23], s30 offen sc1 lds
    s_add_u32 m0, s32, 82944
    s_add_u32 s30, s33, 24576
    buffer_load_dwordx4 v1, s[20:23], s30 offen sc1 lds
    s_add_u32 m0, s32, 83968
    s_add_u32 s30, s33, 45056
    buffer_load_dwordx4 v1, s[20:23], s30 offen sc1 lds
    s_add_u32 m0, s32, 84992
    s_add_u32 s30, s33, 65536
    buffer_load_dwordx4 v1, s[20:23], s30 offen sc1 lds
    s_add_u32 m0, s32, 86016
    s_add_u32 s30, s33, 86016
    buffer_load_dwordx4 v1, s[20:23], s30 offen sc1 lds
    s_mul_i32 s32, s19, 5120
    s_mul_i32 s33, s19, 1024
    s_add_u32 s33, s33, s49
    s_add_u32 m0, s32, 102400
    s_add_u32 s30, s33, 8192
    buffer_load_dwordx4 v1, s[20:23], s30 offen sc1 lds
    s_add_u32 m0, s32, 103424
    s_add_u32 s30, s33, 28672
    buffer_load_dwordx4 v1, s[20:23], s30 offen sc1 lds
    s_add_u32 m0, s32, 104448
    s_add_u32 s30, s33, 49152
    buffer_load_dwordx4 v1, s[20:23], s30 offen sc1 lds
    s_add_u32 m0, s32, 105472
    s_add_u32 s30, s33, 69632
    buffer_load_dwordx4 v1, s[20:23], s30 offen sc1 lds
    s_add_u32 m0, s32, 106496
    s_add_u32 s30, s33, 90112
    buffer_load_dwordx4 v1, s[20:23], s30 offen sc1 lds
    s_waitcnt vmcnt(28)
    s_barrier
    s_setprio 0
    v_mfma_f32_16x16x32_bf16 v[50:53], v[146:149], v[130:133], v[50:53]
    v_mfma_f32_16x16x32_bf16 v[70:73], v[146:149], v[134:137], v[70:73]
    v_mfma_f32_16x16x32_bf16 v[90:93], v[146:149], v[138:141], v[90:93]
    v_mfma_f32_16x16x32_bf16 v[110:113], v[146:149], v[142:145], v[110:113]
    v_mfma_f32_16x16x32_bf16 v[114:117], v[150:153], v[142:145], v[114:117]
    v_mfma_f32_16x16x32_bf16 v[94:97], v[150:153], v[138:141], v[94:97]
    v_mfma_f32_16x16x32_bf16 v[74:77], v[150:153], v[134:137], v[74:77]
    v_mfma_f32_16x16x32_bf16 v[54:57], v[150:153], v[130:133], v[54:57]
    v_mfma_f32_16x16x32_bf16 v[58:61], v[154:157], v[130:133], v[58:61]
    v_mfma_f32_16x16x32_bf16 v[78:81], v[154:157], v[134:137], v[78:81]
    v_mfma_f32_16x16x32_bf16 v[98:101], v[154:157], v[138:141], v[98:101]
    v_mfma_f32_16x16x32_bf16 v[118:121], v[154:157], v[142:145], v[118:121]
    v_mfma_f32_16x16x32_bf16 v[122:125], v[158:161], v[142:145], v[122:125]
    v_mfma_f32_16x16x32_bf16 v[102:105], v[158:161], v[138:141], v[102:105]
    v_mfma_f32_16x16x32_bf16 v[82:85], v[158:161], v[134:137], v[82:85]
    v_mfma_f32_16x16x32_bf16 v[62:65], v[158:161], v[130:133], v[62:65]
    v_mfma_f32_16x16x32_bf16 v[66:69], v[162:165], v[130:133], v[66:69]
    v_mfma_f32_16x16x32_bf16 v[86:89], v[162:165], v[134:137], v[86:89]
    v_mfma_f32_16x16x32_bf16 v[106:109], v[162:165], v[138:141], v[106:109]
    v_mfma_f32_16x16x32_bf16 v[126:129], v[162:165], v[142:145], v[126:129]
    s_add_u32 s30, s47, 12288
    s_add_u32 s31, s48, 61440
    buffer_load_dwordx4 v[130:133], v26, s[20:23], s30 offen sc1
    buffer_load_dwordx4 v[134:137], v27, s[20:23], s30 offen sc1
    buffer_load_dwordx4 v[138:141], v28, s[20:23], s30 offen sc1
    buffer_load_dwordx4 v[142:145], v29, s[20:23], s30 offen sc1
    buffer_load_dwordx4 v[146:149], v1, s[20:23], s31 offen offset:0 sc1
    buffer_load_dwordx4 v[150:153], v1, s[20:23], s31 offen offset:1024 sc1
    buffer_load_dwordx4 v[154:157], v1, s[20:23], s31 offen offset:2048 sc1
    buffer_load_dwordx4 v[158:161], v1, s[20:23], s31 offen offset:3072 sc1
    buffer_load_dwordx4 v[162:165], v30, s[20:23], s31 offen sc1
    s_waitcnt vmcnt(32)
    v_mfma_f32_16x16x32_bf16 v[50:53], v[182:185], v[166:169], v[50:53]
    v_mfma_f32_16x16x32_bf16 v[70:73], v[182:185], v[170:173], v[70:73]
    v_mfma_f32_16x16x32_bf16 v[90:93], v[182:185], v[174:177], v[90:93]
    v_mfma_f32_16x16x32_bf16 v[110:113], v[182:185], v[178:181], v[110:113]
    s_waitcnt vmcnt(31)
    v_mfma_f32_16x16x32_bf16 v[114:117], v[186:189], v[178:181], v[114:117]
    v_mfma_f32_16x16x32_bf16 v[94:97], v[186:189], v[174:177], v[94:97]
    v_mfma_f32_16x16x32_bf16 v[74:77], v[186:189], v[170:173], v[74:77]
    v_mfma_f32_16x16x32_bf16 v[54:57], v[186:189], v[166:169], v[54:57]
    s_waitcnt vmcnt(30)
    v_mfma_f32_16x16x32_bf16 v[58:61], v[190:193], v[166:169], v[58:61]
    v_mfma_f32_16x16x32_bf16 v[78:81], v[190:193], v[170:173], v[78:81]
    v_mfma_f32_16x16x32_bf16 v[98:101], v[190:193], v[174:177], v[98:101]
    v_mfma_f32_16x16x32_bf16 v[118:121], v[190:193], v[178:181], v[118:121]
    s_waitcnt vmcnt(29)
    v_mfma_f32_16x16x32_bf16 v[122:125], v[194:197], v[178:181], v[122:125]
    v_mfma_f32_16x16x32_bf16 v[102:105], v[194:197], v[174:177], v[102:105]
    v_mfma_f32_16x16x32_bf16 v[82:85], v[194:197], v[170:173], v[82:85]
    v_mfma_f32_16x16x32_bf16 v[62:65], v[194:197], v[166:169], v[62:65]
    s_waitcnt vmcnt(28)
    v_mfma_f32_16x16x32_bf16 v[66:69], v[198:201], v[166:169], v[66:69]
    v_mfma_f32_16x16x32_bf16 v[86:89], v[198:201], v[170:173], v[86:89]
    v_mfma_f32_16x16x32_bf16 v[106:109], v[198:201], v[174:177], v[106:109]
    v_mfma_f32_16x16x32_bf16 v[126:129], v[198:201], v[178:181], v[126:129]
    s_add_u32 s30, s47, 13312
    s_add_u32 s31, s48, 66560
    s_cmp_ge_u32 s19, 2
    s_cselect_b32 s30, 0x2000000, s30
    s_cselect_b32 s31, 0x2000000, s31
    buffer_load_dwordx4 v[166:169], v26, s[20:23], s30 offen sc1
    buffer_load_dwordx4 v[170:173], v27, s[20:23], s30 offen sc1
    buffer_load_dwordx4 v[174:177], v28, s[20:23], s30 offen sc1
    buffer_load_dwordx4 v[178:181], v29, s[20:23], s30 offen sc1
    buffer_load_dwordx4 v[182:185], v1, s[20:23], s31 offen offset:0 sc1
    buffer_load_dwordx4 v[186:189], v1, s[20:23], s31 offen offset:1024 sc1
    buffer_load_dwordx4 v[190:193], v1, s[20:23], s31 offen offset:2048 sc1
    buffer_load_dwordx4 v[194:197], v1, s[20:23], s31 offen offset:3072 sc1
    buffer_load_dwordx4 v[198:201], v30, s[20:23], s31 offen sc1
    s_setprio 2
    s_mul_i32 s32, s19, 5120
    s_mul_i32 s33, s19, 1024
    s_add_u32 s33, s33, s49
    s_add_u32 m0, s32, 122880
    s_add_u32 s30, s33, 12288
    buffer_load_dwordx4 v1, s[20:23], s30 offen sc1 lds
    s_add_u32 m0, s32, 123904
    s_add_u32 s30, s33, 32768
    buffer_load_dwordx4 v1, s[20:23], s30 offen sc1 lds
    s_add_u32 m0, s32, 124928
    s_add_u32 s30, s33, 53248
    buffer_load_dwordx4 v1, s[20:23], s30 offen sc1 lds
    s_add_u32 m0, s32, 125952
    s_add_u32 s30, s33, 73728
    buffer_load_dwordx4 v1, s[20:23], s30 offen sc1 lds
    s_add_u32 m0, s32, 126976
    s_add_u32 s30, s33, 94208
    buffer_load_dwordx4 v1, s[20:23], s30 offen sc1 lds
    s_mul_i32 s32, s19, 5120
    s_mul_i32 s33, s19, 1024
    s_add_u32 s33, s33, s49
    s_add_u32 m0, s32, 143360
    s_add_u32 s30, s33, 16384
    buffer_load_dwordx4 v1, s[20:23], s30 offen sc1 lds
    s_add_u32 m0, s32, 144384
    s_add_u32 s30, s33, 36864
    buffer_load_dwordx4 v1, s[20:23], s30 offen sc1 lds
    s_add_u32 m0, s32, 145408
    s_add_u32 s30, s33, 57344
    buffer_load_dwordx4 v1, s[20:23], s30 offen sc1 lds
    s_add_u32 m0, s32, 146432
    s_add_u32 s30, s33, 77824
    buffer_load_dwordx4 v1, s[20:23], s30 offen sc1 lds
    s_add_u32 m0, s32, 147456
    s_add_u32 s30, s33, 98304
    buffer_load_dwordx4 v1, s[20:23], s30 offen sc1 lds
    s_xor_b32 s30, s19, 0
    s_mul_i32 s32, s30, 15360
    s_xor_b32 s30, s19, 1
    s_mul_i32 s33, s30, 15360
    s_xor_b32 s30, s19, 2
    s_mul_i32 s34, s30, 15360
    s_xor_b32 s30, s19, 3
    s_mul_i32 s35, s30, 15360
    s_mov_b32 s30, 0xffff0000
    s_waitcnt vmcnt(0)
    s_setprio 0
    s_barrier
    v_mfma_f32_16x16x32_bf16 v[70:73], v[218:221], v[206:209], v[70:73]
    v_add_u32 v32, s32, v1
    v_mfma_f32_16x16x32_bf16 v[90:93], v[218:221], v[210:213], v[90:93]
    v_add_u32 v33, s33, v1
    v_mfma_f32_16x16x32_bf16 v[110:113], v[218:221], v[214:217], v[110:113]
    v_add_u32 v34, s34, v1
    v_mfma_f32_16x16x32_bf16 v[50:53], v[218:221], v[202:205], v[50:53]
    v_add_u32 v35, s35, v1
    v_mfma_f32_16x16x32_bf16 v[70:73], v[146:149], v[134:137], v[70:73]
    v_lshlrev_b32 v6, 16, v40
    v_mfma_f32_16x16x32_bf16 v[90:93], v[146:149], v[138:141], v[90:93]
    v_and_b32 v7, s30, v40
    v_mfma_f32_16x16x32_bf16 v[110:113], v[146:149], v[142:145], v[110:113]
    v_lshlrev_b32 v8, 16, v41
    v_mfma_f32_16x16x32_bf16 v[50:53], v[146:149], v[130:133], v[50:53]
    v_and_b32 v9, s30, v41
    v_mfma_f32_16x16x32_bf16 v[70:73], v[182:185], v[170:173], v[70:73]
    v_mfma_f32_16x16x32_bf16 v[90:93], v[182:185], v[174:177], v[90:93]
    v_mfma_f32_16x16x32_bf16 v[110:113], v[182:185], v[178:181], v[110:113]
    v_mfma_f32_16x16x32_bf16 v[50:53], v[182:185], v[166:169], v[50:53]
    v_mfma_f32_16x16x32_bf16 v[74:77], v[222:225], v[206:209], v[74:77]
    v_lshlrev_b32 v10, 16, v42
    v_mfma_f32_16x16x32_bf16 v[94:97], v[222:225], v[210:213], v[94:97]
    v_and_b32 v11, s30, v42
    v_mfma_f32_16x16x32_bf16 v[114:117], v[222:225], v[214:217], v[114:117]
    v_lshlrev_b32 v12, 16, v43
    v_mfma_f32_16x16x32_bf16 v[54:57], v[222:225], v[202:205], v[54:57]
    v_and_b32 v13, s30, v43
    v_mfma_f32_16x16x32_bf16 v[74:77], v[150:153], v[134:137], v[74:77]
    ds_write_b128 v33, v[70:73] offset:0
    v_mfma_f32_16x16x32_bf16 v[94:97], v[150:153], v[138:141], v[94:97]
    ds_write_b128 v34, v[90:93] offset:5120
    v_mfma_f32_16x16x32_bf16 v[114:117], v[150:153], v[142:145], v[114:117]
    ds_write_b128 v35, v[110:113] offset:10240
    v_mfma_f32_16x16x32_bf16 v[54:57], v[150:153], v[130:133], v[54:57]
    v_add_f32 v6, v6, v50
    v_mfma_f32_16x16x32_bf16 v[74:77], v[186:189], v[170:173], v[74:77]
    v_add_f32 v7, v7, v51
    v_mfma_f32_16x16x32_bf16 v[94:97], v[186:189], v[174:177], v[94:97]
    v_add_f32 v8, v8, v52
    v_mfma_f32_16x16x32_bf16 v[114:117], v[186:189], v[178:181], v[114:117]
    v_add_f32 v9, v9, v53
    v_mfma_f32_16x16x32_bf16 v[54:57], v[186:189], v[166:169], v[54:57]
    v_mfma_f32_16x16x32_bf16 v[78:81], v[226:229], v[206:209], v[78:81]
    v_lshlrev_b32 v14, 16, v44
    v_mfma_f32_16x16x32_bf16 v[98:101], v[226:229], v[210:213], v[98:101]
    v_and_b32 v15, s30, v44
    v_mfma_f32_16x16x32_bf16 v[118:121], v[226:229], v[214:217], v[118:121]
    v_lshlrev_b32 v16, 16, v45
    v_mfma_f32_16x16x32_bf16 v[58:61], v[226:229], v[202:205], v[58:61]
    v_and_b32 v17, s30, v45
    v_mfma_f32_16x16x32_bf16 v[78:81], v[154:157], v[134:137], v[78:81]
    ds_write_b128 v33, v[74:77] offset:1024
    v_mfma_f32_16x16x32_bf16 v[98:101], v[154:157], v[138:141], v[98:101]
    ds_write_b128 v34, v[94:97] offset:6144
    v_mfma_f32_16x16x32_bf16 v[118:121], v[154:157], v[142:145], v[118:121]
    ds_write_b128 v35, v[114:117] offset:11264
    v_mfma_f32_16x16x32_bf16 v[58:61], v[154:157], v[130:133], v[58:61]
    v_add_f32 v10, v10, v54
    v_mfma_f32_16x16x32_bf16 v[78:81], v[190:193], v[170:173], v[78:81]
    v_add_f32 v11, v11, v55
    v_mfma_f32_16x16x32_bf16 v[98:101], v[190:193], v[174:177], v[98:101]
    v_add_f32 v12, v12, v56
    v_mfma_f32_16x16x32_bf16 v[118:121], v[190:193], v[178:181], v[118:121]
    v_add_f32 v13, v13, v57
    v_mfma_f32_16x16x32_bf16 v[58:61], v[190:193], v[166:169], v[58:61]
    v_mfma_f32_16x16x32_bf16 v[82:85], v[230:233], v[206:209], v[82:85]
    v_lshlrev_b32 v18, 16, v46
    v_mfma_f32_16x16x32_bf16 v[102:105], v[230:233], v[210:213], v[102:105]
    v_and_b32 v19, s30, v46
    v_mfma_f32_16x16x32_bf16 v[122:125], v[230:233], v[214:217], v[122:125]
    v_lshlrev_b32 v20, 16, v47
    v_mfma_f32_16x16x32_bf16 v[62:65], v[230:233], v[202:205], v[62:65]
    v_and_b32 v21, s30, v47
    v_mfma_f32_16x16x32_bf16 v[82:85], v[158:161], v[134:137], v[82:85]
    ds_write_b128 v33, v[78:81] offset:2048
    v_mfma_f32_16x16x32_bf16 v[102:105], v[158:161], v[138:141], v[102:105]
    ds_write_b128 v34, v[98:101] offset:7168
    v_mfma_f32_16x16x32_bf16 v[122:125], v[158:161], v[142:145], v[122:125]
    ds_write_b128 v35, v[118:121] offset:12288
    v_mfma_f32_16x16x32_bf16 v[62:65], v[158:161], v[130:133], v[62:65]
    v_add_f32 v14, v14, v58
    v_mfma_f32_16x16x32_bf16 v[82:85], v[194:197], v[170:173], v[82:85]
    v_add_f32 v15, v15, v59
    v_mfma_f32_16x16x32_bf16 v[102:105], v[194:197], v[174:177], v[102:105]
    v_add_f32 v16, v16, v60
    v_mfma_f32_16x16x32_bf16 v[122:125], v[194:197], v[178:181], v[122:125]
    v_add_f32 v17, v17, v61
    v_mfma_f32_16x16x32_bf16 v[62:65], v[194:197], v[166:169], v[62:65]
    v_mfma_f32_16x16x32_bf16 v[86:89], v[234:237], v[206:209], v[86:89]
    v_lshlrev_b32 v22, 16, v48
    v_mfma_f32_16x16x32_bf16 v[106:109], v[234:237], v[210:213], v[106:109]
    v_and_b32 v23, s30, v48
    v_mfma_f32_16x16x32_bf16 v[126:129], v[234:237], v[214:217], v[126:129]
    v_lshlrev_b32 v24, 16, v49
    v_mfma_f32_16x16x32_bf16 v[66:69], v[234:237], v[202:205], v[66:69]
    v_and_b32 v25, s30, v49
    v_mfma_f32_16x16x32_bf16 v[86:89], v[162:165], v[134:137], v[86:89]
    ds_write_b128 v33, v[82:85] offset:3072
    v_mfma_f32_16x16x32_bf16 v[106:109], v[162:165], v[138:141], v[106:109]
    ds_write_b128 v34, v[102:105] offset:8192
    v_mfma_f32_16x16x32_bf16 v[126:129], v[162:165], v[142:145], v[126:129]
    ds_write_b128 v35, v[122:125] offset:13312
    v_mfma_f32_16x16x32_bf16 v[66:69], v[162:165], v[130:133], v[66:69]
    v_add_f32 v18, v18, v62
    v_mfma_f32_16x16x32_bf16 v[86:89], v[198:201], v[170:173], v[86:89]
    v_add_f32 v19, v19, v63
    v_mfma_f32_16x16x32_bf16 v[106:109], v[198:201], v[174:177], v[106:109]
    v_add_f32 v20, v20, v64
    v_mfma_f32_16x16x32_bf16 v[126:129], v[198:201], v[178:181], v[126:129]
    v_add_f32 v21, v21, v65
    v_mfma_f32_16x16x32_bf16 v[66:69], v[198:201], v[166:169], v[66:69]
    s_nop 4
    ds_write_b128 v33, v[86:89] offset:4096
    ds_write_b128 v34, v[106:109] offset:9216
    ds_write_b128 v35, v[126:129] offset:14336
    v_add_f32 v22, v22, v66
    v_add_f32 v23, v23, v67
    v_add_f32 v24, v24, v68
    v_add_f32 v25, v25, v69
    s_waitcnt lgkmcnt(0)
    s_barrier
    ds_read_b128 v[130:133], v32 offset:0
    ds_read_b128 v[134:137], v32 offset:1024
    ds_read_b128 v[138:141], v32 offset:2048
    ds_read_b128 v[142:145], v32 offset:3072
    ds_read_b128 v[146:149], v32 offset:4096
    ds_read_b128 v[150:153], v32 offset:5120
    ds_read_b128 v[154:157], v32 offset:6144
    ds_read_b128 v[158:161], v32 offset:7168
    ds_read_b128 v[162:165], v32 offset:8192
    ds_read_b128 v[166:169], v32 offset:9216
    ds_read_b128 v[170:173], v32 offset:10240
    ds_read_b128 v[174:177], v32 offset:11264
    ds_read_b128 v[178:181], v32 offset:12288
    ds_read_b128 v[182:185], v32 offset:13312
    ds_read_b128 v[186:189], v32 offset:14336
    s_waitcnt lgkmcnt(10)
    v_add_f32 v6, v6, v130
    v_add_f32 v7, v7, v131
    v_add_f32 v8, v8, v132
    v_add_f32 v9, v9, v133
    v_add_f32 v10, v10, v134
    v_add_f32 v11, v11, v135
    v_add_f32 v12, v12, v136
    v_add_f32 v13, v13, v137
    v_add_f32 v14, v14, v138
    v_add_f32 v15, v15, v139
    v_add_f32 v16, v16, v140
    v_add_f32 v17, v17, v141
    v_add_f32 v18, v18, v142
    v_add_f32 v19, v19, v143
    v_add_f32 v20, v20, v144
    v_add_f32 v21, v21, v145
    v_add_f32 v22, v22, v146
    v_add_f32 v23, v23, v147
    v_add_f32 v24, v24, v148
    v_add_f32 v25, v25, v149
    s_waitcnt lgkmcnt(5)
    v_add_f32 v6, v6, v150
    v_add_f32 v7, v7, v151
    v_add_f32 v8, v8, v152
    v_add_f32 v9, v9, v153
    v_add_f32 v10, v10, v154
    v_add_f32 v11, v11, v155
    v_add_f32 v12, v12, v156
    v_add_f32 v13, v13, v157
    v_add_f32 v14, v14, v158
    v_add_f32 v15, v15, v159
    v_add_f32 v16, v16, v160
    v_add_f32 v17, v17, v161
    v_add_f32 v18, v18, v162
    v_add_f32 v19, v19, v163
    v_add_f32 v20, v20, v164
    v_add_f32 v21, v21, v165
    v_add_f32 v22, v22, v166
    v_add_f32 v23, v23, v167
    v_add_f32 v24, v24, v168
    v_add_f32 v25, v25, v169
    s_waitcnt lgkmcnt(0)
    v_add_f32 v6, v6, v170
    v_add_f32 v7, v7, v171
    v_add_f32 v8, v8, v172
    v_add_f32 v9, v9, v173
    v_add_f32 v10, v10, v174
    v_add_f32 v11, v11, v175
    v_add_f32 v12, v12, v176
    v_add_f32 v13, v13, v177
    v_add_f32 v14, v14, v178
    v_add_f32 v15, v15, v179
    v_add_f32 v16, v16, v180
    v_add_f32 v17, v17, v181
    v_add_f32 v18, v18, v182
    v_add_f32 v19, v19, v183
    v_add_f32 v20, v20, v184
    v_add_f32 v21, v21, v185
    v_add_f32 v22, v22, v186
    v_add_f32 v23, v23, v187
    v_add_f32 v24, v24, v188
    v_add_f32 v25, v25, v189
    s_mov_b32 s30, 0xbfb8aa3b
    v_mul_f32 v50, s30, v6
    v_mul_f32 v51, s30, v7
    v_mul_f32 v52, s30, v8
    v_mul_f32 v53, s30, v9
    v_mul_f32 v54, s30, v10
    v_mul_f32 v55, s30, v11
    v_mul_f32 v56, s30, v12
    v_mul_f32 v57, s30, v13
    v_mul_f32 v58, s30, v14
    v_mul_f32 v59, s30, v15
    v_mul_f32 v60, s30, v16
    v_mul_f32 v61, s30, v17
    v_mul_f32 v62, s30, v18
    v_mul_f32 v63, s30, v19
    v_mul_f32 v64, s30, v20
    v_mul_f32 v65, s30, v21
    v_mul_f32 v66, s30, v22
    v_mul_f32 v67, s30, v23
    v_mul_f32 v68, s30, v24
    v_mul_f32 v69, s30, v25
    v_exp_f32 v50, v50
    v_exp_f32 v51, v51
    v_exp_f32 v52, v52
    v_exp_f32 v53, v53
    v_exp_f32 v54, v54
    v_exp_f32 v55, v55
    v_exp_f32 v56, v56
    v_exp_f32 v57, v57
    v_exp_f32 v58, v58
    v_exp_f32 v59, v59
    v_exp_f32 v60, v60
    v_exp_f32 v61, v61
    v_exp_f32 v62, v62
    v_exp_f32 v63, v63
    v_exp_f32 v64, v64
    v_exp_f32 v65, v65
    v_exp_f32 v66, v66
    v_exp_f32 v67, v67
    v_exp_f32 v68, v68
    v_exp_f32 v69, v69
    v_add_f32 v50, 1.0, v50
    v_add_f32 v51, 1.0, v51
    v_add_f32 v52, 1.0, v52
    v_add_f32 v53, 1.0, v53
    v_add_f32 v54, 1.0, v54
    v_add_f32 v55, 1.0, v55
    v_add_f32 v56, 1.0, v56
    v_add_f32 v57, 1.0, v57
    v_add_f32 v58, 1.0, v58
    v_add_f32 v59, 1.0, v59
    v_add_f32 v60, 1.0, v60
    v_add_f32 v61, 1.0, v61
    v_add_f32 v62, 1.0, v62
    v_add_f32 v63, 1.0, v63
    v_add_f32 v64, 1.0, v64
    v_add_f32 v65, 1.0, v65
    v_add_f32 v66, 1.0, v66
    v_add_f32 v67, 1.0, v67
    v_add_f32 v68, 1.0, v68
    v_add_f32 v69, 1.0, v69
    v_rcp_f32 v50, v50
    v_rcp_f32 v51, v51
    v_rcp_f32 v52, v52
    v_rcp_f32 v53, v53
    v_rcp_f32 v54, v54
    v_rcp_f32 v55, v55
    v_rcp_f32 v56, v56
    v_rcp_f32 v57, v57
    v_rcp_f32 v58, v58
    v_rcp_f32 v59, v59
    v_rcp_f32 v60, v60
    v_rcp_f32 v61, v61
    v_rcp_f32 v62, v62
    v_rcp_f32 v63, v63
    v_rcp_f32 v64, v64
    v_rcp_f32 v65, v65
    v_rcp_f32 v66, v66
    v_rcp_f32 v67, v67
    v_rcp_f32 v68, v68
    v_rcp_f32 v69, v69
    v_mul_f32 v6, v50, v6
    v_mul_f32 v7, v51, v7
    v_mul_f32 v8, v52, v8
    v_mul_f32 v9, v53, v9
    v_mul_f32 v10, v54, v10
    v_mul_f32 v11, v55, v11
    v_mul_f32 v12, v56, v12
    v_mul_f32 v13, v57, v13
    v_mul_f32 v14, v58, v14
    v_mul_f32 v15, v59, v15
    v_mul_f32 v16, v60, v16
    v_mul_f32 v17, v61, v17
    v_mul_f32 v18, v62, v18
    v_mul_f32 v19, v63, v19
    v_mul_f32 v20, v64, v20
    v_mul_f32 v21, v65, v21
    v_mul_f32 v22, v66, v22
    v_mul_f32 v23, v67, v23
    v_mul_f32 v24, v68, v24
    v_mul_f32 v25, v69, v25
    ds_write_b128 v32, v[6:9] offset:0
    ds_write_b128 v32, v[10:13] offset:1024
    ds_write_b128 v32, v[14:17] offset:2048
    ds_write_b128 v32, v[18:21] offset:3072
    ds_write_b128 v32, v[22:25] offset:4096
    s_waitcnt lgkmcnt(0)
    s_barrier
M_END:
    s_endpgm
.section .rodata,"a"
.p2align 6
.amdhsa_kernel recurrent_scan__mha_block__mixer_channel_mlp__prompt_kernel
  .amdhsa_next_free_vgpr 252
  .amdhsa_next_free_sgpr 102
  .amdhsa_accum_offset 252
  .amdhsa_group_segment_fixed_size 0
  .amdhsa_kernarg_size 88
  .amdhsa_user_sgpr_count 2
  .amdhsa_user_sgpr_kernarg_segment_ptr 1
  .amdhsa_system_sgpr_workgroup_id_x 1
  .amdhsa_float_denorm_mode_32 3
  .amdhsa_float_denorm_mode_16_64 3
.end_amdhsa_kernel
```
